```python
import torch

def _softmax(x, axis=-1):
    return torch.softmax(x, dim=axis)

def _gelu(x):
    return torch.nn.functional.gelu(x, approximate='tanh')

def _silu(x):
    return torch.nn.functional.silu(x)

def _sigmoid(x):
    return torch.sigmoid(x)

def _layernorm(x, axis=-1, eps=1e-05):
    m = x.mean(dim=axis, keepdim=True)
    v = x.var(dim=axis, keepdim=True, unbiased=False)
    return (x - m) / torch.sqrt(v + eps)

def _scatter_add(tgt, idx, src, axis=0):
    return tgt.clone().index_add_(axis, idx, src)

def _segment_sum(src, seg, n):
    out = torch.zeros((n,) + src.shape[1:], dtype=src.dtype)
    return out.index_add_(0, seg, src)

def _pad(x, pw):
    flat = tuple((v for pair in reversed(pw) for v in pair))
    return torch.nn.functional.pad(x, flat)
kernel_name = 'adaLN_cond__mha_block_cached__moe_arch_mod__prompt'

def setup_inputs():

    _w = lambda a: (lambda t: t.to(torch.bfloat16) if t.is_floating_point() else t)(torch.as_tensor(a))

    def _A_setup():
        B, Sq, D = (1, 2048, 512)
        H, Sk, Dh = (32, 2048, 128)
        return {'x': _w((lambda *s: torch.randn(*s, dtype=torch.bfloat16) * 0.1)(B, Sq, D)), 'k_cache': _w((lambda *s: torch.randn(*s, dtype=torch.bfloat16) * 0.8)(B, H, Sk, Dh)), 'v_cache': _w((lambda *s: torch.randn(*s, dtype=torch.bfloat16) * 1.6)(B, H, Sk, Dh)), 'wq': _w((lambda *s: torch.randn(*s, dtype=torch.bfloat16) * 0.8)(D, H * Dh) * D ** (-0.5)), 'wo': _w((lambda *s: torch.randn(*s, dtype=torch.bfloat16) * 1.6)(H * Dh, D) * (H * Dh) ** (-0.5))}
    _A_in = _A_setup()

    def _B_setup():
        B, S, D, F, C = (1, 2048, 512, 1792, 8)
        return {'x': _w((lambda *s: torch.randn(*s, dtype=torch.bfloat16) * 0.1)(B, S, D)), 'w_r': _w((lambda *s: torch.randn(*s, dtype=torch.bfloat16) * 3.2)(D)), 'w_gate': _w((lambda *s: torch.randn(*s, dtype=torch.bfloat16) * 3.2)(D, F)), 'w_up': _w((lambda *s: torch.randn(*s, dtype=torch.bfloat16) * 3.2)(D, F)), 'w_down': _w((lambda *s: torch.randn(*s, dtype=torch.bfloat16) * 3.2)(F, D))}
    _B_in = _B_setup()
    return {'A_x': _A_in['x'], 'A_k_cache': _A_in['k_cache'], 'A_v_cache': _A_in['v_cache'], 'A_wq': _A_in['wq'], 'A_wo': _A_in['wo'], 'B_x': _B_in['x'], 'B_w_r': _B_in['w_r'], 'B_w_gate': _B_in['w_gate'], 'B_w_up': _B_in['w_up'], 'B_w_down': _B_in['w_down'], 'c': _w((lambda *s: torch.randn(*s, dtype=torch.bfloat16) * 0.2)(1, 512) * 8.0), 'w_mod': _w((lambda *s: torch.randn(*s, dtype=torch.bfloat16) * 0.2)(512, 6 * 512) * 512 ** (-0.5) * 8.0)}

def reference(A_x, A_k_cache, A_v_cache, A_wq, A_wo, B_x, B_w_r, B_w_gate, B_w_up, B_w_down, c, w_mod):

    def _A_ref(x, k_cache, v_cache, wq, wo):
        B, Sq, D = x.shape
        H, Dh = (32, 128)
        q = (lambda x, *d: x.permute(*d))((x @ wq).reshape(B, Sq, H, Dh), 0, 2, 1, 3)
        scores = torch.einsum('bhqd,bhkd->bhqk', q, k_cache) * Dh ** (-0.5)
        p = _softmax(scores, axis=-1)
        o = torch.einsum('bhqk,bhkd->bhqd', p, v_cache)
        return (lambda x, *d: x.permute(*d))(o, 0, 2, 1, 3).reshape(B, Sq, H * Dh) @ wo

    def _B_ref(x, w_r, w_gate, w_up, w_down):
        B, S, D = x.shape
        C = 8
        r = x @ w_r
        idx = torch.argsort(-r, axis=-1)[:, :C]
        idx_e = (lambda x, n, axis: torch.repeat_interleave(x, n, dim=axis))(idx.reshape(B, C, 1), D, axis=2)
        x_sel = (lambda x, i, axis: torch.take_along_dim(x, i, dim=axis))(x, idx_e, axis=1)
        g = _silu(x_sel @ w_gate)
        u = x_sel @ w_up
        y = g * u @ w_down
        r_sel = _sigmoid((lambda x, i, axis: torch.take_along_dim(x, i, dim=axis))(r, idx, axis=1))
        y = y * r_sel.reshape(B, C, 1)
        b_off = (torch.arange(B) * S).reshape(B, 1)
        flat_idx = (idx + b_off).reshape(B * C)
        zero = (x * 0.0).reshape(B * S, D)
        upd = _scatter_add(zero, flat_idx, y.reshape(B * C, D), axis=0)
        return x + upd.reshape(B, S, D)
    x = A_x
    mod = (_silu(c) @ w_mod).reshape(c.shape[0], 6, 1, -1)
    sa, ca, ga, sb, cb, gb = (mod[:, 0].clone(), mod[:, 1].clone(), mod[:, 2].clone(), mod[:, 3].clone(), mod[:, 4].clone(), mod[:, 5].clone())
    h = _layernorm(x, axis=-1) * (1 + ca) + sa
    x = x + ga * _A_ref(h, A_k_cache, A_v_cache, A_wq, A_wo)
    h = _layernorm(x, axis=-1) * (1 + cb) + sb
    x = x + gb * _B_ref(h, B_w_r, B_w_gate, B_w_up, B_w_down)
    return x
```

```asm
; @launch kernel=prep_kernel grid=(176,1,1) block=(256,1,1) lds=8192
; @launch kernel=attn_kernel grid=(256,1,1) block=(512,1,1) lds=131072
; @launch kernel=oproj_kernel grid=(256,1,1) block=(320,1,1) lds=122880
; @launch kernel=pm_kernel grid=(184,1,1) block=(1024,1,1) lds=107520
.amdgcn_target "amdgcn-amd-amdhsa--gfx950"
.text
.globl prep_kernel
.p2align 8
.type prep_kernel,@function
prep_kernel:
    s_cmp_ge_u32 s2, 176
    s_cbranch_scc1 Lk0_end
    s_load_dwordx2 s[4:5], s[0:1], 80
    s_load_dwordx2 s[6:7], s[0:1], 88
    s_load_dwordx2 s[8:9], s[0:1], 112
    s_load_dwordx2 s[10:11], s[0:1], 0
    s_load_dwordx2 s[30:31], s[0:1], 104
    s_cmp_ge_u32 s2, 48
    s_cbranch_scc1 Lk0_h1
    v_and_b32 v1, 7, v0
    v_lshrrev_b32 v2, 3, v0
    v_lshlrev_b32 v3, 5, v2
    s_mov_b32 s24, 98304
    v_mul_lo_u32 v28, v2, s24
    v_lshlrev_b32 v29, 4, v1
    v_add_u32 v28, v28, v29
    s_lshl_b32 s25, s2, 7
    s_waitcnt lgkmcnt(0)

    s_mov_b32 s12, s4
    s_mov_b32 s13, s5
    s_mov_b32 s14, 0x400
    s_mov_b32 s15, 0x00020000
    s_mov_b32 s16, s6
    s_mov_b32 s17, s7
    s_mov_b32 s18, 0x300000
    s_mov_b32 s19, 0x00020000
    s_mov_b32 s20, s8
    s_mov_b32 s21, s9
    s_mov_b32 s22, 0x3000
    s_mov_b32 s23, 0x00020000
    s_mov_b32 s32, s30
    s_mov_b32 s33, s31
    s_mov_b32 s34, 0x100
    s_mov_b32 s35, 0x00020000
    buffer_load_dwordx4 v[4:7], v3, s[12:15], 0 offen
    buffer_load_dwordx4 v[8:11], v3, s[12:15], 0 offen offset:16
    buffer_load_dwordx4 v[32:35], v28, s[16:19], s25 offen
    s_add_u32 s25, s25, 6144
    buffer_load_dwordx4 v[36:39], v28, s[16:19], s25 offen
    s_add_u32 s25, s25, 6144
    buffer_load_dwordx4 v[40:43], v28, s[16:19], s25 offen
    s_add_u32 s25, s25, 6144
    buffer_load_dwordx4 v[44:47], v28, s[16:19], s25 offen
    s_add_u32 s25, s25, 6144
    buffer_load_dwordx4 v[48:51], v28, s[16:19], s25 offen
    s_add_u32 s25, s25, 6144
    buffer_load_dwordx4 v[52:55], v28, s[16:19], s25 offen
    s_add_u32 s25, s25, 6144
    buffer_load_dwordx4 v[56:59], v28, s[16:19], s25 offen
    s_add_u32 s25, s25, 6144
    buffer_load_dwordx4 v[60:63], v28, s[16:19], s25 offen
    s_add_u32 s25, s25, 6144
    buffer_load_dwordx4 v[64:67], v28, s[16:19], s25 offen
    s_add_u32 s25, s25, 6144
    buffer_load_dwordx4 v[68:71], v28, s[16:19], s25 offen
    s_add_u32 s25, s25, 6144
    buffer_load_dwordx4 v[72:75], v28, s[16:19], s25 offen
    s_add_u32 s25, s25, 6144
    buffer_load_dwordx4 v[76:79], v28, s[16:19], s25 offen
    s_add_u32 s25, s25, 6144
    buffer_load_dwordx4 v[80:83], v28, s[16:19], s25 offen
    s_add_u32 s25, s25, 6144
    buffer_load_dwordx4 v[84:87], v28, s[16:19], s25 offen
    s_add_u32 s25, s25, 6144
    buffer_load_dwordx4 v[88:91], v28, s[16:19], s25 offen
    s_add_u32 s25, s25, 6144
    buffer_load_dwordx4 v[92:95], v28, s[16:19], s25 offen
    s_waitcnt vmcnt(16)
    v_lshlrev_b32 v12, 16, v4
    v_and_b32 v13, 0xffff0000, v4
    v_lshlrev_b32 v14, 16, v5
    v_and_b32 v15, 0xffff0000, v5
    v_lshlrev_b32 v16, 16, v6
    v_and_b32 v17, 0xffff0000, v6
    v_lshlrev_b32 v18, 16, v7
    v_and_b32 v19, 0xffff0000, v7
    v_lshlrev_b32 v20, 16, v8
    v_and_b32 v21, 0xffff0000, v8
    v_lshlrev_b32 v22, 16, v9
    v_and_b32 v23, 0xffff0000, v9
    v_lshlrev_b32 v24, 16, v10
    v_and_b32 v25, 0xffff0000, v10
    v_lshlrev_b32 v26, 16, v11
    v_and_b32 v27, 0xffff0000, v11
    s_mov_b32 s26, 0x3fb8aa3b
    v_mul_f32 v30, s26, v12
    v_exp_f32 v30, -v30
    s_nop 0
    v_add_f32 v30, 1.0, v30
    v_rcp_f32 v30, v30
    s_nop 0
    v_mul_f32 v12, v12, v30
    v_cvt_pk_bf16_f32 v12, 0, v12
    v_mul_f32 v30, s26, v13
    v_exp_f32 v30, -v30
    s_nop 0
    v_add_f32 v30, 1.0, v30
    v_rcp_f32 v30, v30
    s_nop 0
    v_mul_f32 v13, v13, v30
    v_cvt_pk_bf16_f32 v13, 0, v13
    v_mul_f32 v30, s26, v14
    v_exp_f32 v30, -v30
    s_nop 0
    v_add_f32 v30, 1.0, v30
    v_rcp_f32 v30, v30
    s_nop 0
    v_mul_f32 v14, v14, v30
    v_cvt_pk_bf16_f32 v14, 0, v14
    v_mul_f32 v30, s26, v15
    v_exp_f32 v30, -v30
    s_nop 0
    v_add_f32 v30, 1.0, v30
    v_rcp_f32 v30, v30
    s_nop 0
    v_mul_f32 v15, v15, v30
    v_cvt_pk_bf16_f32 v15, 0, v15
    v_mul_f32 v30, s26, v16
    v_exp_f32 v30, -v30
    s_nop 0
    v_add_f32 v30, 1.0, v30
    v_rcp_f32 v30, v30
    s_nop 0
    v_mul_f32 v16, v16, v30
    v_cvt_pk_bf16_f32 v16, 0, v16
    v_mul_f32 v30, s26, v17
    v_exp_f32 v30, -v30
    s_nop 0
    v_add_f32 v30, 1.0, v30
    v_rcp_f32 v30, v30
    s_nop 0
    v_mul_f32 v17, v17, v30
    v_cvt_pk_bf16_f32 v17, 0, v17
    v_mul_f32 v30, s26, v18
    v_exp_f32 v30, -v30
    s_nop 0
    v_add_f32 v30, 1.0, v30
    v_rcp_f32 v30, v30
    s_nop 0
    v_mul_f32 v18, v18, v30
    v_cvt_pk_bf16_f32 v18, 0, v18
    v_mul_f32 v30, s26, v19
    v_exp_f32 v30, -v30
    s_nop 0
    v_add_f32 v30, 1.0, v30
    v_rcp_f32 v30, v30
    s_nop 0
    v_mul_f32 v19, v19, v30
    v_cvt_pk_bf16_f32 v19, 0, v19
    v_mul_f32 v30, s26, v20
    v_exp_f32 v30, -v30
    s_nop 0
    v_add_f32 v30, 1.0, v30
    v_rcp_f32 v30, v30
    s_nop 0
    v_mul_f32 v20, v20, v30
    v_cvt_pk_bf16_f32 v20, 0, v20
    v_mul_f32 v30, s26, v21
    v_exp_f32 v30, -v30
    s_nop 0
    v_add_f32 v30, 1.0, v30
    v_rcp_f32 v30, v30
    s_nop 0
    v_mul_f32 v21, v21, v30
    v_cvt_pk_bf16_f32 v21, 0, v21
    v_mul_f32 v30, s26, v22
    v_exp_f32 v30, -v30
    s_nop 0
    v_add_f32 v30, 1.0, v30
    v_rcp_f32 v30, v30
    s_nop 0
    v_mul_f32 v22, v22, v30
    v_cvt_pk_bf16_f32 v22, 0, v22
    v_mul_f32 v30, s26, v23
    v_exp_f32 v30, -v30
    s_nop 0
    v_add_f32 v30, 1.0, v30
    v_rcp_f32 v30, v30
    s_nop 0
    v_mul_f32 v23, v23, v30
    v_cvt_pk_bf16_f32 v23, 0, v23
    v_mul_f32 v30, s26, v24
    v_exp_f32 v30, -v30
    s_nop 0
    v_add_f32 v30, 1.0, v30
    v_rcp_f32 v30, v30
    s_nop 0
    v_mul_f32 v24, v24, v30
    v_cvt_pk_bf16_f32 v24, 0, v24
    v_mul_f32 v30, s26, v25
    v_exp_f32 v30, -v30
    s_nop 0
    v_add_f32 v30, 1.0, v30
    v_rcp_f32 v30, v30
    s_nop 0
    v_mul_f32 v25, v25, v30
    v_cvt_pk_bf16_f32 v25, 0, v25
    v_mul_f32 v30, s26, v26
    v_exp_f32 v30, -v30
    s_nop 0
    v_add_f32 v30, 1.0, v30
    v_rcp_f32 v30, v30
    s_nop 0
    v_mul_f32 v26, v26, v30
    v_cvt_pk_bf16_f32 v26, 0, v26
    v_mul_f32 v30, s26, v27
    v_exp_f32 v30, -v30
    s_nop 0
    v_add_f32 v30, 1.0, v30
    v_rcp_f32 v30, v30
    s_nop 0
    v_mul_f32 v27, v27, v30
    v_cvt_pk_bf16_f32 v27, 0, v27
    v_mov_b32 v96, 0
    v_mov_b32 v97, 0
    v_mov_b32 v98, 0
    v_mov_b32 v99, 0
    v_mov_b32 v100, 0
    v_mov_b32 v101, 0
    v_mov_b32 v102, 0
    v_mov_b32 v103, 0
    s_waitcnt vmcnt(15)
    v_lshlrev_b32 v30, 16, v32
    v_and_b32 v31, 0xffff0000, v32
    v_fmac_f32 v96, v12, v30
    v_fmac_f32 v97, v12, v31
    v_lshlrev_b32 v30, 16, v33
    v_and_b32 v31, 0xffff0000, v33
    v_fmac_f32 v98, v12, v30
    v_fmac_f32 v99, v12, v31
    v_lshlrev_b32 v30, 16, v34
    v_and_b32 v31, 0xffff0000, v34
    v_fmac_f32 v100, v12, v30
    v_fmac_f32 v101, v12, v31
    v_lshlrev_b32 v30, 16, v35
    v_and_b32 v31, 0xffff0000, v35
    v_fmac_f32 v102, v12, v30
    v_fmac_f32 v103, v12, v31
    s_waitcnt vmcnt(14)
    v_lshlrev_b32 v30, 16, v36
    v_and_b32 v31, 0xffff0000, v36
    v_fmac_f32 v96, v13, v30
    v_fmac_f32 v97, v13, v31
    v_lshlrev_b32 v30, 16, v37
    v_and_b32 v31, 0xffff0000, v37
    v_fmac_f32 v98, v13, v30
    v_fmac_f32 v99, v13, v31
    v_lshlrev_b32 v30, 16, v38
    v_and_b32 v31, 0xffff0000, v38
    v_fmac_f32 v100, v13, v30
    v_fmac_f32 v101, v13, v31
    v_lshlrev_b32 v30, 16, v39
    v_and_b32 v31, 0xffff0000, v39
    v_fmac_f32 v102, v13, v30
    v_fmac_f32 v103, v13, v31
    s_waitcnt vmcnt(13)
    v_lshlrev_b32 v30, 16, v40
    v_and_b32 v31, 0xffff0000, v40
    v_fmac_f32 v96, v14, v30
    v_fmac_f32 v97, v14, v31
    v_lshlrev_b32 v30, 16, v41
    v_and_b32 v31, 0xffff0000, v41
    v_fmac_f32 v98, v14, v30
    v_fmac_f32 v99, v14, v31
    v_lshlrev_b32 v30, 16, v42
    v_and_b32 v31, 0xffff0000, v42
    v_fmac_f32 v100, v14, v30
    v_fmac_f32 v101, v14, v31
    v_lshlrev_b32 v30, 16, v43
    v_and_b32 v31, 0xffff0000, v43
    v_fmac_f32 v102, v14, v30
    v_fmac_f32 v103, v14, v31
    s_waitcnt vmcnt(12)
    v_lshlrev_b32 v30, 16, v44
    v_and_b32 v31, 0xffff0000, v44
    v_fmac_f32 v96, v15, v30
    v_fmac_f32 v97, v15, v31
    v_lshlrev_b32 v30, 16, v45
    v_and_b32 v31, 0xffff0000, v45
    v_fmac_f32 v98, v15, v30
    v_fmac_f32 v99, v15, v31
    v_lshlrev_b32 v30, 16, v46
    v_and_b32 v31, 0xffff0000, v46
    v_fmac_f32 v100, v15, v30
    v_fmac_f32 v101, v15, v31
    v_lshlrev_b32 v30, 16, v47
    v_and_b32 v31, 0xffff0000, v47
    v_fmac_f32 v102, v15, v30
    v_fmac_f32 v103, v15, v31
    s_waitcnt vmcnt(11)
    v_lshlrev_b32 v30, 16, v48
    v_and_b32 v31, 0xffff0000, v48
    v_fmac_f32 v96, v16, v30
    v_fmac_f32 v97, v16, v31
    v_lshlrev_b32 v30, 16, v49
    v_and_b32 v31, 0xffff0000, v49
    v_fmac_f32 v98, v16, v30
    v_fmac_f32 v99, v16, v31
    v_lshlrev_b32 v30, 16, v50
    v_and_b32 v31, 0xffff0000, v50
    v_fmac_f32 v100, v16, v30
    v_fmac_f32 v101, v16, v31
    v_lshlrev_b32 v30, 16, v51
    v_and_b32 v31, 0xffff0000, v51
    v_fmac_f32 v102, v16, v30
    v_fmac_f32 v103, v16, v31
    s_waitcnt vmcnt(10)
    v_lshlrev_b32 v30, 16, v52
    v_and_b32 v31, 0xffff0000, v52
    v_fmac_f32 v96, v17, v30
    v_fmac_f32 v97, v17, v31
    v_lshlrev_b32 v30, 16, v53
    v_and_b32 v31, 0xffff0000, v53
    v_fmac_f32 v98, v17, v30
    v_fmac_f32 v99, v17, v31
    v_lshlrev_b32 v30, 16, v54
    v_and_b32 v31, 0xffff0000, v54
    v_fmac_f32 v100, v17, v30
    v_fmac_f32 v101, v17, v31
    v_lshlrev_b32 v30, 16, v55
    v_and_b32 v31, 0xffff0000, v55
    v_fmac_f32 v102, v17, v30
    v_fmac_f32 v103, v17, v31
    s_waitcnt vmcnt(9)
    v_lshlrev_b32 v30, 16, v56
    v_and_b32 v31, 0xffff0000, v56
    v_fmac_f32 v96, v18, v30
    v_fmac_f32 v97, v18, v31
    v_lshlrev_b32 v30, 16, v57
    v_and_b32 v31, 0xffff0000, v57
    v_fmac_f32 v98, v18, v30
    v_fmac_f32 v99, v18, v31
    v_lshlrev_b32 v30, 16, v58
    v_and_b32 v31, 0xffff0000, v58
    v_fmac_f32 v100, v18, v30
    v_fmac_f32 v101, v18, v31
    v_lshlrev_b32 v30, 16, v59
    v_and_b32 v31, 0xffff0000, v59
    v_fmac_f32 v102, v18, v30
    v_fmac_f32 v103, v18, v31
    s_waitcnt vmcnt(8)
    v_lshlrev_b32 v30, 16, v60
    v_and_b32 v31, 0xffff0000, v60
    v_fmac_f32 v96, v19, v30
    v_fmac_f32 v97, v19, v31
    v_lshlrev_b32 v30, 16, v61
    v_and_b32 v31, 0xffff0000, v61
    v_fmac_f32 v98, v19, v30
    v_fmac_f32 v99, v19, v31
    v_lshlrev_b32 v30, 16, v62
    v_and_b32 v31, 0xffff0000, v62
    v_fmac_f32 v100, v19, v30
    v_fmac_f32 v101, v19, v31
    v_lshlrev_b32 v30, 16, v63
    v_and_b32 v31, 0xffff0000, v63
    v_fmac_f32 v102, v19, v30
    v_fmac_f32 v103, v19, v31
    s_waitcnt vmcnt(7)
    v_lshlrev_b32 v30, 16, v64
    v_and_b32 v31, 0xffff0000, v64
    v_fmac_f32 v96, v20, v30
    v_fmac_f32 v97, v20, v31
    v_lshlrev_b32 v30, 16, v65
    v_and_b32 v31, 0xffff0000, v65
    v_fmac_f32 v98, v20, v30
    v_fmac_f32 v99, v20, v31
    v_lshlrev_b32 v30, 16, v66
    v_and_b32 v31, 0xffff0000, v66
    v_fmac_f32 v100, v20, v30
    v_fmac_f32 v101, v20, v31
    v_lshlrev_b32 v30, 16, v67
    v_and_b32 v31, 0xffff0000, v67
    v_fmac_f32 v102, v20, v30
    v_fmac_f32 v103, v20, v31
    s_waitcnt vmcnt(6)
    v_lshlrev_b32 v30, 16, v68
    v_and_b32 v31, 0xffff0000, v68
    v_fmac_f32 v96, v21, v30
    v_fmac_f32 v97, v21, v31
    v_lshlrev_b32 v30, 16, v69
    v_and_b32 v31, 0xffff0000, v69
    v_fmac_f32 v98, v21, v30
    v_fmac_f32 v99, v21, v31
    v_lshlrev_b32 v30, 16, v70
    v_and_b32 v31, 0xffff0000, v70
    v_fmac_f32 v100, v21, v30
    v_fmac_f32 v101, v21, v31
    v_lshlrev_b32 v30, 16, v71
    v_and_b32 v31, 0xffff0000, v71
    v_fmac_f32 v102, v21, v30
    v_fmac_f32 v103, v21, v31
    s_waitcnt vmcnt(5)
    v_lshlrev_b32 v30, 16, v72
    v_and_b32 v31, 0xffff0000, v72
    v_fmac_f32 v96, v22, v30
    v_fmac_f32 v97, v22, v31
    v_lshlrev_b32 v30, 16, v73
    v_and_b32 v31, 0xffff0000, v73
    v_fmac_f32 v98, v22, v30
    v_fmac_f32 v99, v22, v31
    v_lshlrev_b32 v30, 16, v74
    v_and_b32 v31, 0xffff0000, v74
    v_fmac_f32 v100, v22, v30
    v_fmac_f32 v101, v22, v31
    v_lshlrev_b32 v30, 16, v75
    v_and_b32 v31, 0xffff0000, v75
    v_fmac_f32 v102, v22, v30
    v_fmac_f32 v103, v22, v31
    s_waitcnt vmcnt(4)
    v_lshlrev_b32 v30, 16, v76
    v_and_b32 v31, 0xffff0000, v76
    v_fmac_f32 v96, v23, v30
    v_fmac_f32 v97, v23, v31
    v_lshlrev_b32 v30, 16, v77
    v_and_b32 v31, 0xffff0000, v77
    v_fmac_f32 v98, v23, v30
    v_fmac_f32 v99, v23, v31
    v_lshlrev_b32 v30, 16, v78
    v_and_b32 v31, 0xffff0000, v78
    v_fmac_f32 v100, v23, v30
    v_fmac_f32 v101, v23, v31
    v_lshlrev_b32 v30, 16, v79
    v_and_b32 v31, 0xffff0000, v79
    v_fmac_f32 v102, v23, v30
    v_fmac_f32 v103, v23, v31
    s_waitcnt vmcnt(3)
    v_lshlrev_b32 v30, 16, v80
    v_and_b32 v31, 0xffff0000, v80
    v_fmac_f32 v96, v24, v30
    v_fmac_f32 v97, v24, v31
    v_lshlrev_b32 v30, 16, v81
    v_and_b32 v31, 0xffff0000, v81
    v_fmac_f32 v98, v24, v30
    v_fmac_f32 v99, v24, v31
    v_lshlrev_b32 v30, 16, v82
    v_and_b32 v31, 0xffff0000, v82
    v_fmac_f32 v100, v24, v30
    v_fmac_f32 v101, v24, v31
    v_lshlrev_b32 v30, 16, v83
    v_and_b32 v31, 0xffff0000, v83
    v_fmac_f32 v102, v24, v30
    v_fmac_f32 v103, v24, v31
    s_waitcnt vmcnt(2)
    v_lshlrev_b32 v30, 16, v84
    v_and_b32 v31, 0xffff0000, v84
    v_fmac_f32 v96, v25, v30
    v_fmac_f32 v97, v25, v31
    v_lshlrev_b32 v30, 16, v85
    v_and_b32 v31, 0xffff0000, v85
    v_fmac_f32 v98, v25, v30
    v_fmac_f32 v99, v25, v31
    v_lshlrev_b32 v30, 16, v86
    v_and_b32 v31, 0xffff0000, v86
    v_fmac_f32 v100, v25, v30
    v_fmac_f32 v101, v25, v31
    v_lshlrev_b32 v30, 16, v87
    v_and_b32 v31, 0xffff0000, v87
    v_fmac_f32 v102, v25, v30
    v_fmac_f32 v103, v25, v31
    s_waitcnt vmcnt(1)
    v_lshlrev_b32 v30, 16, v88
    v_and_b32 v31, 0xffff0000, v88
    v_fmac_f32 v96, v26, v30
    v_fmac_f32 v97, v26, v31
    v_lshlrev_b32 v30, 16, v89
    v_and_b32 v31, 0xffff0000, v89
    v_fmac_f32 v98, v26, v30
    v_fmac_f32 v99, v26, v31
    v_lshlrev_b32 v30, 16, v90
    v_and_b32 v31, 0xffff0000, v90
    v_fmac_f32 v100, v26, v30
    v_fmac_f32 v101, v26, v31
    v_lshlrev_b32 v30, 16, v91
    v_and_b32 v31, 0xffff0000, v91
    v_fmac_f32 v102, v26, v30
    v_fmac_f32 v103, v26, v31
    s_waitcnt vmcnt(0)
    v_lshlrev_b32 v30, 16, v92
    v_and_b32 v31, 0xffff0000, v92
    v_fmac_f32 v96, v27, v30
    v_fmac_f32 v97, v27, v31
    v_lshlrev_b32 v30, 16, v93
    v_and_b32 v31, 0xffff0000, v93
    v_fmac_f32 v98, v27, v30
    v_fmac_f32 v99, v27, v31
    v_lshlrev_b32 v30, 16, v94
    v_and_b32 v31, 0xffff0000, v94
    v_fmac_f32 v100, v27, v30
    v_fmac_f32 v101, v27, v31
    v_lshlrev_b32 v30, 16, v95
    v_and_b32 v31, 0xffff0000, v95
    v_fmac_f32 v102, v27, v30
    v_fmac_f32 v103, v27, v31
    v_lshlrev_b32 v3, 8, v2
    v_lshlrev_b32 v29, 5, v1
    v_add_u32 v3, v3, v29
    ds_write_b128 v3, v[96:99]
    ds_write_b128 v3, v[100:103] offset:16
    s_waitcnt lgkmcnt(0)
    s_barrier
    v_cmp_gt_u32 vcc, 64, v0
    s_and_saveexec_b64 s[28:29], vcc
    s_cbranch_execz Lk0_end
    v_lshlrev_b32 v3, 2, v0

    ds_read_b32 v32, v3 offset:0
    ds_read_b32 v33, v3 offset:256
    ds_read_b32 v34, v3 offset:512
    ds_read_b32 v35, v3 offset:768
    ds_read_b32 v36, v3 offset:1024
    ds_read_b32 v37, v3 offset:1280
    ds_read_b32 v38, v3 offset:1536
    ds_read_b32 v39, v3 offset:1792
    ds_read_b32 v40, v3 offset:2048
    ds_read_b32 v41, v3 offset:2304
    ds_read_b32 v42, v3 offset:2560
    ds_read_b32 v43, v3 offset:2816
    ds_read_b32 v44, v3 offset:3072
    ds_read_b32 v45, v3 offset:3328
    ds_read_b32 v46, v3 offset:3584
    ds_read_b32 v47, v3 offset:3840
    ds_read_b32 v48, v3 offset:4096
    ds_read_b32 v49, v3 offset:4352
    ds_read_b32 v50, v3 offset:4608
    ds_read_b32 v51, v3 offset:4864
    ds_read_b32 v52, v3 offset:5120
    ds_read_b32 v53, v3 offset:5376
    ds_read_b32 v54, v3 offset:5632
    ds_read_b32 v55, v3 offset:5888
    ds_read_b32 v56, v3 offset:6144
    ds_read_b32 v57, v3 offset:6400
    ds_read_b32 v58, v3 offset:6656
    ds_read_b32 v59, v3 offset:6912
    ds_read_b32 v60, v3 offset:7168
    ds_read_b32 v61, v3 offset:7424
    ds_read_b32 v62, v3 offset:7680
    ds_read_b32 v63, v3 offset:7936
    s_waitcnt lgkmcnt(0)
    v_add_f32 v32, v32, v33
    v_add_f32 v32, v32, v34
    v_add_f32 v32, v32, v35
    v_add_f32 v32, v32, v36
    v_add_f32 v32, v32, v37
    v_add_f32 v32, v32, v38
    v_add_f32 v32, v32, v39
    v_add_f32 v32, v32, v40
    v_add_f32 v32, v32, v41
    v_add_f32 v32, v32, v42
    v_add_f32 v32, v32, v43
    v_add_f32 v32, v32, v44
    v_add_f32 v32, v32, v45
    v_add_f32 v32, v32, v46
    v_add_f32 v32, v32, v47
    v_add_f32 v32, v32, v48
    v_add_f32 v32, v32, v49
    v_add_f32 v32, v32, v50
    v_add_f32 v32, v32, v51
    v_add_f32 v32, v32, v52
    v_add_f32 v32, v32, v53
    v_add_f32 v32, v32, v54
    v_add_f32 v32, v32, v55
    v_add_f32 v32, v32, v56
    v_add_f32 v32, v32, v57
    v_add_f32 v32, v32, v58
    v_add_f32 v32, v32, v59
    v_add_f32 v32, v32, v60
    v_add_f32 v32, v32, v61
    v_add_f32 v32, v32, v62
    v_add_f32 v32, v32, v63
    v_cvt_pk_bf16_f32 v32, 0, v32
    s_lshl_b32 s25, s2, 8
    buffer_store_dword v32, v3, s[20:23], s25 offen sc0 sc1
    s_cmp_ge_u32 s2, 16
    s_cbranch_scc1 Lk0_end
    s_waitcnt vmcnt(0)
    v_mov_b32 v4, 1
    v_mov_b32 v5, 64
    s_mov_b64 exec, 1
    buffer_atomic_add v4, v5, s[32:35], 0 offen sc0 sc1
    s_waitcnt vmcnt(0)
    v_readfirstlane_b32 s24, v4
    s_nop 3
    s_cmp_lg_u32 s24, 15
    s_cbranch_scc1 Lk0_end
    v_mov_b32 v4, 16
    v_mov_b32 v5, 128
    buffer_store_dword v4, v5, s[32:35], 0 offen sc0 sc1
    s_branch Lk0_end

Lk0_h1:
    v_and_b32 v1, 63, v0
    v_lshrrev_b32 v2, 6, v0
    s_sub_u32 s24, s2, 48
    s_lshl_b32 s24, s24, 2
    v_add_u32 v2, s24, v2
    v_lshlrev_b32 v2, 2, v2
    v_lshlrev_b32 v3, 10, v2
    v_lshlrev_b32 v4, 4, v1
    v_add_u32 v3, v3, v4
    v_lshlrev_b32 v5, 5, v1
    s_waitcnt lgkmcnt(0)

    s_mov_b32 s12, s10
    s_mov_b32 s13, s11
    s_mov_b32 s14, 0x200000
    s_mov_b32 s15, 0x00020000
    s_mov_b32 s16, s8
    s_mov_b32 s17, s9
    s_mov_b32 s18, 0x3000
    s_mov_b32 s19, 0x00020000
    s_add_u32 s20, s8, 0x100000
    s_addc_u32 s21, s9, 0
    s_mov_b32 s22, 0x200000
    s_mov_b32 s23, 0x00020000
    s_mov_b32 s32, s30
    s_mov_b32 s33, s31
    s_mov_b32 s34, 0x100
    s_mov_b32 s35, 0x00020000
    buffer_load_dwordx4 v[8:11], v3, s[12:15], 0 offen offset:0
    buffer_load_dwordx4 v[12:15], v3, s[12:15], 0 offen offset:1024
    buffer_load_dwordx4 v[16:19], v3, s[12:15], 0 offen offset:2048
    buffer_load_dwordx4 v[20:23], v3, s[12:15], 0 offen offset:3072
    v_lshrrev_b32 v6, 5, v2
    v_lshlrev_b32 v6, 15, v6
    v_lshrrev_b32 v7, 1, v1
    v_lshlrev_b32 v7, 10, v7
    v_add_u32 v6, v6, v7
    v_and_b32 v7, 31, v2
    v_lshlrev_b32 v7, 4, v7
    v_add_u32 v6, v6, v7
    v_and_b32 v7, 1, v1
    v_lshlrev_b32 v7, 9, v7
    v_add_u32 v6, v6, v7
    s_waitcnt vmcnt(0)

    v_lshlrev_b32 v32, 16, v8
    v_and_b32 v33, 0xffff0000, v8
    v_lshlrev_b32 v34, 16, v9
    v_and_b32 v35, 0xffff0000, v9
    v_lshlrev_b32 v36, 16, v10
    v_and_b32 v37, 0xffff0000, v10
    v_lshlrev_b32 v38, 16, v11
    v_and_b32 v39, 0xffff0000, v11
    v_add_f32 v24, v32, v33
    v_add_f32 v24, v24, v34
    v_add_f32 v24, v24, v35
    v_add_f32 v24, v24, v36
    v_add_f32 v24, v24, v37
    v_add_f32 v24, v24, v38
    v_add_f32 v24, v24, v39
    s_nop 1
    v_add_f32_dpp v24, v24, v24 quad_perm:[1,0,3,2] row_mask:0xf bank_mask:0xf
    s_nop 1
    v_add_f32_dpp v24, v24, v24 quad_perm:[2,3,0,1] row_mask:0xf bank_mask:0xf
    s_nop 1
    v_add_f32_dpp v24, v24, v24 row_half_mirror row_mask:0xf bank_mask:0xf
    s_nop 1
    v_add_f32_dpp v24, v24, v24 row_mirror row_mask:0xf bank_mask:0xf
    v_mov_b32 v25, v24
    v_mov_b32 v26, v24
    s_nop 1
    v_permlane16_swap_b32 v25, v26
    s_nop 1
    v_add_f32 v24, v25, v26
    v_mov_b32 v25, v24
    v_mov_b32 v26, v24
    s_nop 1
    v_permlane32_swap_b32 v25, v26
    s_nop 1
    v_add_f32 v24, v25, v26
    v_mul_f32 v24, 0x3b000000, v24
    v_sub_f32 v25, v32, v24
    v_mul_f32 v27, v25, v25
    v_sub_f32 v25, v33, v24
    v_fmac_f32 v27, v25, v25
    v_sub_f32 v25, v34, v24
    v_fmac_f32 v27, v25, v25
    v_sub_f32 v25, v35, v24
    v_fmac_f32 v27, v25, v25
    v_sub_f32 v25, v36, v24
    v_fmac_f32 v27, v25, v25
    v_sub_f32 v25, v37, v24
    v_fmac_f32 v27, v25, v25
    v_sub_f32 v25, v38, v24
    v_fmac_f32 v27, v25, v25
    v_sub_f32 v25, v39, v24
    v_fmac_f32 v27, v25, v25
    s_nop 1
    v_add_f32_dpp v27, v27, v27 quad_perm:[1,0,3,2] row_mask:0xf bank_mask:0xf
    s_nop 1
    v_add_f32_dpp v27, v27, v27 quad_perm:[2,3,0,1] row_mask:0xf bank_mask:0xf
    s_nop 1
    v_add_f32_dpp v27, v27, v27 row_half_mirror row_mask:0xf bank_mask:0xf
    s_nop 1
    v_add_f32_dpp v27, v27, v27 row_mirror row_mask:0xf bank_mask:0xf
    v_mov_b32 v25, v27
    v_mov_b32 v26, v27
    s_nop 1
    v_permlane16_swap_b32 v25, v26
    s_nop 1
    v_add_f32 v27, v25, v26
    v_mov_b32 v25, v27
    v_mov_b32 v26, v27
    s_nop 1
    v_permlane32_swap_b32 v25, v26
    s_nop 1
    v_add_f32 v27, v25, v26
    v_mul_f32 v27, 0x3b000000, v27
    v_cvt_pk_bf16_f32 v24, 0, v24
    v_cvt_pk_bf16_f32 v27, 0, v27
    v_add_f32 v27, 0x3727c5ac, v27
    v_cvt_pk_bf16_f32 v27, 0, v27
    v_sqrt_f32 v27, v27
    s_nop 0
    v_cvt_pk_bf16_f32 v27, 0, v27
    v_rcp_f32 v27, v27
    s_nop 0
    v_sub_f32 v64, v32, v24
    v_cvt_pk_bf16_f32 v64, 0, v64
    v_mul_f32 v64, v64, v27
    v_cvt_pk_bf16_f32 v64, 0, v64
    v_sub_f32 v65, v33, v24
    v_cvt_pk_bf16_f32 v65, 0, v65
    v_mul_f32 v65, v65, v27
    v_cvt_pk_bf16_f32 v65, 0, v65
    v_sub_f32 v66, v34, v24
    v_cvt_pk_bf16_f32 v66, 0, v66
    v_mul_f32 v66, v66, v27
    v_cvt_pk_bf16_f32 v66, 0, v66
    v_sub_f32 v67, v35, v24
    v_cvt_pk_bf16_f32 v67, 0, v67
    v_mul_f32 v67, v67, v27
    v_cvt_pk_bf16_f32 v67, 0, v67
    v_sub_f32 v68, v36, v24
    v_cvt_pk_bf16_f32 v68, 0, v68
    v_mul_f32 v68, v68, v27
    v_cvt_pk_bf16_f32 v68, 0, v68
    v_sub_f32 v69, v37, v24
    v_cvt_pk_bf16_f32 v69, 0, v69
    v_mul_f32 v69, v69, v27
    v_cvt_pk_bf16_f32 v69, 0, v69
    v_sub_f32 v70, v38, v24
    v_cvt_pk_bf16_f32 v70, 0, v70
    v_mul_f32 v70, v70, v27
    v_cvt_pk_bf16_f32 v70, 0, v70
    v_sub_f32 v71, v39, v24
    v_cvt_pk_bf16_f32 v71, 0, v71
    v_mul_f32 v71, v71, v27
    v_cvt_pk_bf16_f32 v71, 0, v71
    v_lshlrev_b32 v32, 16, v12
    v_and_b32 v33, 0xffff0000, v12
    v_lshlrev_b32 v34, 16, v13
    v_and_b32 v35, 0xffff0000, v13
    v_lshlrev_b32 v36, 16, v14
    v_and_b32 v37, 0xffff0000, v14
    v_lshlrev_b32 v38, 16, v15
    v_and_b32 v39, 0xffff0000, v15
    v_add_f32 v24, v32, v33
    v_add_f32 v24, v24, v34
    v_add_f32 v24, v24, v35
    v_add_f32 v24, v24, v36
    v_add_f32 v24, v24, v37
    v_add_f32 v24, v24, v38
    v_add_f32 v24, v24, v39
    s_nop 1
    v_add_f32_dpp v24, v24, v24 quad_perm:[1,0,3,2] row_mask:0xf bank_mask:0xf
    s_nop 1
    v_add_f32_dpp v24, v24, v24 quad_perm:[2,3,0,1] row_mask:0xf bank_mask:0xf
    s_nop 1
    v_add_f32_dpp v24, v24, v24 row_half_mirror row_mask:0xf bank_mask:0xf
    s_nop 1
    v_add_f32_dpp v24, v24, v24 row_mirror row_mask:0xf bank_mask:0xf
    v_mov_b32 v25, v24
    v_mov_b32 v26, v24
    s_nop 1
    v_permlane16_swap_b32 v25, v26
    s_nop 1
    v_add_f32 v24, v25, v26
    v_mov_b32 v25, v24
    v_mov_b32 v26, v24
    s_nop 1
    v_permlane32_swap_b32 v25, v26
    s_nop 1
    v_add_f32 v24, v25, v26
    v_mul_f32 v24, 0x3b000000, v24
    v_sub_f32 v25, v32, v24
    v_mul_f32 v27, v25, v25
    v_sub_f32 v25, v33, v24
    v_fmac_f32 v27, v25, v25
    v_sub_f32 v25, v34, v24
    v_fmac_f32 v27, v25, v25
    v_sub_f32 v25, v35, v24
    v_fmac_f32 v27, v25, v25
    v_sub_f32 v25, v36, v24
    v_fmac_f32 v27, v25, v25
    v_sub_f32 v25, v37, v24
    v_fmac_f32 v27, v25, v25
    v_sub_f32 v25, v38, v24
    v_fmac_f32 v27, v25, v25
    v_sub_f32 v25, v39, v24
    v_fmac_f32 v27, v25, v25
    s_nop 1
    v_add_f32_dpp v27, v27, v27 quad_perm:[1,0,3,2] row_mask:0xf bank_mask:0xf
    s_nop 1
    v_add_f32_dpp v27, v27, v27 quad_perm:[2,3,0,1] row_mask:0xf bank_mask:0xf
    s_nop 1
    v_add_f32_dpp v27, v27, v27 row_half_mirror row_mask:0xf bank_mask:0xf
    s_nop 1
    v_add_f32_dpp v27, v27, v27 row_mirror row_mask:0xf bank_mask:0xf
    v_mov_b32 v25, v27
    v_mov_b32 v26, v27
    s_nop 1
    v_permlane16_swap_b32 v25, v26
    s_nop 1
    v_add_f32 v27, v25, v26
    v_mov_b32 v25, v27
    v_mov_b32 v26, v27
    s_nop 1
    v_permlane32_swap_b32 v25, v26
    s_nop 1
    v_add_f32 v27, v25, v26
    v_mul_f32 v27, 0x3b000000, v27
    v_cvt_pk_bf16_f32 v24, 0, v24
    v_cvt_pk_bf16_f32 v27, 0, v27
    v_add_f32 v27, 0x3727c5ac, v27
    v_cvt_pk_bf16_f32 v27, 0, v27
    v_sqrt_f32 v27, v27
    s_nop 0
    v_cvt_pk_bf16_f32 v27, 0, v27
    v_rcp_f32 v27, v27
    s_nop 0
    v_sub_f32 v72, v32, v24
    v_cvt_pk_bf16_f32 v72, 0, v72
    v_mul_f32 v72, v72, v27
    v_cvt_pk_bf16_f32 v72, 0, v72
    v_sub_f32 v73, v33, v24
    v_cvt_pk_bf16_f32 v73, 0, v73
    v_mul_f32 v73, v73, v27
    v_cvt_pk_bf16_f32 v73, 0, v73
    v_sub_f32 v74, v34, v24
    v_cvt_pk_bf16_f32 v74, 0, v74
    v_mul_f32 v74, v74, v27
    v_cvt_pk_bf16_f32 v74, 0, v74
    v_sub_f32 v75, v35, v24
    v_cvt_pk_bf16_f32 v75, 0, v75
    v_mul_f32 v75, v75, v27
    v_cvt_pk_bf16_f32 v75, 0, v75
    v_sub_f32 v76, v36, v24
    v_cvt_pk_bf16_f32 v76, 0, v76
    v_mul_f32 v76, v76, v27
    v_cvt_pk_bf16_f32 v76, 0, v76
    v_sub_f32 v77, v37, v24
    v_cvt_pk_bf16_f32 v77, 0, v77
    v_mul_f32 v77, v77, v27
    v_cvt_pk_bf16_f32 v77, 0, v77
    v_sub_f32 v78, v38, v24
    v_cvt_pk_bf16_f32 v78, 0, v78
    v_mul_f32 v78, v78, v27
    v_cvt_pk_bf16_f32 v78, 0, v78
    v_sub_f32 v79, v39, v24
    v_cvt_pk_bf16_f32 v79, 0, v79
    v_mul_f32 v79, v79, v27
    v_cvt_pk_bf16_f32 v79, 0, v79
    v_lshlrev_b32 v32, 16, v16
    v_and_b32 v33, 0xffff0000, v16
    v_lshlrev_b32 v34, 16, v17
    v_and_b32 v35, 0xffff0000, v17
    v_lshlrev_b32 v36, 16, v18
    v_and_b32 v37, 0xffff0000, v18
    v_lshlrev_b32 v38, 16, v19
    v_and_b32 v39, 0xffff0000, v19
    v_add_f32 v24, v32, v33
    v_add_f32 v24, v24, v34
    v_add_f32 v24, v24, v35
    v_add_f32 v24, v24, v36
    v_add_f32 v24, v24, v37
    v_add_f32 v24, v24, v38
    v_add_f32 v24, v24, v39
    s_nop 1
    v_add_f32_dpp v24, v24, v24 quad_perm:[1,0,3,2] row_mask:0xf bank_mask:0xf
    s_nop 1
    v_add_f32_dpp v24, v24, v24 quad_perm:[2,3,0,1] row_mask:0xf bank_mask:0xf
    s_nop 1
    v_add_f32_dpp v24, v24, v24 row_half_mirror row_mask:0xf bank_mask:0xf
    s_nop 1
    v_add_f32_dpp v24, v24, v24 row_mirror row_mask:0xf bank_mask:0xf
    v_mov_b32 v25, v24
    v_mov_b32 v26, v24
    s_nop 1
    v_permlane16_swap_b32 v25, v26
    s_nop 1
    v_add_f32 v24, v25, v26
    v_mov_b32 v25, v24
    v_mov_b32 v26, v24
    s_nop 1
    v_permlane32_swap_b32 v25, v26
    s_nop 1
    v_add_f32 v24, v25, v26
    v_mul_f32 v24, 0x3b000000, v24
    v_sub_f32 v25, v32, v24
    v_mul_f32 v27, v25, v25
    v_sub_f32 v25, v33, v24
    v_fmac_f32 v27, v25, v25
    v_sub_f32 v25, v34, v24
    v_fmac_f32 v27, v25, v25
    v_sub_f32 v25, v35, v24
    v_fmac_f32 v27, v25, v25
    v_sub_f32 v25, v36, v24
    v_fmac_f32 v27, v25, v25
    v_sub_f32 v25, v37, v24
    v_fmac_f32 v27, v25, v25
    v_sub_f32 v25, v38, v24
    v_fmac_f32 v27, v25, v25
    v_sub_f32 v25, v39, v24
    v_fmac_f32 v27, v25, v25
    s_nop 1
    v_add_f32_dpp v27, v27, v27 quad_perm:[1,0,3,2] row_mask:0xf bank_mask:0xf
    s_nop 1
    v_add_f32_dpp v27, v27, v27 quad_perm:[2,3,0,1] row_mask:0xf bank_mask:0xf
    s_nop 1
    v_add_f32_dpp v27, v27, v27 row_half_mirror row_mask:0xf bank_mask:0xf
    s_nop 1
    v_add_f32_dpp v27, v27, v27 row_mirror row_mask:0xf bank_mask:0xf
    v_mov_b32 v25, v27
    v_mov_b32 v26, v27
    s_nop 1
    v_permlane16_swap_b32 v25, v26
    s_nop 1
    v_add_f32 v27, v25, v26
    v_mov_b32 v25, v27
    v_mov_b32 v26, v27
    s_nop 1
    v_permlane32_swap_b32 v25, v26
    s_nop 1
    v_add_f32 v27, v25, v26
    v_mul_f32 v27, 0x3b000000, v27
    v_cvt_pk_bf16_f32 v24, 0, v24
    v_cvt_pk_bf16_f32 v27, 0, v27
    v_add_f32 v27, 0x3727c5ac, v27
    v_cvt_pk_bf16_f32 v27, 0, v27
    v_sqrt_f32 v27, v27
    s_nop 0
    v_cvt_pk_bf16_f32 v27, 0, v27
    v_rcp_f32 v27, v27
    s_nop 0
    v_sub_f32 v80, v32, v24
    v_cvt_pk_bf16_f32 v80, 0, v80
    v_mul_f32 v80, v80, v27
    v_cvt_pk_bf16_f32 v80, 0, v80
    v_sub_f32 v81, v33, v24
    v_cvt_pk_bf16_f32 v81, 0, v81
    v_mul_f32 v81, v81, v27
    v_cvt_pk_bf16_f32 v81, 0, v81
    v_sub_f32 v82, v34, v24
    v_cvt_pk_bf16_f32 v82, 0, v82
    v_mul_f32 v82, v82, v27
    v_cvt_pk_bf16_f32 v82, 0, v82
    v_sub_f32 v83, v35, v24
    v_cvt_pk_bf16_f32 v83, 0, v83
    v_mul_f32 v83, v83, v27
    v_cvt_pk_bf16_f32 v83, 0, v83
    v_sub_f32 v84, v36, v24
    v_cvt_pk_bf16_f32 v84, 0, v84
    v_mul_f32 v84, v84, v27
    v_cvt_pk_bf16_f32 v84, 0, v84
    v_sub_f32 v85, v37, v24
    v_cvt_pk_bf16_f32 v85, 0, v85
    v_mul_f32 v85, v85, v27
    v_cvt_pk_bf16_f32 v85, 0, v85
    v_sub_f32 v86, v38, v24
    v_cvt_pk_bf16_f32 v86, 0, v86
    v_mul_f32 v86, v86, v27
    v_cvt_pk_bf16_f32 v86, 0, v86
    v_sub_f32 v87, v39, v24
    v_cvt_pk_bf16_f32 v87, 0, v87
    v_mul_f32 v87, v87, v27
    v_cvt_pk_bf16_f32 v87, 0, v87
    v_lshlrev_b32 v32, 16, v20
    v_and_b32 v33, 0xffff0000, v20
    v_lshlrev_b32 v34, 16, v21
    v_and_b32 v35, 0xffff0000, v21
    v_lshlrev_b32 v36, 16, v22
    v_and_b32 v37, 0xffff0000, v22
    v_lshlrev_b32 v38, 16, v23
    v_and_b32 v39, 0xffff0000, v23
    v_add_f32 v24, v32, v33
    v_add_f32 v24, v24, v34
    v_add_f32 v24, v24, v35
    v_add_f32 v24, v24, v36
    v_add_f32 v24, v24, v37
    v_add_f32 v24, v24, v38
    v_add_f32 v24, v24, v39
    s_nop 1
    v_add_f32_dpp v24, v24, v24 quad_perm:[1,0,3,2] row_mask:0xf bank_mask:0xf
    s_nop 1
    v_add_f32_dpp v24, v24, v24 quad_perm:[2,3,0,1] row_mask:0xf bank_mask:0xf
    s_nop 1
    v_add_f32_dpp v24, v24, v24 row_half_mirror row_mask:0xf bank_mask:0xf
    s_nop 1
    v_add_f32_dpp v24, v24, v24 row_mirror row_mask:0xf bank_mask:0xf
    v_mov_b32 v25, v24
    v_mov_b32 v26, v24
    s_nop 1
    v_permlane16_swap_b32 v25, v26
    s_nop 1
    v_add_f32 v24, v25, v26
    v_mov_b32 v25, v24
    v_mov_b32 v26, v24
    s_nop 1
    v_permlane32_swap_b32 v25, v26
    s_nop 1
    v_add_f32 v24, v25, v26
    v_mul_f32 v24, 0x3b000000, v24
    v_sub_f32 v25, v32, v24
    v_mul_f32 v27, v25, v25
    v_sub_f32 v25, v33, v24
    v_fmac_f32 v27, v25, v25
    v_sub_f32 v25, v34, v24
    v_fmac_f32 v27, v25, v25
    v_sub_f32 v25, v35, v24
    v_fmac_f32 v27, v25, v25
    v_sub_f32 v25, v36, v24
    v_fmac_f32 v27, v25, v25
    v_sub_f32 v25, v37, v24
    v_fmac_f32 v27, v25, v25
    v_sub_f32 v25, v38, v24
    v_fmac_f32 v27, v25, v25
    v_sub_f32 v25, v39, v24
    v_fmac_f32 v27, v25, v25
    s_nop 1
    v_add_f32_dpp v27, v27, v27 quad_perm:[1,0,3,2] row_mask:0xf bank_mask:0xf
    s_nop 1
    v_add_f32_dpp v27, v27, v27 quad_perm:[2,3,0,1] row_mask:0xf bank_mask:0xf
    s_nop 1
    v_add_f32_dpp v27, v27, v27 row_half_mirror row_mask:0xf bank_mask:0xf
    s_nop 1
    v_add_f32_dpp v27, v27, v27 row_mirror row_mask:0xf bank_mask:0xf
    v_mov_b32 v25, v27
    v_mov_b32 v26, v27
    s_nop 1
    v_permlane16_swap_b32 v25, v26
    s_nop 1
    v_add_f32 v27, v25, v26
    v_mov_b32 v25, v27
    v_mov_b32 v26, v27
    s_nop 1
    v_permlane32_swap_b32 v25, v26
    s_nop 1
    v_add_f32 v27, v25, v26
    v_mul_f32 v27, 0x3b000000, v27
    v_cvt_pk_bf16_f32 v24, 0, v24
    v_cvt_pk_bf16_f32 v27, 0, v27
    v_add_f32 v27, 0x3727c5ac, v27
    v_cvt_pk_bf16_f32 v27, 0, v27
    v_sqrt_f32 v27, v27
    s_nop 0
    v_cvt_pk_bf16_f32 v27, 0, v27
    v_rcp_f32 v27, v27
    s_nop 0
    v_sub_f32 v88, v32, v24
    v_cvt_pk_bf16_f32 v88, 0, v88
    v_mul_f32 v88, v88, v27
    v_cvt_pk_bf16_f32 v88, 0, v88
    v_sub_f32 v89, v33, v24
    v_cvt_pk_bf16_f32 v89, 0, v89
    v_mul_f32 v89, v89, v27
    v_cvt_pk_bf16_f32 v89, 0, v89
    v_sub_f32 v90, v34, v24
    v_cvt_pk_bf16_f32 v90, 0, v90
    v_mul_f32 v90, v90, v27
    v_cvt_pk_bf16_f32 v90, 0, v90
    v_sub_f32 v91, v35, v24
    v_cvt_pk_bf16_f32 v91, 0, v91
    v_mul_f32 v91, v91, v27
    v_cvt_pk_bf16_f32 v91, 0, v91
    v_sub_f32 v92, v36, v24
    v_cvt_pk_bf16_f32 v92, 0, v92
    v_mul_f32 v92, v92, v27
    v_cvt_pk_bf16_f32 v92, 0, v92
    v_sub_f32 v93, v37, v24
    v_cvt_pk_bf16_f32 v93, 0, v93
    v_mul_f32 v93, v93, v27
    v_cvt_pk_bf16_f32 v93, 0, v93
    v_sub_f32 v94, v38, v24
    v_cvt_pk_bf16_f32 v94, 0, v94
    v_mul_f32 v94, v94, v27
    v_cvt_pk_bf16_f32 v94, 0, v94
    v_sub_f32 v95, v39, v24
    v_cvt_pk_bf16_f32 v95, 0, v95
    v_mul_f32 v95, v95, v27
    v_cvt_pk_bf16_f32 v95, 0, v95
    v_mov_b32 v28, 128
    v_lshrrev_b32 v29, 6, v0
    s_nop 0
    v_readfirstlane_b32 s24, v29
    s_nop 3
    s_cmp_lg_u32 s24, 0
    s_cbranch_scc1 Lk0_go

Lk0_poll:
    buffer_load_dword v29, v28, s[32:35], 0 offen sc0 sc1
    s_waitcnt vmcnt(0)
    v_readfirstlane_b32 s24, v29
    s_nop 3
    s_cmp_ge_u32 s24, 16
    s_cbranch_scc1 Lk0_go
    s_sleep 2
    s_branch Lk0_poll

Lk0_go:
    s_barrier
    buffer_load_dwordx4 v[40:43], v5, s[16:19], 0 offen sc1
    buffer_load_dwordx4 v[44:47], v5, s[16:19], 0 offen offset:16 sc1
    buffer_load_dwordx4 v[48:51], v5, s[16:19], 0 offen offset:2048 sc1
    buffer_load_dwordx4 v[52:55], v5, s[16:19], 0 offen offset:2064 sc1
    s_waitcnt vmcnt(0)

    v_add_f32 v48, 1.0, v48
    v_cvt_pk_bf16_f32 v48, 0, v48
    v_add_f32 v49, 1.0, v49
    v_cvt_pk_bf16_f32 v49, 0, v49
    v_add_f32 v50, 1.0, v50
    v_cvt_pk_bf16_f32 v50, 0, v50
    v_add_f32 v51, 1.0, v51
    v_cvt_pk_bf16_f32 v51, 0, v51
    v_add_f32 v52, 1.0, v52
    v_cvt_pk_bf16_f32 v52, 0, v52
    v_add_f32 v53, 1.0, v53
    v_cvt_pk_bf16_f32 v53, 0, v53
    v_add_f32 v54, 1.0, v54
    v_cvt_pk_bf16_f32 v54, 0, v54
    v_add_f32 v55, 1.0, v55
    v_cvt_pk_bf16_f32 v55, 0, v55
    v_mul_f32 v64, v64, v48
    v_cvt_pk_bf16_f32 v64, 0, v64
    v_add_f32 v64, v64, v40
    v_mul_f32 v65, v65, v49
    v_cvt_pk_bf16_f32 v65, 0, v65
    v_add_f32 v65, v65, v41
    v_mul_f32 v66, v66, v50
    v_cvt_pk_bf16_f32 v66, 0, v66
    v_add_f32 v66, v66, v42
    v_mul_f32 v67, v67, v51
    v_cvt_pk_bf16_f32 v67, 0, v67
    v_add_f32 v67, v67, v43
    v_mul_f32 v68, v68, v52
    v_cvt_pk_bf16_f32 v68, 0, v68
    v_add_f32 v68, v68, v44
    v_mul_f32 v69, v69, v53
    v_cvt_pk_bf16_f32 v69, 0, v69
    v_add_f32 v69, v69, v45
    v_mul_f32 v70, v70, v54
    v_cvt_pk_bf16_f32 v70, 0, v70
    v_add_f32 v70, v70, v46
    v_mul_f32 v71, v71, v55
    v_cvt_pk_bf16_f32 v71, 0, v71
    v_add_f32 v71, v71, v47
    v_cvt_pk_bf16_f32 v8, v64, v65
    v_cvt_pk_bf16_f32 v9, v66, v67
    v_cvt_pk_bf16_f32 v10, v68, v69
    v_cvt_pk_bf16_f32 v11, v70, v71
    buffer_store_dwordx4 v[8:11], v6, s[20:23], 0 offen offset:0
    v_mul_f32 v72, v72, v48
    v_cvt_pk_bf16_f32 v72, 0, v72
    v_add_f32 v72, v72, v40
    v_mul_f32 v73, v73, v49
    v_cvt_pk_bf16_f32 v73, 0, v73
    v_add_f32 v73, v73, v41
    v_mul_f32 v74, v74, v50
    v_cvt_pk_bf16_f32 v74, 0, v74
    v_add_f32 v74, v74, v42
    v_mul_f32 v75, v75, v51
    v_cvt_pk_bf16_f32 v75, 0, v75
    v_add_f32 v75, v75, v43
    v_mul_f32 v76, v76, v52
    v_cvt_pk_bf16_f32 v76, 0, v76
    v_add_f32 v76, v76, v44
    v_mul_f32 v77, v77, v53
    v_cvt_pk_bf16_f32 v77, 0, v77
    v_add_f32 v77, v77, v45
    v_mul_f32 v78, v78, v54
    v_cvt_pk_bf16_f32 v78, 0, v78
    v_add_f32 v78, v78, v46
    v_mul_f32 v79, v79, v55
    v_cvt_pk_bf16_f32 v79, 0, v79
    v_add_f32 v79, v79, v47
    v_cvt_pk_bf16_f32 v12, v72, v73
    v_cvt_pk_bf16_f32 v13, v74, v75
    v_cvt_pk_bf16_f32 v14, v76, v77
    v_cvt_pk_bf16_f32 v15, v78, v79
    buffer_store_dwordx4 v[12:15], v6, s[20:23], 0 offen offset:16
    v_mul_f32 v80, v80, v48
    v_cvt_pk_bf16_f32 v80, 0, v80
    v_add_f32 v80, v80, v40
    v_mul_f32 v81, v81, v49
    v_cvt_pk_bf16_f32 v81, 0, v81
    v_add_f32 v81, v81, v41
    v_mul_f32 v82, v82, v50
    v_cvt_pk_bf16_f32 v82, 0, v82
    v_add_f32 v82, v82, v42
    v_mul_f32 v83, v83, v51
    v_cvt_pk_bf16_f32 v83, 0, v83
    v_add_f32 v83, v83, v43
    v_mul_f32 v84, v84, v52
    v_cvt_pk_bf16_f32 v84, 0, v84
    v_add_f32 v84, v84, v44
    v_mul_f32 v85, v85, v53
    v_cvt_pk_bf16_f32 v85, 0, v85
    v_add_f32 v85, v85, v45
    v_mul_f32 v86, v86, v54
    v_cvt_pk_bf16_f32 v86, 0, v86
    v_add_f32 v86, v86, v46
    v_mul_f32 v87, v87, v55
    v_cvt_pk_bf16_f32 v87, 0, v87
    v_add_f32 v87, v87, v47
    v_cvt_pk_bf16_f32 v16, v80, v81
    v_cvt_pk_bf16_f32 v17, v82, v83
    v_cvt_pk_bf16_f32 v18, v84, v85
    v_cvt_pk_bf16_f32 v19, v86, v87
    buffer_store_dwordx4 v[16:19], v6, s[20:23], 0 offen offset:32
    v_mul_f32 v88, v88, v48
    v_cvt_pk_bf16_f32 v88, 0, v88
    v_add_f32 v88, v88, v40
    v_mul_f32 v89, v89, v49
    v_cvt_pk_bf16_f32 v89, 0, v89
    v_add_f32 v89, v89, v41
    v_mul_f32 v90, v90, v50
    v_cvt_pk_bf16_f32 v90, 0, v90
    v_add_f32 v90, v90, v42
    v_mul_f32 v91, v91, v51
    v_cvt_pk_bf16_f32 v91, 0, v91
    v_add_f32 v91, v91, v43
    v_mul_f32 v92, v92, v52
    v_cvt_pk_bf16_f32 v92, 0, v92
    v_add_f32 v92, v92, v44
    v_mul_f32 v93, v93, v53
    v_cvt_pk_bf16_f32 v93, 0, v93
    v_add_f32 v93, v93, v45
    v_mul_f32 v94, v94, v54
    v_cvt_pk_bf16_f32 v94, 0, v94
    v_add_f32 v94, v94, v46
    v_mul_f32 v95, v95, v55
    v_cvt_pk_bf16_f32 v95, 0, v95
    v_add_f32 v95, v95, v47
    v_cvt_pk_bf16_f32 v20, v88, v89
    v_cvt_pk_bf16_f32 v21, v90, v91
    v_cvt_pk_bf16_f32 v22, v92, v93
    v_cvt_pk_bf16_f32 v23, v94, v95
    buffer_store_dwordx4 v[20:23], v6, s[20:23], 0 offen offset:48
Lk0_end:
    s_endpgm
.globl attn_kernel
.p2align 8
.type attn_kernel,@function
attn_kernel:
    s_cmp_ge_u32 s2, 256
    s_cbranch_scc1 Lk2_end
    s_load_dwordx2 s[36:37], s[0:1], 8
    s_load_dwordx2 s[38:39], s[0:1], 16
    s_load_dwordx2 s[40:41], s[0:1], 24
    s_load_dwordx2 s[42:43], s[0:1], 112
    s_load_dwordx2 s[64:65], s[0:1], 32
    s_load_dwordx4 s[68:71], s[0:1], 56
    s_load_dwordx2 s[66:67], s[0:1], 72
    s_and_b32 s3, s2, 7
    s_lshr_b32 s30, s2, 6
    s_lshl_b32 s30, s30, 3
    s_or_b32 s3, s3, s30
    s_lshr_b32 s4, s2, 3
    s_and_b32 s4, s4, 7
    v_lshrrev_b32 v1, 6, v0
    s_nop 0
    v_readfirstlane_b32 s5, v1
    v_and_b32 v0, 63, v0
    s_lshl_b32 s6, s5, 10
    s_mov_b32 s33, 0x3e0293ee
    s_mov_b32 s46, 0x3db504f3
    s_mov_b32 s44, 0x3fb8aa3b

    v_lshlrev_b32 v142, 4, v0
    v_lshrrev_b32 v20, 4, v0
    v_and_b32 v21, 15, v0
    s_lshl_b32 s30, s5, 2
    v_add_u32 v22, s30, v20
    v_and_b32 v22, 15, v22
    v_xor_b32 v22, v22, v21
    v_lshlrev_b32 v22, 4, v22
    v_lshlrev_b32 v23, 8, v20
    v_add_u32 v22, v22, v23
    v_add_u32 v13, s6, v22
    v_lshlrev_b32 v22, 2, v20
    v_xor_b32 v22, v22, v21
    v_lshlrev_b32 v22, 4, v22
    v_add_u32 v14, v22, v23
    v_add_u32 v14, s6, v14
    v_lshlrev_b32 v23, 13, v20
    v_add_u32 v140, v22, v23
    s_lshl_b32 s30, s5, 15
    v_add_u32 v140, s30, v140
    v_and_b32 v20, 31, v0
    v_lshlrev_b32 v20, 8, v20
    v_lshrrev_b32 v22, 5, v0
    v_xor_b32 v23, v22, v21
    v_lshlrev_b32 v23, 4, v23
    v_add_u32 v1, v20, v23

    v_xor_b32 v2, 32, v1
    v_xor_b32 v3, 64, v1
    v_xor_b32 v4, 96, v1
    v_xor_b32 v5, 128, v1
    v_xor_b32 v6, 160, v1
    v_xor_b32 v7, 192, v1
    v_xor_b32 v8, 224, v1
    v_lshrrev_b32 v20, 2, v21
    v_lshrrev_b32 v23, 4, v0
    v_and_b32 v23, 1, v23
    v_lshlrev_b32 v23, 5, v23
    v_and_b32 v21, 3, v0
    v_lshlrev_b32 v21, 3, v21
    v_add_u32 v21, v21, v23
    v_lshlrev_b32 v23, 8, v20
    v_add_u32 v21, v21, v23
    v_lshlrev_b32 v23, 10, v22

    v_xor_b32 v9, 0, v20
    v_lshlrev_b32 v9, 6, v9
    v_add_u32 v9, v9, v21
    v_add_u32 v9, v9, v23
    v_add_u32 v136, v9, v23
    v_add_u32 v9, 0x10000, v9
    v_add_u32 v15, 0x10000, v136
    v_xor_b32 v10, 1, v20
    v_lshlrev_b32 v10, 6, v10
    v_add_u32 v10, v10, v21
    v_add_u32 v10, v10, v23
    v_add_u32 v137, v10, v23
    v_add_u32 v10, 0x10000, v10
    v_add_u32 v16, 0x10000, v137
    v_xor_b32 v11, 2, v20
    v_lshlrev_b32 v11, 6, v11
    v_add_u32 v11, v11, v21
    v_add_u32 v11, v11, v23
    v_add_u32 v138, v11, v23
    v_add_u32 v11, 0x10000, v11
    v_add_u32 v17, 0x10000, v138
    v_xor_b32 v12, 3, v20
    v_lshlrev_b32 v12, 6, v12
    v_add_u32 v12, v12, v21
    v_add_u32 v12, v12, v23
    v_add_u32 v139, v12, v23
    v_add_u32 v12, 0x10000, v12
    v_add_u32 v18, 0x10000, v139
    s_waitcnt lgkmcnt(0)
    s_lshl_b32 s30, s3, 19
    s_add_u32 s8, s36, s30
    s_addc_u32 s9, s37, 0
    s_mov_b32 s10, 0x80000
    s_mov_b32 s11, 0x00020000
    s_add_u32 s12, s38, s30
    s_addc_u32 s13, s39, 0
    s_mov_b32 s14, 0x80000
    s_mov_b32 s15, 0x00020000
    s_lshl_b32 s30, s3, 8
    s_add_u32 s16, s40, s30
    s_addc_u32 s17, s41, 0
    s_sub_u32 s18, 0x400000, s30
    s_mov_b32 s19, 0x00020000

    s_lshl_b32 s76, s2, 3
    s_add_u32 s76, s76, s5
    s_mov_b32 s72, s64
    s_mov_b32 s73, s65
    s_mov_b32 s74, 0x400000
    s_mov_b32 s75, 0x00020000
    s_lshl_b32 s77, s76, 13
    s_cmp_ge_u32 s76, 512
    s_cselect_b32 s72, s68, s72
    s_cselect_b32 s73, s69, s73
    s_cselect_b32 s74, 0x1c0000, s74
    s_cselect_b32 s78, 0x400000, 0
    s_cmp_ge_u32 s76, 736
    s_cselect_b32 s72, s70, s72
    s_cselect_b32 s73, s71, s73
    s_cselect_b32 s78, 0x5c0000, s78
    s_cmp_ge_u32 s76, 960
    s_cselect_b32 s72, s66, s72
    s_cselect_b32 s73, s67, s73
    s_cselect_b32 s78, 0x780000, s78
    s_sub_u32 s77, s77, s78

    s_add_u32 s20, s42, 0x100000
    s_addc_u32 s21, s43, 0
    s_mov_b32 s22, 0x200000
    s_mov_b32 s23, 0x00020000
    s_add_u32 s24, s42, 0x400000
    s_addc_u32 s25, s43, 0
    s_mov_b32 s26, 0x1000000
    s_mov_b32 s27, 0x00020000
    s_mov_b32 s31, 0
    s_lshl_b32 s34, s4, 3
    s_add_u32 s34, s34, s5
    s_lshl_b32 s34, s34, 15

    s_add_u32 m0, s6, 0
    s_nop 0
    buffer_load_dwordx4 v140, s[16:19], s31 offen lds
    s_add_u32 m0, s6, 8192
    s_add_u32 s30, s31, 262144
    buffer_load_dwordx4 v140, s[16:19], s30 offen lds
    s_add_u32 s31, s31, 524288
    buffer_load_dwordx4 a[32:35], v142, s[20:23], s34 offen offset:0
    buffer_load_dwordx4 a[36:39], v142, s[20:23], s34 offen offset:1024
    buffer_load_dwordx4 a[40:43], v142, s[20:23], s34 offen offset:2048
    buffer_load_dwordx4 a[44:47], v142, s[20:23], s34 offen offset:3072
    s_add_u32 s34, s34, 4096
    s_add_u32 m0, s6, 16384
    s_nop 0
    buffer_load_dwordx4 v140, s[16:19], s31 offen lds
    s_add_u32 m0, s6, 24576
    s_add_u32 s30, s31, 262144
    buffer_load_dwordx4 v140, s[16:19], s30 offen lds
    s_add_u32 s31, s31, 524288
    buffer_load_dwordx4 a[48:51], v142, s[20:23], s34 offen offset:0
    buffer_load_dwordx4 a[52:55], v142, s[20:23], s34 offen offset:1024
    buffer_load_dwordx4 a[56:59], v142, s[20:23], s34 offen offset:2048
    buffer_load_dwordx4 a[60:63], v142, s[20:23], s34 offen offset:3072
    s_add_u32 s34, s34, 4096
    s_add_u32 m0, s6, 32768
    s_nop 0
    buffer_load_dwordx4 v140, s[16:19], s31 offen lds
    s_add_u32 m0, s6, 40960
    s_add_u32 s30, s31, 262144
    buffer_load_dwordx4 v140, s[16:19], s30 offen lds
    s_add_u32 s31, s31, 524288
    buffer_load_dwordx4 a[64:67], v142, s[20:23], s34 offen offset:0
    buffer_load_dwordx4 a[68:71], v142, s[20:23], s34 offen offset:1024
    buffer_load_dwordx4 a[72:75], v142, s[20:23], s34 offen offset:2048
    buffer_load_dwordx4 a[76:79], v142, s[20:23], s34 offen offset:3072
    s_add_u32 s34, s34, 4096
    s_mov_b32 s28, 0
    s_mov_b32 s29, 0
    s_waitcnt vmcnt(6)
    s_barrier
    ds_read_b64_tr_b16 v[24:25], v136 offset:0
    ds_read_b64_tr_b16 v[26:27], v136 offset:1024
    ds_read_b64_tr_b16 v[28:29], v137 offset:0
    ds_read_b64_tr_b16 v[30:31], v137 offset:1024
    ds_read_b64_tr_b16 v[32:33], v138 offset:0
    ds_read_b64_tr_b16 v[34:35], v138 offset:1024
    ds_read_b64_tr_b16 v[36:37], v139 offset:0
    ds_read_b64_tr_b16 v[38:39], v139 offset:1024
    ds_read_b64_tr_b16 v[40:41], v136 offset:4096
    ds_read_b64_tr_b16 v[42:43], v136 offset:5120
    ds_read_b64_tr_b16 v[44:45], v137 offset:4096
    ds_read_b64_tr_b16 v[46:47], v137 offset:5120
    ds_read_b64_tr_b16 v[48:49], v138 offset:4096
    ds_read_b64_tr_b16 v[50:51], v138 offset:5120
    ds_read_b64_tr_b16 v[52:53], v139 offset:4096
    ds_read_b64_tr_b16 v[54:55], v139 offset:5120
    s_waitcnt lgkmcnt(14)
    v_mfma_f32_32x32x16_bf16 v[72:87], v[24:27], a[32:35], 0
    ds_read_b64_tr_b16 v[24:25], v136 offset:8192
    ds_read_b64_tr_b16 v[26:27], v136 offset:9216
    s_waitcnt lgkmcnt(14)
    v_mfma_f32_32x32x16_bf16 v[88:103], v[28:31], a[32:35], 0
    ds_read_b64_tr_b16 v[28:29], v137 offset:8192
    ds_read_b64_tr_b16 v[30:31], v137 offset:9216
    s_waitcnt lgkmcnt(14)
    v_mfma_f32_32x32x16_bf16 v[104:119], v[32:35], a[32:35], 0
    ds_read_b64_tr_b16 v[32:33], v138 offset:8192
    ds_read_b64_tr_b16 v[34:35], v138 offset:9216
    s_add_u32 m0, s6, 65536
    s_nop 0
    buffer_load_dwordx4 v140, s[16:19], s31 offen lds
    s_waitcnt lgkmcnt(14)
    v_mfma_f32_32x32x16_bf16 v[120:135], v[36:39], a[32:35], 0
    ds_read_b64_tr_b16 v[36:37], v139 offset:8192
    ds_read_b64_tr_b16 v[38:39], v139 offset:9216
    s_waitcnt lgkmcnt(14)
    v_mfma_f32_32x32x16_bf16 v[72:87], v[40:43], a[36:39], v[72:87]
    ds_read_b64_tr_b16 v[40:41], v136 offset:12288
    ds_read_b64_tr_b16 v[42:43], v136 offset:13312
    s_add_u32 m0, s6, 73728
    s_add_u32 s30, s31, 262144
    buffer_load_dwordx4 v140, s[16:19], s30 offen lds
    s_add_u32 s31, s31, 524288
    s_waitcnt lgkmcnt(14)
    v_mfma_f32_32x32x16_bf16 v[88:103], v[44:47], a[36:39], v[88:103]
    ds_read_b64_tr_b16 v[44:45], v137 offset:12288
    ds_read_b64_tr_b16 v[46:47], v137 offset:13312
    s_waitcnt lgkmcnt(14)
    v_mfma_f32_32x32x16_bf16 v[104:119], v[48:51], a[36:39], v[104:119]
    ds_read_b64_tr_b16 v[48:49], v138 offset:12288
    ds_read_b64_tr_b16 v[50:51], v138 offset:13312
    buffer_load_dwordx4 a[80:83], v142, s[20:23], s34 offen offset:0
    s_waitcnt lgkmcnt(14)
    v_mfma_f32_32x32x16_bf16 v[120:135], v[52:55], a[36:39], v[120:135]
    ds_read_b64_tr_b16 v[52:53], v139 offset:12288
    ds_read_b64_tr_b16 v[54:55], v139 offset:13312
    s_waitcnt lgkmcnt(14)
    v_mfma_f32_32x32x16_bf16 v[72:87], v[24:27], a[40:43], v[72:87]
    ds_read_b64_tr_b16 v[24:25], v136 offset:16384
    ds_read_b64_tr_b16 v[26:27], v136 offset:17408
    buffer_load_dwordx4 a[84:87], v142, s[20:23], s34 offen offset:1024
    s_waitcnt lgkmcnt(14)
    v_mfma_f32_32x32x16_bf16 v[88:103], v[28:31], a[40:43], v[88:103]
    ds_read_b64_tr_b16 v[28:29], v137 offset:16384
    ds_read_b64_tr_b16 v[30:31], v137 offset:17408
    s_waitcnt lgkmcnt(14)
    v_mfma_f32_32x32x16_bf16 v[104:119], v[32:35], a[40:43], v[104:119]
    ds_read_b64_tr_b16 v[32:33], v138 offset:16384
    ds_read_b64_tr_b16 v[34:35], v138 offset:17408
    buffer_load_dwordx4 a[88:91], v142, s[20:23], s34 offen offset:2048
    s_waitcnt lgkmcnt(14)
    v_mfma_f32_32x32x16_bf16 v[120:135], v[36:39], a[40:43], v[120:135]
    ds_read_b64_tr_b16 v[36:37], v139 offset:16384
    ds_read_b64_tr_b16 v[38:39], v139 offset:17408
    s_waitcnt lgkmcnt(14)
    v_mfma_f32_32x32x16_bf16 v[72:87], v[40:43], a[44:47], v[72:87]
    ds_read_b64_tr_b16 v[40:41], v136 offset:20480
    ds_read_b64_tr_b16 v[42:43], v136 offset:21504
    buffer_load_dwordx4 a[92:95], v142, s[20:23], s34 offen offset:3072
    s_add_u32 s34, s34, 4096
    s_waitcnt lgkmcnt(14)
    v_mfma_f32_32x32x16_bf16 v[88:103], v[44:47], a[44:47], v[88:103]
    ds_read_b64_tr_b16 v[44:45], v137 offset:20480
    ds_read_b64_tr_b16 v[46:47], v137 offset:21504
    s_waitcnt lgkmcnt(14)
    v_mfma_f32_32x32x16_bf16 v[104:119], v[48:51], a[44:47], v[104:119]
    ds_read_b64_tr_b16 v[48:49], v138 offset:20480
    ds_read_b64_tr_b16 v[50:51], v138 offset:21504
    s_waitcnt lgkmcnt(14)
    v_mfma_f32_32x32x16_bf16 v[120:135], v[52:55], a[44:47], v[120:135]
    ds_read_b64_tr_b16 v[52:53], v139 offset:20480
    ds_read_b64_tr_b16 v[54:55], v139 offset:21504
    s_waitcnt vmcnt(6)
    s_barrier
    s_waitcnt lgkmcnt(14)
    v_mfma_f32_32x32x16_bf16 v[72:87], v[24:27], a[48:51], v[72:87]
    ds_read_b64_tr_b16 v[24:25], v136 offset:24576
    ds_read_b64_tr_b16 v[26:27], v136 offset:25600
    s_add_u32 m0, s6, 0
    s_nop 0
    buffer_load_dwordx4 v13, s[8:11], s28 offen lds
    s_waitcnt lgkmcnt(14)
    v_mfma_f32_32x32x16_bf16 v[88:103], v[28:31], a[48:51], v[88:103]
    ds_read_b64_tr_b16 v[28:29], v137 offset:24576
    ds_read_b64_tr_b16 v[30:31], v137 offset:25600
    s_add_u32 m0, s6, 8192
    s_add_u32 s30, s28, 8192
    buffer_load_dwordx4 v13, s[8:11], s30 offen lds
    s_add_u32 s28, s28, 16384
    s_waitcnt lgkmcnt(14)
    v_mfma_f32_32x32x16_bf16 v[104:119], v[32:35], a[48:51], v[104:119]
    ds_read_b64_tr_b16 v[32:33], v138 offset:24576
    ds_read_b64_tr_b16 v[34:35], v138 offset:25600
    s_add_u32 m0, s6, 81920
    s_nop 0
    buffer_load_dwordx4 v140, s[16:19], s31 offen lds
    s_waitcnt lgkmcnt(14)
    v_mfma_f32_32x32x16_bf16 v[120:135], v[36:39], a[48:51], v[120:135]
    ds_read_b64_tr_b16 v[36:37], v139 offset:24576
    ds_read_b64_tr_b16 v[38:39], v139 offset:25600
    s_waitcnt lgkmcnt(14)
    v_mfma_f32_32x32x16_bf16 v[72:87], v[40:43], a[52:55], v[72:87]
    ds_read_b64_tr_b16 v[40:41], v136 offset:28672
    ds_read_b64_tr_b16 v[42:43], v136 offset:29696
    s_add_u32 m0, s6, 90112
    s_add_u32 s30, s31, 262144
    buffer_load_dwordx4 v140, s[16:19], s30 offen lds
    s_add_u32 s31, s31, 524288
    s_waitcnt lgkmcnt(14)
    v_mfma_f32_32x32x16_bf16 v[88:103], v[44:47], a[52:55], v[88:103]
    ds_read_b64_tr_b16 v[44:45], v137 offset:28672
    ds_read_b64_tr_b16 v[46:47], v137 offset:29696
    s_waitcnt lgkmcnt(14)
    v_mfma_f32_32x32x16_bf16 v[104:119], v[48:51], a[52:55], v[104:119]
    ds_read_b64_tr_b16 v[48:49], v138 offset:28672
    ds_read_b64_tr_b16 v[50:51], v138 offset:29696
    buffer_load_dwordx4 a[0:3], v142, s[20:23], s34 offen offset:0
    s_waitcnt lgkmcnt(14)
    v_mfma_f32_32x32x16_bf16 v[120:135], v[52:55], a[52:55], v[120:135]
    ds_read_b64_tr_b16 v[52:53], v139 offset:28672
    ds_read_b64_tr_b16 v[54:55], v139 offset:29696
    s_waitcnt lgkmcnt(14)
    v_mfma_f32_32x32x16_bf16 v[72:87], v[24:27], a[56:59], v[72:87]
    ds_read_b64_tr_b16 v[24:25], v136 offset:32768
    ds_read_b64_tr_b16 v[26:27], v136 offset:33792
    buffer_load_dwordx4 a[4:7], v142, s[20:23], s34 offen offset:1024
    s_waitcnt lgkmcnt(14)
    v_mfma_f32_32x32x16_bf16 v[88:103], v[28:31], a[56:59], v[88:103]
    ds_read_b64_tr_b16 v[28:29], v137 offset:32768
    ds_read_b64_tr_b16 v[30:31], v137 offset:33792
    s_waitcnt lgkmcnt(14)
    v_mfma_f32_32x32x16_bf16 v[104:119], v[32:35], a[56:59], v[104:119]
    ds_read_b64_tr_b16 v[32:33], v138 offset:32768
    ds_read_b64_tr_b16 v[34:35], v138 offset:33792
    buffer_load_dwordx4 a[8:11], v142, s[20:23], s34 offen offset:2048
    s_waitcnt lgkmcnt(14)
    v_mfma_f32_32x32x16_bf16 v[120:135], v[36:39], a[56:59], v[120:135]
    ds_read_b64_tr_b16 v[36:37], v139 offset:32768
    ds_read_b64_tr_b16 v[38:39], v139 offset:33792
    s_waitcnt lgkmcnt(14)
    v_mfma_f32_32x32x16_bf16 v[72:87], v[40:43], a[60:63], v[72:87]
    ds_read_b64_tr_b16 v[40:41], v136 offset:36864
    ds_read_b64_tr_b16 v[42:43], v136 offset:37888
    buffer_load_dwordx4 a[12:15], v142, s[20:23], s34 offen offset:3072
    s_add_u32 s34, s34, 4096
    s_waitcnt lgkmcnt(14)
    v_mfma_f32_32x32x16_bf16 v[88:103], v[44:47], a[60:63], v[88:103]
    ds_read_b64_tr_b16 v[44:45], v137 offset:36864
    ds_read_b64_tr_b16 v[46:47], v137 offset:37888
    s_waitcnt lgkmcnt(14)
    v_mfma_f32_32x32x16_bf16 v[104:119], v[48:51], a[60:63], v[104:119]
    ds_read_b64_tr_b16 v[48:49], v138 offset:36864
    ds_read_b64_tr_b16 v[50:51], v138 offset:37888
    s_waitcnt lgkmcnt(14)
    v_mfma_f32_32x32x16_bf16 v[120:135], v[52:55], a[60:63], v[120:135]
    ds_read_b64_tr_b16 v[52:53], v139 offset:36864
    ds_read_b64_tr_b16 v[54:55], v139 offset:37888
    s_waitcnt vmcnt(8)
    s_barrier
    s_waitcnt lgkmcnt(14)
    v_mfma_f32_32x32x16_bf16 v[72:87], v[24:27], a[64:67], v[72:87]
    ds_read_b64_tr_b16 v[24:25], v136 offset:40960
    ds_read_b64_tr_b16 v[26:27], v136 offset:41984
    s_add_u32 m0, s6, 16384
    s_nop 0
    buffer_load_dwordx4 v13, s[8:11], s28 offen lds
    s_waitcnt lgkmcnt(14)
    v_mfma_f32_32x32x16_bf16 v[88:103], v[28:31], a[64:67], v[88:103]
    ds_read_b64_tr_b16 v[28:29], v137 offset:40960
    ds_read_b64_tr_b16 v[30:31], v137 offset:41984
    s_add_u32 m0, s6, 24576
    s_add_u32 s30, s28, 8192
    buffer_load_dwordx4 v13, s[8:11], s30 offen lds
    s_add_u32 s28, s28, 16384
    s_waitcnt lgkmcnt(14)
    v_mfma_f32_32x32x16_bf16 v[104:119], v[32:35], a[64:67], v[104:119]
    ds_read_b64_tr_b16 v[32:33], v138 offset:40960
    ds_read_b64_tr_b16 v[34:35], v138 offset:41984
    s_add_u32 m0, s6, 49152
    s_nop 0
    buffer_load_dwordx4 v140, s[16:19], s31 offen lds
    s_waitcnt lgkmcnt(14)
    v_mfma_f32_32x32x16_bf16 v[120:135], v[36:39], a[64:67], v[120:135]
    ds_read_b64_tr_b16 v[36:37], v139 offset:40960
    ds_read_b64_tr_b16 v[38:39], v139 offset:41984
    s_waitcnt lgkmcnt(14)
    v_mfma_f32_32x32x16_bf16 v[72:87], v[40:43], a[68:71], v[72:87]
    ds_read_b64_tr_b16 v[40:41], v136 offset:45056
    ds_read_b64_tr_b16 v[42:43], v136 offset:46080
    s_add_u32 m0, s6, 57344
    s_add_u32 s30, s31, 262144
    buffer_load_dwordx4 v140, s[16:19], s30 offen lds
    s_add_u32 s31, s31, 524288
    s_waitcnt lgkmcnt(14)
    v_mfma_f32_32x32x16_bf16 v[88:103], v[44:47], a[68:71], v[88:103]
    ds_read_b64_tr_b16 v[44:45], v137 offset:45056
    ds_read_b64_tr_b16 v[46:47], v137 offset:46080
    s_waitcnt lgkmcnt(14)
    v_mfma_f32_32x32x16_bf16 v[104:119], v[48:51], a[68:71], v[104:119]
    ds_read_b64_tr_b16 v[48:49], v138 offset:45056
    ds_read_b64_tr_b16 v[50:51], v138 offset:46080
    buffer_load_dwordx4 a[16:19], v142, s[20:23], s34 offen offset:0
    s_waitcnt lgkmcnt(14)
    v_mfma_f32_32x32x16_bf16 v[120:135], v[52:55], a[68:71], v[120:135]
    ds_read_b64_tr_b16 v[52:53], v139 offset:45056
    ds_read_b64_tr_b16 v[54:55], v139 offset:46080
    s_waitcnt lgkmcnt(14)
    v_mfma_f32_32x32x16_bf16 v[72:87], v[24:27], a[72:75], v[72:87]
    ds_read_b64_tr_b16 v[24:25], v15 offset:0
    ds_read_b64_tr_b16 v[26:27], v15 offset:1024
    buffer_load_dwordx4 a[20:23], v142, s[20:23], s34 offen offset:1024
    s_waitcnt lgkmcnt(14)
    v_mfma_f32_32x32x16_bf16 v[88:103], v[28:31], a[72:75], v[88:103]
    ds_read_b64_tr_b16 v[28:29], v16 offset:0
    ds_read_b64_tr_b16 v[30:31], v16 offset:1024
    s_waitcnt lgkmcnt(14)
    v_mfma_f32_32x32x16_bf16 v[104:119], v[32:35], a[72:75], v[104:119]
    ds_read_b64_tr_b16 v[32:33], v17 offset:0
    ds_read_b64_tr_b16 v[34:35], v17 offset:1024
    buffer_load_dwordx4 a[24:27], v142, s[20:23], s34 offen offset:2048
    s_waitcnt lgkmcnt(14)
    v_mfma_f32_32x32x16_bf16 v[120:135], v[36:39], a[72:75], v[120:135]
    ds_read_b64_tr_b16 v[36:37], v18 offset:0
    ds_read_b64_tr_b16 v[38:39], v18 offset:1024
    s_waitcnt lgkmcnt(14)
    v_mfma_f32_32x32x16_bf16 v[72:87], v[40:43], a[76:79], v[72:87]
    ds_read_b64_tr_b16 v[40:41], v15 offset:4096
    ds_read_b64_tr_b16 v[42:43], v15 offset:5120
    buffer_load_dwordx4 a[28:31], v142, s[20:23], s34 offen offset:3072
    s_add_u32 s34, s34, 4096
    s_waitcnt lgkmcnt(14)
    v_mfma_f32_32x32x16_bf16 v[88:103], v[44:47], a[76:79], v[88:103]
    ds_read_b64_tr_b16 v[44:45], v16 offset:4096
    ds_read_b64_tr_b16 v[46:47], v16 offset:5120
    s_waitcnt lgkmcnt(14)
    v_mfma_f32_32x32x16_bf16 v[104:119], v[48:51], a[76:79], v[104:119]
    ds_read_b64_tr_b16 v[48:49], v17 offset:4096
    ds_read_b64_tr_b16 v[50:51], v17 offset:5120
    s_waitcnt lgkmcnt(14)
    v_mfma_f32_32x32x16_bf16 v[120:135], v[52:55], a[76:79], v[120:135]
    ds_read_b64_tr_b16 v[52:53], v18 offset:4096
    ds_read_b64_tr_b16 v[54:55], v18 offset:5120
    s_waitcnt vmcnt(8)
    s_barrier
    s_waitcnt lgkmcnt(14)
    v_mfma_f32_32x32x16_bf16 v[72:87], v[24:27], a[80:83], v[72:87]
    ds_read_b64_tr_b16 v[24:25], v15 offset:8192
    ds_read_b64_tr_b16 v[26:27], v15 offset:9216
    s_add_u32 m0, s6, 32768
    s_nop 0
    buffer_load_dwordx4 v13, s[8:11], s28 offen lds
    s_waitcnt lgkmcnt(14)
    v_mfma_f32_32x32x16_bf16 v[88:103], v[28:31], a[80:83], v[88:103]
    ds_read_b64_tr_b16 v[28:29], v16 offset:8192
    ds_read_b64_tr_b16 v[30:31], v16 offset:9216
    s_add_u32 m0, s6, 40960
    s_add_u32 s30, s28, 8192
    buffer_load_dwordx4 v13, s[8:11], s30 offen lds
    s_add_u32 s28, s28, 16384
    s_waitcnt lgkmcnt(14)
    v_mfma_f32_32x32x16_bf16 v[104:119], v[32:35], a[80:83], v[104:119]
    ds_read_b64_tr_b16 v[32:33], v17 offset:8192
    ds_read_b64_tr_b16 v[34:35], v17 offset:9216
    s_add_u32 m0, s6, 98304
    s_nop 0
    buffer_load_dwordx4 v140, s[16:19], s31 offen lds
    s_waitcnt lgkmcnt(14)
    v_mfma_f32_32x32x16_bf16 v[120:135], v[36:39], a[80:83], v[120:135]
    ds_read_b64_tr_b16 v[36:37], v18 offset:8192
    ds_read_b64_tr_b16 v[38:39], v18 offset:9216
    s_waitcnt lgkmcnt(14)
    v_mfma_f32_32x32x16_bf16 v[72:87], v[40:43], a[84:87], v[72:87]
    ds_read_b64_tr_b16 v[40:41], v15 offset:12288
    ds_read_b64_tr_b16 v[42:43], v15 offset:13312
    s_add_u32 m0, s6, 106496
    s_add_u32 s30, s31, 262144
    buffer_load_dwordx4 v140, s[16:19], s30 offen lds
    s_add_u32 s31, s31, 524288
    s_waitcnt lgkmcnt(14)
    v_mfma_f32_32x32x16_bf16 v[88:103], v[44:47], a[84:87], v[88:103]
    ds_read_b64_tr_b16 v[44:45], v16 offset:12288
    ds_read_b64_tr_b16 v[46:47], v16 offset:13312
    s_waitcnt lgkmcnt(14)
    v_mfma_f32_32x32x16_bf16 v[104:119], v[48:51], a[84:87], v[104:119]
    ds_read_b64_tr_b16 v[48:49], v17 offset:12288
    ds_read_b64_tr_b16 v[50:51], v17 offset:13312
    buffer_load_dwordx4 v[56:59], v142, s[20:23], s34 offen offset:0
    s_waitcnt lgkmcnt(14)
    v_mfma_f32_32x32x16_bf16 v[120:135], v[52:55], a[84:87], v[120:135]
    ds_read_b64_tr_b16 v[52:53], v18 offset:12288
    ds_read_b64_tr_b16 v[54:55], v18 offset:13312
    s_waitcnt lgkmcnt(14)
    v_mfma_f32_32x32x16_bf16 v[72:87], v[24:27], a[88:91], v[72:87]
    ds_read_b64_tr_b16 v[24:25], v15 offset:16384
    ds_read_b64_tr_b16 v[26:27], v15 offset:17408
    buffer_load_dwordx4 v[60:63], v142, s[20:23], s34 offen offset:1024
    s_waitcnt lgkmcnt(14)
    v_mfma_f32_32x32x16_bf16 v[88:103], v[28:31], a[88:91], v[88:103]
    ds_read_b64_tr_b16 v[28:29], v16 offset:16384
    ds_read_b64_tr_b16 v[30:31], v16 offset:17408
    s_waitcnt lgkmcnt(14)
    v_mfma_f32_32x32x16_bf16 v[104:119], v[32:35], a[88:91], v[104:119]
    ds_read_b64_tr_b16 v[32:33], v17 offset:16384
    ds_read_b64_tr_b16 v[34:35], v17 offset:17408
    buffer_load_dwordx4 v[64:67], v142, s[20:23], s34 offen offset:2048
    s_waitcnt lgkmcnt(14)
    v_mfma_f32_32x32x16_bf16 v[120:135], v[36:39], a[88:91], v[120:135]
    ds_read_b64_tr_b16 v[36:37], v18 offset:16384
    ds_read_b64_tr_b16 v[38:39], v18 offset:17408
    s_waitcnt lgkmcnt(14)
    v_mfma_f32_32x32x16_bf16 v[72:87], v[40:43], a[92:95], v[72:87]
    ds_read_b64_tr_b16 v[40:41], v15 offset:20480
    ds_read_b64_tr_b16 v[42:43], v15 offset:21504
    buffer_load_dwordx4 v[68:71], v142, s[20:23], s34 offen offset:3072
    s_add_u32 s34, s34, 4096
    s_waitcnt lgkmcnt(14)
    v_mfma_f32_32x32x16_bf16 v[88:103], v[44:47], a[92:95], v[88:103]
    ds_read_b64_tr_b16 v[44:45], v16 offset:20480
    ds_read_b64_tr_b16 v[46:47], v16 offset:21504
    s_waitcnt lgkmcnt(14)
    v_mfma_f32_32x32x16_bf16 v[104:119], v[48:51], a[92:95], v[104:119]
    ds_read_b64_tr_b16 v[48:49], v17 offset:20480
    ds_read_b64_tr_b16 v[50:51], v17 offset:21504
    s_waitcnt lgkmcnt(14)
    v_mfma_f32_32x32x16_bf16 v[120:135], v[52:55], a[92:95], v[120:135]
    ds_read_b64_tr_b16 v[52:53], v18 offset:20480
    ds_read_b64_tr_b16 v[54:55], v18 offset:21504
    s_waitcnt vmcnt(8)
    s_barrier
    s_waitcnt lgkmcnt(14)
    v_mfma_f32_32x32x16_bf16 v[72:87], v[24:27], a[0:3], v[72:87]
    ds_read_b64_tr_b16 v[24:25], v15 offset:24576
    ds_read_b64_tr_b16 v[26:27], v15 offset:25600
    s_add_u32 m0, s6, 65536
    s_nop 0
    buffer_load_dwordx4 v14, s[12:15], s29 offen lds
    s_waitcnt lgkmcnt(14)
    v_mfma_f32_32x32x16_bf16 v[88:103], v[28:31], a[0:3], v[88:103]
    ds_read_b64_tr_b16 v[28:29], v16 offset:24576
    ds_read_b64_tr_b16 v[30:31], v16 offset:25600
    s_add_u32 m0, s6, 73728
    s_add_u32 s30, s29, 8192
    buffer_load_dwordx4 v14, s[12:15], s30 offen lds
    s_add_u32 s29, s29, 16384
    s_waitcnt lgkmcnt(14)
    v_mfma_f32_32x32x16_bf16 v[104:119], v[32:35], a[0:3], v[104:119]
    ds_read_b64_tr_b16 v[32:33], v17 offset:24576
    ds_read_b64_tr_b16 v[34:35], v17 offset:25600
    s_add_u32 m0, s6, 114688
    s_nop 0
    buffer_load_dwordx4 v140, s[16:19], s31 offen lds
    s_waitcnt lgkmcnt(14)
    v_mfma_f32_32x32x16_bf16 v[120:135], v[36:39], a[0:3], v[120:135]
    ds_read_b64_tr_b16 v[36:37], v18 offset:24576
    ds_read_b64_tr_b16 v[38:39], v18 offset:25600
    s_waitcnt lgkmcnt(14)
    v_mfma_f32_32x32x16_bf16 v[72:87], v[40:43], a[4:7], v[72:87]
    ds_read_b64_tr_b16 v[40:41], v15 offset:28672
    ds_read_b64_tr_b16 v[42:43], v15 offset:29696
    s_add_u32 m0, s6, 122880
    s_add_u32 s30, s31, 262144
    buffer_load_dwordx4 v140, s[16:19], s30 offen lds
    s_add_u32 s31, s31, 524288
    s_waitcnt lgkmcnt(14)
    v_mfma_f32_32x32x16_bf16 v[88:103], v[44:47], a[4:7], v[88:103]
    ds_read_b64_tr_b16 v[44:45], v16 offset:28672
    ds_read_b64_tr_b16 v[46:47], v16 offset:29696
    s_waitcnt lgkmcnt(14)
    v_mfma_f32_32x32x16_bf16 v[104:119], v[48:51], a[4:7], v[104:119]
    ds_read_b64_tr_b16 v[48:49], v17 offset:28672
    ds_read_b64_tr_b16 v[50:51], v17 offset:29696
    buffer_load_dwordx4 v[144:147], v142, s[20:23], s34 offen offset:0
    s_waitcnt lgkmcnt(14)
    v_mfma_f32_32x32x16_bf16 v[120:135], v[52:55], a[4:7], v[120:135]
    ds_read_b64_tr_b16 v[52:53], v18 offset:28672
    ds_read_b64_tr_b16 v[54:55], v18 offset:29696
    s_waitcnt lgkmcnt(14)
    v_mfma_f32_32x32x16_bf16 v[72:87], v[24:27], a[8:11], v[72:87]
    ds_read_b64_tr_b16 v[24:25], v136 offset:49152
    ds_read_b64_tr_b16 v[26:27], v136 offset:50176
    buffer_load_dwordx4 v[148:151], v142, s[20:23], s34 offen offset:1024
    s_waitcnt lgkmcnt(14)
    v_mfma_f32_32x32x16_bf16 v[88:103], v[28:31], a[8:11], v[88:103]
    ds_read_b64_tr_b16 v[28:29], v137 offset:49152
    ds_read_b64_tr_b16 v[30:31], v137 offset:50176
    s_waitcnt lgkmcnt(14)
    v_mfma_f32_32x32x16_bf16 v[104:119], v[32:35], a[8:11], v[104:119]
    ds_read_b64_tr_b16 v[32:33], v138 offset:49152
    ds_read_b64_tr_b16 v[34:35], v138 offset:50176
    buffer_load_dwordx4 v[152:155], v142, s[20:23], s34 offen offset:2048
    s_waitcnt lgkmcnt(14)
    v_mfma_f32_32x32x16_bf16 v[120:135], v[36:39], a[8:11], v[120:135]
    ds_read_b64_tr_b16 v[36:37], v139 offset:49152
    ds_read_b64_tr_b16 v[38:39], v139 offset:50176
    s_waitcnt lgkmcnt(14)
    v_mfma_f32_32x32x16_bf16 v[72:87], v[40:43], a[12:15], v[72:87]
    ds_read_b64_tr_b16 v[40:41], v136 offset:53248
    ds_read_b64_tr_b16 v[42:43], v136 offset:54272
    buffer_load_dwordx4 v[156:159], v142, s[20:23], s34 offen offset:3072
    s_add_u32 s34, s34, 4096
    s_waitcnt lgkmcnt(14)
    v_mfma_f32_32x32x16_bf16 v[88:103], v[44:47], a[12:15], v[88:103]
    ds_read_b64_tr_b16 v[44:45], v137 offset:53248
    ds_read_b64_tr_b16 v[46:47], v137 offset:54272
    s_waitcnt lgkmcnt(14)
    v_mfma_f32_32x32x16_bf16 v[104:119], v[48:51], a[12:15], v[104:119]
    ds_read_b64_tr_b16 v[48:49], v138 offset:53248
    ds_read_b64_tr_b16 v[50:51], v138 offset:54272
    s_waitcnt lgkmcnt(14)
    v_mfma_f32_32x32x16_bf16 v[120:135], v[52:55], a[12:15], v[120:135]
    ds_read_b64_tr_b16 v[52:53], v139 offset:53248
    ds_read_b64_tr_b16 v[54:55], v139 offset:54272
    s_waitcnt vmcnt(8)
    s_barrier
    s_waitcnt lgkmcnt(14)
    v_mfma_f32_32x32x16_bf16 v[72:87], v[24:27], a[16:19], v[72:87]
    ds_read_b64_tr_b16 v[24:25], v136 offset:57344
    ds_read_b64_tr_b16 v[26:27], v136 offset:58368
    s_add_u32 m0, s6, 81920
    s_nop 0
    buffer_load_dwordx4 v14, s[12:15], s29 offen lds
    s_waitcnt lgkmcnt(14)
    v_mfma_f32_32x32x16_bf16 v[88:103], v[28:31], a[16:19], v[88:103]
    ds_read_b64_tr_b16 v[28:29], v137 offset:57344
    ds_read_b64_tr_b16 v[30:31], v137 offset:58368
    s_add_u32 m0, s6, 90112
    s_add_u32 s30, s29, 8192
    buffer_load_dwordx4 v14, s[12:15], s30 offen lds
    s_add_u32 s29, s29, 16384
    s_waitcnt lgkmcnt(14)
    v_mfma_f32_32x32x16_bf16 v[104:119], v[32:35], a[16:19], v[104:119]
    ds_read_b64_tr_b16 v[32:33], v138 offset:57344
    ds_read_b64_tr_b16 v[34:35], v138 offset:58368
    s_waitcnt lgkmcnt(14)
    v_mfma_f32_32x32x16_bf16 v[120:135], v[36:39], a[16:19], v[120:135]
    ds_read_b64_tr_b16 v[36:37], v139 offset:57344
    ds_read_b64_tr_b16 v[38:39], v139 offset:58368
    s_waitcnt lgkmcnt(14)
    v_mfma_f32_32x32x16_bf16 v[72:87], v[40:43], a[20:23], v[72:87]
    ds_read_b64_tr_b16 v[40:41], v136 offset:61440
    ds_read_b64_tr_b16 v[42:43], v136 offset:62464
    s_waitcnt lgkmcnt(14)
    v_mfma_f32_32x32x16_bf16 v[88:103], v[44:47], a[20:23], v[88:103]
    ds_read_b64_tr_b16 v[44:45], v137 offset:61440
    ds_read_b64_tr_b16 v[46:47], v137 offset:62464
    s_waitcnt lgkmcnt(14)
    v_mfma_f32_32x32x16_bf16 v[104:119], v[48:51], a[20:23], v[104:119]
    ds_read_b64_tr_b16 v[48:49], v138 offset:61440
    ds_read_b64_tr_b16 v[50:51], v138 offset:62464
    s_waitcnt lgkmcnt(14)
    v_mfma_f32_32x32x16_bf16 v[120:135], v[52:55], a[20:23], v[120:135]
    ds_read_b64_tr_b16 v[52:53], v139 offset:61440
    ds_read_b64_tr_b16 v[54:55], v139 offset:62464
    s_waitcnt lgkmcnt(14)
    v_mfma_f32_32x32x16_bf16 v[72:87], v[24:27], a[24:27], v[72:87]
    ds_read_b64_tr_b16 v[24:25], v15 offset:32768
    ds_read_b64_tr_b16 v[26:27], v15 offset:33792
    s_waitcnt lgkmcnt(14)
    v_mfma_f32_32x32x16_bf16 v[88:103], v[28:31], a[24:27], v[88:103]
    ds_read_b64_tr_b16 v[28:29], v16 offset:32768
    ds_read_b64_tr_b16 v[30:31], v16 offset:33792
    s_waitcnt lgkmcnt(14)
    v_mfma_f32_32x32x16_bf16 v[104:119], v[32:35], a[24:27], v[104:119]
    ds_read_b64_tr_b16 v[32:33], v17 offset:32768
    ds_read_b64_tr_b16 v[34:35], v17 offset:33792
    s_waitcnt lgkmcnt(14)
    v_mfma_f32_32x32x16_bf16 v[120:135], v[36:39], a[24:27], v[120:135]
    ds_read_b64_tr_b16 v[36:37], v18 offset:32768
    ds_read_b64_tr_b16 v[38:39], v18 offset:33792
    s_waitcnt lgkmcnt(14)
    v_mfma_f32_32x32x16_bf16 v[72:87], v[40:43], a[28:31], v[72:87]
    ds_read_b64_tr_b16 v[40:41], v15 offset:36864
    ds_read_b64_tr_b16 v[42:43], v15 offset:37888
    s_waitcnt lgkmcnt(14)
    v_mfma_f32_32x32x16_bf16 v[88:103], v[44:47], a[28:31], v[88:103]
    ds_read_b64_tr_b16 v[44:45], v16 offset:36864
    ds_read_b64_tr_b16 v[46:47], v16 offset:37888
    s_waitcnt lgkmcnt(14)
    v_mfma_f32_32x32x16_bf16 v[104:119], v[48:51], a[28:31], v[104:119]
    ds_read_b64_tr_b16 v[48:49], v17 offset:36864
    ds_read_b64_tr_b16 v[50:51], v17 offset:37888
    s_waitcnt lgkmcnt(14)
    v_mfma_f32_32x32x16_bf16 v[120:135], v[52:55], a[28:31], v[120:135]
    ds_read_b64_tr_b16 v[52:53], v18 offset:36864
    ds_read_b64_tr_b16 v[54:55], v18 offset:37888
    s_waitcnt vmcnt(2)
    s_barrier
    s_waitcnt lgkmcnt(14)
    v_mfma_f32_32x32x16_bf16 v[72:87], v[24:27], v[56:59], v[72:87]
    ds_read_b64_tr_b16 v[24:25], v15 offset:40960
    ds_read_b64_tr_b16 v[26:27], v15 offset:41984
    s_add_u32 m0, s6, 49152
    s_nop 0
    buffer_load_dwordx4 v13, s[8:11], s28 offen lds
    s_waitcnt lgkmcnt(14)
    v_mfma_f32_32x32x16_bf16 v[88:103], v[28:31], v[56:59], v[88:103]
    ds_read_b64_tr_b16 v[28:29], v16 offset:40960
    ds_read_b64_tr_b16 v[30:31], v16 offset:41984
    s_add_u32 m0, s6, 57344
    s_add_u32 s30, s28, 8192
    buffer_load_dwordx4 v13, s[8:11], s30 offen lds
    s_add_u32 s28, s28, 16384
    s_waitcnt lgkmcnt(14)
    v_mfma_f32_32x32x16_bf16 v[104:119], v[32:35], v[56:59], v[104:119]
    ds_read_b64_tr_b16 v[32:33], v17 offset:40960
    ds_read_b64_tr_b16 v[34:35], v17 offset:41984
    s_waitcnt lgkmcnt(14)
    v_mfma_f32_32x32x16_bf16 v[120:135], v[36:39], v[56:59], v[120:135]
    ds_read_b64_tr_b16 v[36:37], v18 offset:40960
    ds_read_b64_tr_b16 v[38:39], v18 offset:41984
    s_waitcnt lgkmcnt(14)
    v_mfma_f32_32x32x16_bf16 v[72:87], v[40:43], v[60:63], v[72:87]
    ds_read_b64_tr_b16 v[40:41], v15 offset:45056
    ds_read_b64_tr_b16 v[42:43], v15 offset:46080
    s_waitcnt lgkmcnt(14)
    v_mfma_f32_32x32x16_bf16 v[88:103], v[44:47], v[60:63], v[88:103]
    ds_read_b64_tr_b16 v[44:45], v16 offset:45056
    ds_read_b64_tr_b16 v[46:47], v16 offset:46080
    s_waitcnt lgkmcnt(14)
    v_mfma_f32_32x32x16_bf16 v[104:119], v[48:51], v[60:63], v[104:119]
    ds_read_b64_tr_b16 v[48:49], v17 offset:45056
    ds_read_b64_tr_b16 v[50:51], v17 offset:46080
    s_waitcnt lgkmcnt(14)
    v_mfma_f32_32x32x16_bf16 v[120:135], v[52:55], v[60:63], v[120:135]
    ds_read_b64_tr_b16 v[52:53], v18 offset:45056
    ds_read_b64_tr_b16 v[54:55], v18 offset:46080
    s_waitcnt lgkmcnt(14)
    v_mfma_f32_32x32x16_bf16 v[72:87], v[24:27], v[64:67], v[72:87]
    ds_read_b64_tr_b16 v[24:25], v15 offset:49152
    ds_read_b64_tr_b16 v[26:27], v15 offset:50176
    s_waitcnt lgkmcnt(14)
    v_mfma_f32_32x32x16_bf16 v[88:103], v[28:31], v[64:67], v[88:103]
    ds_read_b64_tr_b16 v[28:29], v16 offset:49152
    ds_read_b64_tr_b16 v[30:31], v16 offset:50176
    s_waitcnt lgkmcnt(14)
    v_mfma_f32_32x32x16_bf16 v[104:119], v[32:35], v[64:67], v[104:119]
    ds_read_b64_tr_b16 v[32:33], v17 offset:49152
    ds_read_b64_tr_b16 v[34:35], v17 offset:50176
    s_waitcnt lgkmcnt(14)
    v_mfma_f32_32x32x16_bf16 v[120:135], v[36:39], v[64:67], v[120:135]
    ds_read_b64_tr_b16 v[36:37], v18 offset:49152
    ds_read_b64_tr_b16 v[38:39], v18 offset:50176
    s_waitcnt lgkmcnt(14)
    v_mfma_f32_32x32x16_bf16 v[72:87], v[40:43], v[68:71], v[72:87]
    ds_read_b64_tr_b16 v[40:41], v15 offset:53248
    ds_read_b64_tr_b16 v[42:43], v15 offset:54272
    s_waitcnt lgkmcnt(14)
    v_mfma_f32_32x32x16_bf16 v[88:103], v[44:47], v[68:71], v[88:103]
    ds_read_b64_tr_b16 v[44:45], v16 offset:53248
    ds_read_b64_tr_b16 v[46:47], v16 offset:54272
    s_waitcnt lgkmcnt(14)
    v_mfma_f32_32x32x16_bf16 v[104:119], v[48:51], v[68:71], v[104:119]
    ds_read_b64_tr_b16 v[48:49], v17 offset:53248
    ds_read_b64_tr_b16 v[50:51], v17 offset:54272
    s_waitcnt lgkmcnt(14)
    v_mfma_f32_32x32x16_bf16 v[120:135], v[52:55], v[68:71], v[120:135]
    ds_read_b64_tr_b16 v[52:53], v18 offset:53248
    ds_read_b64_tr_b16 v[54:55], v18 offset:54272
    s_waitcnt vmcnt(2)
    s_barrier
    s_waitcnt lgkmcnt(14)
    v_mfma_f32_32x32x16_bf16 v[72:87], v[24:27], v[144:147], v[72:87]
    ds_read_b64_tr_b16 v[24:25], v15 offset:57344
    ds_read_b64_tr_b16 v[26:27], v15 offset:58368
    s_add_u32 m0, s6, 98304
    s_nop 0
    buffer_load_dwordx4 v14, s[12:15], s29 offen lds
    s_waitcnt lgkmcnt(14)
    v_mfma_f32_32x32x16_bf16 v[88:103], v[28:31], v[144:147], v[88:103]
    ds_read_b64_tr_b16 v[28:29], v16 offset:57344
    ds_read_b64_tr_b16 v[30:31], v16 offset:58368
    s_add_u32 m0, s6, 106496
    s_add_u32 s30, s29, 8192
    buffer_load_dwordx4 v14, s[12:15], s30 offen lds
    s_add_u32 s29, s29, 16384
    s_waitcnt lgkmcnt(14)
    v_mfma_f32_32x32x16_bf16 v[104:119], v[32:35], v[144:147], v[104:119]
    ds_read_b64_tr_b16 v[32:33], v17 offset:57344
    ds_read_b64_tr_b16 v[34:35], v17 offset:58368
    s_waitcnt lgkmcnt(14)
    v_mfma_f32_32x32x16_bf16 v[120:135], v[36:39], v[144:147], v[120:135]
    ds_read_b64_tr_b16 v[36:37], v18 offset:57344
    ds_read_b64_tr_b16 v[38:39], v18 offset:58368
    s_waitcnt lgkmcnt(14)
    v_mfma_f32_32x32x16_bf16 v[72:87], v[40:43], v[148:151], v[72:87]
    ds_read_b64_tr_b16 v[40:41], v15 offset:61440
    ds_read_b64_tr_b16 v[42:43], v15 offset:62464
    s_waitcnt lgkmcnt(14)
    v_mfma_f32_32x32x16_bf16 v[88:103], v[44:47], v[148:151], v[88:103]
    ds_read_b64_tr_b16 v[44:45], v16 offset:61440
    ds_read_b64_tr_b16 v[46:47], v16 offset:62464
    s_waitcnt lgkmcnt(14)
    v_mfma_f32_32x32x16_bf16 v[104:119], v[48:51], v[148:151], v[104:119]
    ds_read_b64_tr_b16 v[48:49], v17 offset:61440
    ds_read_b64_tr_b16 v[50:51], v17 offset:62464
    s_waitcnt lgkmcnt(14)
    v_mfma_f32_32x32x16_bf16 v[120:135], v[52:55], v[148:151], v[120:135]
    ds_read_b64_tr_b16 v[52:53], v18 offset:61440
    ds_read_b64_tr_b16 v[54:55], v18 offset:62464
    s_waitcnt lgkmcnt(14)
    v_mfma_f32_32x32x16_bf16 v[72:87], v[24:27], v[152:155], v[72:87]
    s_waitcnt lgkmcnt(12)
    v_mfma_f32_32x32x16_bf16 v[88:103], v[28:31], v[152:155], v[88:103]
    s_waitcnt lgkmcnt(10)
    v_mfma_f32_32x32x16_bf16 v[104:119], v[32:35], v[152:155], v[104:119]
    s_waitcnt lgkmcnt(8)
    v_mfma_f32_32x32x16_bf16 v[120:135], v[36:39], v[152:155], v[120:135]
    s_waitcnt lgkmcnt(6)
    v_mfma_f32_32x32x16_bf16 v[72:87], v[40:43], v[156:159], v[72:87]
    s_waitcnt lgkmcnt(4)
    v_mfma_f32_32x32x16_bf16 v[88:103], v[44:47], v[156:159], v[88:103]
    s_waitcnt lgkmcnt(2)
    v_mfma_f32_32x32x16_bf16 v[104:119], v[48:51], v[156:159], v[104:119]
    s_waitcnt lgkmcnt(0)
    v_mfma_f32_32x32x16_bf16 v[120:135], v[52:55], v[156:159], v[120:135]
    s_nop 15
    v_cvt_pk_bf16_f32 v20, v72, v73
    v_cvt_pk_bf16_f32 v21, v74, v75
    v_cvt_pk_bf16_f32 v22, v76, v77
    v_cvt_pk_bf16_f32 v23, v78, v79
    s_nop 1
    v_permlane32_swap_b32 v20, v22
    v_permlane32_swap_b32 v21, v23
    s_nop 1
    v_accvgpr_write_b32 a0, v20
    v_accvgpr_write_b32 a1, v21
    v_accvgpr_write_b32 a2, v22
    v_accvgpr_write_b32 a3, v23
    v_cvt_pk_bf16_f32 v20, v80, v81
    v_cvt_pk_bf16_f32 v21, v82, v83
    v_cvt_pk_bf16_f32 v22, v84, v85
    v_cvt_pk_bf16_f32 v23, v86, v87
    s_nop 1
    v_permlane32_swap_b32 v20, v22
    v_permlane32_swap_b32 v21, v23
    s_nop 1
    v_accvgpr_write_b32 a4, v20
    v_accvgpr_write_b32 a5, v21
    v_accvgpr_write_b32 a6, v22
    v_accvgpr_write_b32 a7, v23
    v_cvt_pk_bf16_f32 v20, v88, v89
    v_cvt_pk_bf16_f32 v21, v90, v91
    v_cvt_pk_bf16_f32 v22, v92, v93
    v_cvt_pk_bf16_f32 v23, v94, v95
    s_nop 1
    v_permlane32_swap_b32 v20, v22
    v_permlane32_swap_b32 v21, v23
    s_nop 1
    v_accvgpr_write_b32 a8, v20
    v_accvgpr_write_b32 a9, v21
    v_accvgpr_write_b32 a10, v22
    v_accvgpr_write_b32 a11, v23
    v_cvt_pk_bf16_f32 v20, v96, v97
    v_cvt_pk_bf16_f32 v21, v98, v99
    v_cvt_pk_bf16_f32 v22, v100, v101
    v_cvt_pk_bf16_f32 v23, v102, v103
    s_nop 1
    v_permlane32_swap_b32 v20, v22
    v_permlane32_swap_b32 v21, v23
    s_nop 1
    v_accvgpr_write_b32 a12, v20
    v_accvgpr_write_b32 a13, v21
    v_accvgpr_write_b32 a14, v22
    v_accvgpr_write_b32 a15, v23
    v_cvt_pk_bf16_f32 v20, v104, v105
    v_cvt_pk_bf16_f32 v21, v106, v107
    v_cvt_pk_bf16_f32 v22, v108, v109
    v_cvt_pk_bf16_f32 v23, v110, v111
    s_nop 1
    v_permlane32_swap_b32 v20, v22
    v_permlane32_swap_b32 v21, v23
    s_nop 1
    v_accvgpr_write_b32 a16, v20
    v_accvgpr_write_b32 a17, v21
    v_accvgpr_write_b32 a18, v22
    v_accvgpr_write_b32 a19, v23
    v_cvt_pk_bf16_f32 v20, v112, v113
    v_cvt_pk_bf16_f32 v21, v114, v115
    v_cvt_pk_bf16_f32 v22, v116, v117
    v_cvt_pk_bf16_f32 v23, v118, v119
    s_nop 1
    v_permlane32_swap_b32 v20, v22
    v_permlane32_swap_b32 v21, v23
    s_nop 1
    v_accvgpr_write_b32 a20, v20
    v_accvgpr_write_b32 a21, v21
    v_accvgpr_write_b32 a22, v22
    v_accvgpr_write_b32 a23, v23
    v_cvt_pk_bf16_f32 v20, v120, v121
    v_cvt_pk_bf16_f32 v21, v122, v123
    v_cvt_pk_bf16_f32 v22, v124, v125
    v_cvt_pk_bf16_f32 v23, v126, v127
    s_nop 1
    v_permlane32_swap_b32 v20, v22
    v_permlane32_swap_b32 v21, v23
    s_nop 1
    v_accvgpr_write_b32 a24, v20
    v_accvgpr_write_b32 a25, v21
    v_accvgpr_write_b32 a26, v22
    v_accvgpr_write_b32 a27, v23
    v_cvt_pk_bf16_f32 v20, v128, v129
    v_cvt_pk_bf16_f32 v21, v130, v131
    v_cvt_pk_bf16_f32 v22, v132, v133
    v_cvt_pk_bf16_f32 v23, v134, v135
    s_nop 1
    v_permlane32_swap_b32 v20, v22
    v_permlane32_swap_b32 v21, v23
    s_nop 1
    v_accvgpr_write_b32 a28, v20
    v_accvgpr_write_b32 a29, v21
    v_accvgpr_write_b32 a30, v22
    v_accvgpr_write_b32 a31, v23
    v_accvgpr_write_b32 a32, 0
    v_accvgpr_write_b32 a33, 0
    v_accvgpr_write_b32 a34, 0
    v_accvgpr_write_b32 a35, 0
    v_accvgpr_write_b32 a36, 0
    v_accvgpr_write_b32 a37, 0
    v_accvgpr_write_b32 a38, 0
    v_accvgpr_write_b32 a39, 0
    v_accvgpr_write_b32 a40, 0
    v_accvgpr_write_b32 a41, 0
    v_accvgpr_write_b32 a42, 0
    v_accvgpr_write_b32 a43, 0
    v_accvgpr_write_b32 a44, 0
    v_accvgpr_write_b32 a45, 0
    v_accvgpr_write_b32 a46, 0
    v_accvgpr_write_b32 a47, 0
    v_accvgpr_write_b32 a48, 0
    v_accvgpr_write_b32 a49, 0
    v_accvgpr_write_b32 a50, 0
    v_accvgpr_write_b32 a51, 0
    v_accvgpr_write_b32 a52, 0
    v_accvgpr_write_b32 a53, 0
    v_accvgpr_write_b32 a54, 0
    v_accvgpr_write_b32 a55, 0
    v_accvgpr_write_b32 a56, 0
    v_accvgpr_write_b32 a57, 0
    v_accvgpr_write_b32 a58, 0
    v_accvgpr_write_b32 a59, 0
    v_accvgpr_write_b32 a60, 0
    v_accvgpr_write_b32 a61, 0
    v_accvgpr_write_b32 a62, 0
    v_accvgpr_write_b32 a63, 0
    v_accvgpr_write_b32 a64, 0
    v_accvgpr_write_b32 a65, 0
    v_accvgpr_write_b32 a66, 0
    v_accvgpr_write_b32 a67, 0
    v_accvgpr_write_b32 a68, 0
    v_accvgpr_write_b32 a69, 0
    v_accvgpr_write_b32 a70, 0
    v_accvgpr_write_b32 a71, 0
    v_accvgpr_write_b32 a72, 0
    v_accvgpr_write_b32 a73, 0
    v_accvgpr_write_b32 a74, 0
    v_accvgpr_write_b32 a75, 0
    v_accvgpr_write_b32 a76, 0
    v_accvgpr_write_b32 a77, 0
    v_accvgpr_write_b32 a78, 0
    v_accvgpr_write_b32 a79, 0
    v_accvgpr_write_b32 a80, 0
    v_accvgpr_write_b32 a81, 0
    v_accvgpr_write_b32 a82, 0
    v_accvgpr_write_b32 a83, 0
    v_accvgpr_write_b32 a84, 0
    v_accvgpr_write_b32 a85, 0
    v_accvgpr_write_b32 a86, 0
    v_accvgpr_write_b32 a87, 0
    v_accvgpr_write_b32 a88, 0
    v_accvgpr_write_b32 a89, 0
    v_accvgpr_write_b32 a90, 0
    v_accvgpr_write_b32 a91, 0
    v_accvgpr_write_b32 a92, 0
    v_accvgpr_write_b32 a93, 0
    v_accvgpr_write_b32 a94, 0
    v_accvgpr_write_b32 a95, 0
    v_mov_b32 v143, 0xff800000
    v_mov_b32 v15, 0xff800000
    v_mov_b32 v18, 0
    v_mov_b32 v19, 0
    v_mov_b32 v16, 0
    v_lshrrev_b32 v20, 4, v0
    v_xor_b32 v20, v20, v0
    v_and_b32 v20, 1, v20
    v_cmp_eq_u32 vcc, 0, v20
    v_mov_b32 v21, 0x3f803f80
    s_nop 1
    v_cndmask_b32 v144, 0, v21, vcc
    v_cndmask_b32 v145, 0, v21, vcc
    v_cndmask_b32 v146, 0, v21, vcc
    v_cndmask_b32 v147, 0, v21, vcc
    v_mov_b32 v148, 0
    v_mov_b32 v149, 0
    v_mov_b32 v150, 0
    v_mov_b32 v151, 0
    s_waitcnt vmcnt(10)
    s_barrier

    s_mov_b32 s35, 0
    ds_read_b128 v[24:27], v1 offset:0
    ds_read_b128 v[28:31], v2 offset:0
    ds_read_b128 v[32:35], v3 offset:0
    ds_read_b128 v[36:39], v4 offset:0
    ds_read_b128 v[40:43], v5 offset:0
    ds_read_b128 v[44:47], v6 offset:0
    ds_read_b128 v[48:51], v7 offset:0
    ds_read_b128 v[52:55], v8 offset:0
    s_waitcnt lgkmcnt(7)
    v_mfma_f32_32x32x16_bf16 v[72:87], v[24:27], a[0:3], 0
    ds_read_b128 v[24:27], v1 offset:8192
    s_waitcnt lgkmcnt(7)
    v_mfma_f32_32x32x16_bf16 v[72:87], v[28:31], a[4:7], v[72:87]
    ds_read_b128 v[28:31], v2 offset:8192
    s_waitcnt lgkmcnt(7)
    v_mfma_f32_32x32x16_bf16 v[72:87], v[32:35], a[8:11], v[72:87]
    ds_read_b128 v[32:35], v3 offset:8192
    s_waitcnt lgkmcnt(7)
    v_mfma_f32_32x32x16_bf16 v[72:87], v[36:39], a[12:15], v[72:87]
    ds_read_b128 v[36:39], v4 offset:8192
    s_waitcnt lgkmcnt(7)
    v_mfma_f32_32x32x16_bf16 v[72:87], v[40:43], a[16:19], v[72:87]
    ds_read_b128 v[40:43], v5 offset:8192
    s_waitcnt lgkmcnt(7)
    v_mfma_f32_32x32x16_bf16 v[72:87], v[44:47], a[20:23], v[72:87]
    ds_read_b128 v[44:47], v6 offset:8192
    s_waitcnt lgkmcnt(7)
    v_mfma_f32_32x32x16_bf16 v[72:87], v[48:51], a[24:27], v[72:87]
    ds_read_b128 v[48:51], v7 offset:8192
    s_waitcnt lgkmcnt(7)
    v_mfma_f32_32x32x16_bf16 v[72:87], v[52:55], a[28:31], v[72:87]
    ds_read_b128 v[52:55], v8 offset:8192
    s_waitcnt lgkmcnt(7)
    v_mfma_f32_32x32x16_bf16 v[88:103], v[24:27], a[0:3], 0
    ds_read_b128 v[24:27], v1 offset:16384
    s_waitcnt lgkmcnt(7)
    v_mfma_f32_32x32x16_bf16 v[88:103], v[28:31], a[4:7], v[88:103]
    ds_read_b128 v[28:31], v2 offset:16384
    s_waitcnt lgkmcnt(7)
    v_mfma_f32_32x32x16_bf16 v[88:103], v[32:35], a[8:11], v[88:103]
    ds_read_b128 v[32:35], v3 offset:16384
    s_waitcnt lgkmcnt(7)
    v_mfma_f32_32x32x16_bf16 v[88:103], v[36:39], a[12:15], v[88:103]
    ds_read_b128 v[36:39], v4 offset:16384
    s_waitcnt lgkmcnt(7)
    v_mfma_f32_32x32x16_bf16 v[88:103], v[40:43], a[16:19], v[88:103]
    ds_read_b128 v[40:43], v5 offset:16384
    s_waitcnt lgkmcnt(7)
    v_mfma_f32_32x32x16_bf16 v[88:103], v[44:47], a[20:23], v[88:103]
    ds_read_b128 v[44:47], v6 offset:16384
    s_waitcnt lgkmcnt(7)
    v_mfma_f32_32x32x16_bf16 v[88:103], v[48:51], a[24:27], v[88:103]
    ds_read_b128 v[48:51], v7 offset:16384
    s_waitcnt lgkmcnt(7)
    v_mfma_f32_32x32x16_bf16 v[88:103], v[52:55], a[28:31], v[88:103]
    ds_read_b128 v[52:55], v8 offset:16384
    s_nop 15
    v_cvt_pk_bf16_f32 v72, 0, v72
    v_cvt_pk_bf16_f32 v73, 0, v73
    v_cvt_pk_bf16_f32 v74, 0, v74
    v_cvt_pk_bf16_f32 v75, 0, v75
    v_mul_f32 v72, s46, v72
    v_mul_f32 v73, s46, v73
    v_cvt_pk_bf16_f32 v76, 0, v76
    v_cvt_pk_bf16_f32 v77, 0, v77
    v_mul_f32 v74, s46, v74
    v_mul_f32 v75, s46, v75
    v_cvt_pk_bf16_f32 v72, 0, v72
    v_cvt_pk_bf16_f32 v73, 0, v73
    v_cvt_pk_bf16_f32 v78, 0, v78
    v_cvt_pk_bf16_f32 v79, 0, v79
    v_mul_f32 v76, s46, v76
    v_mul_f32 v77, s46, v77
    v_cvt_pk_bf16_f32 v74, 0, v74
    v_cvt_pk_bf16_f32 v75, 0, v75
    v_max_f32 v141, v72, v73
    v_cvt_pk_bf16_f32 v80, 0, v80
    v_cvt_pk_bf16_f32 v81, 0, v81
    v_mul_f32 v78, s46, v78
    v_mul_f32 v79, s46, v79
    v_cvt_pk_bf16_f32 v76, 0, v76
    v_cvt_pk_bf16_f32 v77, 0, v77
    v_max3_f32 v141, v141, v74, v75
    v_cvt_pk_bf16_f32 v82, 0, v82
    v_cvt_pk_bf16_f32 v83, 0, v83
    v_mul_f32 v80, s46, v80
    v_mul_f32 v81, s46, v81
    v_cvt_pk_bf16_f32 v78, 0, v78
    v_cvt_pk_bf16_f32 v79, 0, v79
    v_max3_f32 v141, v141, v76, v77
    v_cvt_pk_bf16_f32 v84, 0, v84
    v_cvt_pk_bf16_f32 v85, 0, v85
    v_mul_f32 v82, s46, v82
    v_mul_f32 v83, s46, v83
    v_cvt_pk_bf16_f32 v80, 0, v80
    v_cvt_pk_bf16_f32 v81, 0, v81
    v_max3_f32 v141, v141, v78, v79
    v_cvt_pk_bf16_f32 v86, 0, v86
    v_cvt_pk_bf16_f32 v87, 0, v87
    v_mul_f32 v84, s46, v84
    v_mul_f32 v85, s46, v85
    v_cvt_pk_bf16_f32 v82, 0, v82
    v_cvt_pk_bf16_f32 v83, 0, v83
    v_max3_f32 v141, v141, v80, v81
    v_cvt_pk_bf16_f32 v88, 0, v88
    v_cvt_pk_bf16_f32 v89, 0, v89
    v_mul_f32 v86, s46, v86
    v_mul_f32 v87, s46, v87
    v_cvt_pk_bf16_f32 v84, 0, v84
    v_cvt_pk_bf16_f32 v85, 0, v85
    v_max3_f32 v141, v141, v82, v83
    v_cvt_pk_bf16_f32 v90, 0, v90
    v_cvt_pk_bf16_f32 v91, 0, v91
    v_mul_f32 v88, s46, v88
    v_mul_f32 v89, s46, v89
    v_cvt_pk_bf16_f32 v86, 0, v86
    v_cvt_pk_bf16_f32 v87, 0, v87
    v_max3_f32 v141, v141, v84, v85
    v_cvt_pk_bf16_f32 v92, 0, v92
    v_cvt_pk_bf16_f32 v93, 0, v93
    v_mul_f32 v90, s46, v90
    v_mul_f32 v91, s46, v91
    v_cvt_pk_bf16_f32 v88, 0, v88
    v_cvt_pk_bf16_f32 v89, 0, v89
    v_max3_f32 v141, v141, v86, v87
    v_cvt_pk_bf16_f32 v94, 0, v94
    v_cvt_pk_bf16_f32 v95, 0, v95
    v_mul_f32 v92, s46, v92
    v_mul_f32 v93, s46, v93
    v_cvt_pk_bf16_f32 v90, 0, v90
    v_cvt_pk_bf16_f32 v91, 0, v91
    v_max3_f32 v141, v141, v88, v89
    v_cvt_pk_bf16_f32 v96, 0, v96
    v_cvt_pk_bf16_f32 v97, 0, v97
    v_mul_f32 v94, s46, v94
    v_mul_f32 v95, s46, v95
    v_cvt_pk_bf16_f32 v92, 0, v92
    v_cvt_pk_bf16_f32 v93, 0, v93
    v_max3_f32 v141, v141, v90, v91
    v_cvt_pk_bf16_f32 v98, 0, v98
    v_cvt_pk_bf16_f32 v99, 0, v99
    v_mul_f32 v96, s46, v96
    v_mul_f32 v97, s46, v97
    v_cvt_pk_bf16_f32 v94, 0, v94
    v_cvt_pk_bf16_f32 v95, 0, v95
    v_max3_f32 v141, v141, v92, v93
    v_cvt_pk_bf16_f32 v100, 0, v100
    v_cvt_pk_bf16_f32 v101, 0, v101
    v_mul_f32 v98, s46, v98
    v_mul_f32 v99, s46, v99
    v_cvt_pk_bf16_f32 v96, 0, v96
    v_cvt_pk_bf16_f32 v97, 0, v97
    v_max3_f32 v141, v141, v94, v95
    v_cvt_pk_bf16_f32 v102, 0, v102
    v_cvt_pk_bf16_f32 v103, 0, v103
    v_mul_f32 v100, s46, v100
    v_mul_f32 v101, s46, v101
    v_cvt_pk_bf16_f32 v98, 0, v98
    v_cvt_pk_bf16_f32 v99, 0, v99
    v_max3_f32 v141, v141, v96, v97
    v_mul_f32 v102, s46, v102
    v_mul_f32 v103, s46, v103
    v_cvt_pk_bf16_f32 v100, 0, v100
    v_cvt_pk_bf16_f32 v101, 0, v101
    v_max3_f32 v141, v141, v98, v99
    v_cvt_pk_bf16_f32 v102, 0, v102
    v_cvt_pk_bf16_f32 v103, 0, v103
    v_max3_f32 v141, v141, v100, v101
    v_max3_f32 v141, v141, v102, v103
    v_cmp_gt_f32 vcc, v141, v15
    s_cbranch_vccnz LrareA_1
LbackA_2:
    s_mov_b32 s35, 0
    v_fma_f32 v72, v72, s44, v16
    v_fma_f32 v73, v73, s44, v16
    v_fma_f32 v74, v74, s44, v16
    v_fma_f32 v75, v75, s44, v16
    v_exp_f32 v72, v72
    v_exp_f32 v73, v73
    v_fma_f32 v76, v76, s44, v16
    v_fma_f32 v77, v77, s44, v16
    v_exp_f32 v74, v74
    v_exp_f32 v75, v75
    v_cvt_pk_bf16_f32 v56, v72, v73
    v_fma_f32 v78, v78, s44, v16
    v_fma_f32 v79, v79, s44, v16
    v_exp_f32 v76, v76
    v_exp_f32 v77, v77
    v_cvt_pk_bf16_f32 v57, v74, v75
    v_fma_f32 v80, v80, s44, v16
    v_fma_f32 v81, v81, s44, v16
    v_exp_f32 v78, v78
    v_exp_f32 v79, v79
    v_cvt_pk_bf16_f32 v58, v76, v77
    v_fma_f32 v82, v82, s44, v16
    v_fma_f32 v83, v83, s44, v16
    v_exp_f32 v80, v80
    v_exp_f32 v81, v81
    v_cvt_pk_bf16_f32 v59, v78, v79
    v_fma_f32 v84, v84, s44, v16
    v_fma_f32 v85, v85, s44, v16
    v_exp_f32 v82, v82
    v_exp_f32 v83, v83
    s_mov_b32 s32, 7
Lk2_loop:
    s_waitcnt vmcnt(4)
    s_barrier
    s_waitcnt lgkmcnt(7)
    v_mfma_f32_32x32x16_bf16 v[104:119], v[24:27], a[0:3], 0
    ds_read_b128 v[24:27], v1 offset:24576
    s_cmp_lt_u32 s5, 4
    s_cbranch_scc0 Lpr_7
    s_setprio 2
    s_branch Lpr_8
Lpr_7:
    s_setprio 1
Lpr_8:
    v_cvt_pk_bf16_f32 v60, v80, v81
    v_fma_f32 v86, v86, s44, v16
    v_fma_f32 v87, v87, s44, v16
    v_exp_f32 v84, v84
    v_exp_f32 v85, v85
    s_waitcnt lgkmcnt(7)
    v_mfma_f32_32x32x16_bf16 v[104:119], v[28:31], a[4:7], v[104:119]
    ds_read_b128 v[28:31], v2 offset:24576
    v_cvt_pk_bf16_f32 v61, v82, v83
    v_fma_f32 v88, v88, s44, v16
    v_fma_f32 v89, v89, s44, v16
    v_exp_f32 v86, v86
    v_exp_f32 v87, v87
    s_add_u32 m0, s6, 0
    s_nop 0
    buffer_load_dwordx4 v13, s[8:11], s28 offen lds
    s_add_u32 m0, s6, 8192
    s_add_u32 s30, s28, 8192
    buffer_load_dwordx4 v13, s[8:11], s30 offen lds
    s_add_u32 s28, s28, 16384
    s_waitcnt lgkmcnt(7)
    v_mfma_f32_32x32x16_bf16 v[104:119], v[32:35], a[8:11], v[104:119]
    ds_read_b128 v[32:35], v3 offset:24576
    v_cvt_pk_bf16_f32 v62, v84, v85
    v_fma_f32 v90, v90, s44, v16
    v_fma_f32 v91, v91, s44, v16
    v_exp_f32 v88, v88
    v_exp_f32 v89, v89
    s_waitcnt lgkmcnt(7)
    v_mfma_f32_32x32x16_bf16 v[104:119], v[36:39], a[12:15], v[104:119]
    ds_read_b128 v[36:39], v4 offset:24576
    v_cvt_pk_bf16_f32 v63, v86, v87
    v_fma_f32 v92, v92, s44, v16
    v_fma_f32 v93, v93, s44, v16
    v_exp_f32 v90, v90
    v_exp_f32 v91, v91
    s_waitcnt lgkmcnt(7)
    v_mfma_f32_32x32x16_bf16 v[104:119], v[40:43], a[16:19], v[104:119]
    ds_read_b128 v[40:43], v5 offset:24576
    v_cvt_pk_bf16_f32 v64, v88, v89
    v_fma_f32 v94, v94, s44, v16
    v_fma_f32 v95, v95, s44, v16
    v_exp_f32 v92, v92
    v_exp_f32 v93, v93
    s_waitcnt lgkmcnt(7)
    v_mfma_f32_32x32x16_bf16 v[104:119], v[44:47], a[20:23], v[104:119]
    ds_read_b128 v[44:47], v6 offset:24576
    v_cvt_pk_bf16_f32 v65, v90, v91
    v_fma_f32 v96, v96, s44, v16
    v_fma_f32 v97, v97, s44, v16
    v_exp_f32 v94, v94
    v_exp_f32 v95, v95
    s_waitcnt lgkmcnt(7)
    v_mfma_f32_32x32x16_bf16 v[104:119], v[48:51], a[24:27], v[104:119]
    ds_read_b128 v[48:51], v7 offset:24576
    v_cvt_pk_bf16_f32 v66, v92, v93
    v_fma_f32 v98, v98, s44, v16
    v_fma_f32 v99, v99, s44, v16
    v_exp_f32 v96, v96
    v_exp_f32 v97, v97
    s_add_u32 m0, s6, 114688
    s_nop 0
    buffer_load_dwordx4 v14, s[12:15], s29 offen lds
    s_add_u32 m0, s6, 122880
    s_add_u32 s30, s29, 8192
    buffer_load_dwordx4 v14, s[12:15], s30 offen lds
    s_add_u32 s29, s29, 16384
    s_waitcnt lgkmcnt(7)
    v_mfma_f32_32x32x16_bf16 v[104:119], v[52:55], a[28:31], v[104:119]
    ds_read_b128 v[52:55], v8 offset:24576
    v_cvt_pk_bf16_f32 v67, v94, v95
    v_fma_f32 v100, v100, s44, v16
    v_fma_f32 v101, v101, s44, v16
    v_exp_f32 v98, v98
    v_exp_f32 v99, v99
    s_waitcnt lgkmcnt(7)
    v_mfma_f32_32x32x16_bf16 v[120:135], v[24:27], a[0:3], 0
    ds_read_b64_tr_b16 v[24:25], v9 offset:0
    ds_read_b64_tr_b16 v[26:27], v9 offset:2048
    v_cvt_pk_bf16_f32 v68, v96, v97
    v_fma_f32 v102, v102, s44, v16
    v_fma_f32 v103, v103, s44, v16
    v_exp_f32 v100, v100
    v_exp_f32 v101, v101
    s_waitcnt lgkmcnt(8)
    v_mfma_f32_32x32x16_bf16 v[120:135], v[28:31], a[4:7], v[120:135]
    ds_read_b64_tr_b16 v[28:29], v10 offset:0
    ds_read_b64_tr_b16 v[30:31], v10 offset:2048
    v_cvt_pk_bf16_f32 v69, v98, v99
    v_exp_f32 v102, v102
    v_exp_f32 v103, v103
    v_cvt_pk_bf16_f32 v70, v100, v101
    v_cvt_pk_bf16_f32 v71, v102, v103
    s_waitcnt lgkmcnt(9)
    v_mfma_f32_32x32x16_bf16 v[120:135], v[32:35], a[8:11], v[120:135]
    ds_read_b64_tr_b16 v[32:33], v11 offset:0
    ds_read_b64_tr_b16 v[34:35], v11 offset:2048
    v_cvt_pk_bf16_f32 v104, 0, v104
    v_cvt_pk_bf16_f32 v105, 0, v105
    v_cvt_pk_bf16_f32 v106, 0, v106
    v_cvt_pk_bf16_f32 v107, 0, v107
    v_mul_f32 v104, s46, v104
    v_mul_f32 v105, s46, v105
    v_cvt_pk_bf16_f32 v108, 0, v108
    s_waitcnt lgkmcnt(10)
    v_mfma_f32_32x32x16_bf16 v[120:135], v[36:39], a[12:15], v[120:135]
    ds_read_b64_tr_b16 v[36:37], v12 offset:0
    ds_read_b64_tr_b16 v[38:39], v12 offset:2048
    v_cvt_pk_bf16_f32 v109, 0, v109
    v_mul_f32 v106, s46, v106
    v_mul_f32 v107, s46, v107
    v_cvt_pk_bf16_f32 v104, 0, v104
    v_cvt_pk_bf16_f32 v105, 0, v105
    v_cvt_pk_bf16_f32 v110, 0, v110
    v_cvt_pk_bf16_f32 v111, 0, v111
    s_waitcnt lgkmcnt(11)
    v_mfma_f32_32x32x16_bf16 v[120:135], v[40:43], a[16:19], v[120:135]
    ds_read_b64_tr_b16 v[40:41], v9 offset:4096
    ds_read_b64_tr_b16 v[42:43], v9 offset:6144
    v_mul_f32 v108, s46, v108
    v_mul_f32 v109, s46, v109
    v_cvt_pk_bf16_f32 v106, 0, v106
    v_cvt_pk_bf16_f32 v107, 0, v107
    v_max_f32 v141, v104, v105
    v_cvt_pk_bf16_f32 v112, 0, v112
    v_cvt_pk_bf16_f32 v113, 0, v113
    s_waitcnt lgkmcnt(12)
    v_mfma_f32_32x32x16_bf16 v[120:135], v[44:47], a[20:23], v[120:135]
    ds_read_b64_tr_b16 v[44:45], v10 offset:4096
    ds_read_b64_tr_b16 v[46:47], v10 offset:6144
    v_mul_f32 v110, s46, v110
    v_mul_f32 v111, s46, v111
    v_cvt_pk_bf16_f32 v108, 0, v108
    v_cvt_pk_bf16_f32 v109, 0, v109
    v_max3_f32 v141, v141, v106, v107
    v_cvt_pk_bf16_f32 v114, 0, v114
    v_cvt_pk_bf16_f32 v115, 0, v115
    s_waitcnt lgkmcnt(13)
    v_mfma_f32_32x32x16_bf16 v[120:135], v[48:51], a[24:27], v[120:135]
    ds_read_b64_tr_b16 v[48:49], v11 offset:4096
    ds_read_b64_tr_b16 v[50:51], v11 offset:6144
    v_mul_f32 v112, s46, v112
    v_mul_f32 v113, s46, v113
    v_cvt_pk_bf16_f32 v110, 0, v110
    v_cvt_pk_bf16_f32 v111, 0, v111
    v_max3_f32 v141, v141, v108, v109
    v_cvt_pk_bf16_f32 v116, 0, v116
    v_cvt_pk_bf16_f32 v117, 0, v117
    s_waitcnt lgkmcnt(14)
    v_mfma_f32_32x32x16_bf16 v[120:135], v[52:55], a[28:31], v[120:135]
    ds_read_b64_tr_b16 v[52:53], v12 offset:4096
    ds_read_b64_tr_b16 v[54:55], v12 offset:6144
    v_mul_f32 v114, s46, v114
    v_mul_f32 v115, s46, v115
    v_cvt_pk_bf16_f32 v112, 0, v112
    v_cvt_pk_bf16_f32 v113, 0, v113
    v_max3_f32 v141, v141, v110, v111
    v_cvt_pk_bf16_f32 v118, 0, v118
    v_cvt_pk_bf16_f32 v119, 0, v119
    s_waitcnt lgkmcnt(14)
    v_mfma_f32_32x32x16_bf16 a[32:47], v[24:27], v[56:59], a[32:47]
    ds_read_b64_tr_b16 v[24:25], v9 offset:8192
    ds_read_b64_tr_b16 v[26:27], v9 offset:10240
    v_mul_f32 v116, s46, v116
    v_mul_f32 v117, s46, v117
    v_cvt_pk_bf16_f32 v114, 0, v114
    v_cvt_pk_bf16_f32 v115, 0, v115
    v_max3_f32 v141, v141, v112, v113
    v_mul_f32 v118, s46, v118
    v_mul_f32 v119, s46, v119
    s_waitcnt lgkmcnt(14)
    v_mfma_f32_32x32x16_bf16 a[48:63], v[28:31], v[56:59], a[48:63]
    ds_read_b64_tr_b16 v[28:29], v10 offset:8192
    ds_read_b64_tr_b16 v[30:31], v10 offset:10240
    v_mfma_f32_16x16x32_bf16 v[148:151], v[144:147], v[56:59], v[148:151]
    v_cvt_pk_bf16_f32 v116, 0, v116
    v_cvt_pk_bf16_f32 v117, 0, v117
    v_max3_f32 v141, v141, v114, v115
    v_cvt_pk_bf16_f32 v118, 0, v118
    v_cvt_pk_bf16_f32 v119, 0, v119
    v_max3_f32 v141, v141, v116, v117
    v_max3_f32 v141, v141, v118, v119
    s_waitcnt lgkmcnt(14)
    v_mfma_f32_32x32x16_bf16 a[64:79], v[32:35], v[56:59], a[64:79]
    ds_read_b64_tr_b16 v[32:33], v11 offset:8192
    ds_read_b64_tr_b16 v[34:35], v11 offset:10240
    v_cvt_pk_bf16_f32 v120, 0, v120
    v_cvt_pk_bf16_f32 v121, 0, v121
    v_cvt_pk_bf16_f32 v122, 0, v122
    v_cvt_pk_bf16_f32 v123, 0, v123
    v_mul_f32 v120, s46, v120
    v_mul_f32 v121, s46, v121
    v_cvt_pk_bf16_f32 v124, 0, v124
    s_waitcnt lgkmcnt(14)
    v_mfma_f32_32x32x16_bf16 a[80:95], v[36:39], v[56:59], a[80:95]
    ds_read_b64_tr_b16 v[36:37], v12 offset:8192
    ds_read_b64_tr_b16 v[38:39], v12 offset:10240
    v_cvt_pk_bf16_f32 v125, 0, v125
    v_mul_f32 v122, s46, v122
    v_mul_f32 v123, s46, v123
    v_cvt_pk_bf16_f32 v120, 0, v120
    v_cvt_pk_bf16_f32 v121, 0, v121
    v_cvt_pk_bf16_f32 v126, 0, v126
    v_cvt_pk_bf16_f32 v127, 0, v127
    s_cmp_lt_u32 s5, 4
    s_cbranch_scc0 Lpr_9
    s_setprio 0
    s_branch Lpr_10
Lpr_9:
    s_setprio 1
Lpr_10:
    s_waitcnt lgkmcnt(14)
    v_mfma_f32_32x32x16_bf16 a[32:47], v[40:43], v[60:63], a[32:47]
    ds_read_b64_tr_b16 v[40:41], v9 offset:12288
    ds_read_b64_tr_b16 v[42:43], v9 offset:14336
    v_mul_f32 v124, s46, v124
    v_mul_f32 v125, s46, v125
    v_cvt_pk_bf16_f32 v122, 0, v122
    v_cvt_pk_bf16_f32 v123, 0, v123
    v_max3_f32 v141, v141, v120, v121
    v_cvt_pk_bf16_f32 v128, 0, v128
    v_cvt_pk_bf16_f32 v129, 0, v129
    s_waitcnt lgkmcnt(14)
    v_mfma_f32_32x32x16_bf16 a[48:63], v[44:47], v[60:63], a[48:63]
    ds_read_b64_tr_b16 v[44:45], v10 offset:12288
    ds_read_b64_tr_b16 v[46:47], v10 offset:14336
    v_mfma_f32_16x16x32_bf16 v[148:151], v[144:147], v[60:63], v[148:151]
    v_mul_f32 v126, s46, v126
    v_mul_f32 v127, s46, v127
    v_cvt_pk_bf16_f32 v124, 0, v124
    v_cvt_pk_bf16_f32 v125, 0, v125
    v_max3_f32 v141, v141, v122, v123
    v_cvt_pk_bf16_f32 v130, 0, v130
    v_cvt_pk_bf16_f32 v131, 0, v131
    s_waitcnt lgkmcnt(14)
    v_mfma_f32_32x32x16_bf16 a[64:79], v[48:51], v[60:63], a[64:79]
    ds_read_b64_tr_b16 v[48:49], v11 offset:12288
    ds_read_b64_tr_b16 v[50:51], v11 offset:14336
    v_mul_f32 v128, s46, v128
    v_mul_f32 v129, s46, v129
    v_cvt_pk_bf16_f32 v126, 0, v126
    v_cvt_pk_bf16_f32 v127, 0, v127
    v_max3_f32 v141, v141, v124, v125
    v_cvt_pk_bf16_f32 v132, 0, v132
    v_cvt_pk_bf16_f32 v133, 0, v133
    s_waitcnt lgkmcnt(14)
    v_mfma_f32_32x32x16_bf16 a[80:95], v[52:55], v[60:63], a[80:95]
    ds_read_b64_tr_b16 v[52:53], v12 offset:12288
    ds_read_b64_tr_b16 v[54:55], v12 offset:14336
    v_mul_f32 v130, s46, v130
    v_mul_f32 v131, s46, v131
    v_cvt_pk_bf16_f32 v128, 0, v128
    v_cvt_pk_bf16_f32 v129, 0, v129
    v_max3_f32 v141, v141, v126, v127
    v_cvt_pk_bf16_f32 v134, 0, v134
    v_cvt_pk_bf16_f32 v135, 0, v135
    s_waitcnt lgkmcnt(14)
    v_mfma_f32_32x32x16_bf16 a[32:47], v[24:27], v[64:67], a[32:47]
    ds_read_b128 v[24:27], v1 offset:32768
    v_mul_f32 v132, s46, v132
    v_mul_f32 v133, s46, v133
    v_cvt_pk_bf16_f32 v130, 0, v130
    v_cvt_pk_bf16_f32 v131, 0, v131
    v_max3_f32 v141, v141, v128, v129
    v_mul_f32 v134, s46, v134
    v_mul_f32 v135, s46, v135
    s_waitcnt lgkmcnt(13)
    v_mfma_f32_32x32x16_bf16 a[48:63], v[28:31], v[64:67], a[48:63]
    ds_read_b128 v[28:31], v2 offset:32768
    v_mfma_f32_16x16x32_bf16 v[148:151], v[144:147], v[64:67], v[148:151]
    v_cvt_pk_bf16_f32 v132, 0, v132
    v_cvt_pk_bf16_f32 v133, 0, v133
    v_max3_f32 v141, v141, v130, v131
    v_cvt_pk_bf16_f32 v134, 0, v134
    v_cvt_pk_bf16_f32 v135, 0, v135
    v_max3_f32 v141, v141, v132, v133
    v_max3_f32 v141, v141, v134, v135
    v_cmp_gt_f32 vcc, v141, v15
    s_cbranch_vccnz LrareA_3
LbackA_4:
    s_waitcnt lgkmcnt(12)
    v_mfma_f32_32x32x16_bf16 a[64:79], v[32:35], v[64:67], a[64:79]
    ds_read_b128 v[32:35], v3 offset:32768
    v_fma_f32 v104, v104, s44, v16
    v_fma_f32 v105, v105, s44, v16
    v_fma_f32 v106, v106, s44, v16
    v_fma_f32 v107, v107, s44, v16
    v_exp_f32 v104, v104
    s_waitcnt lgkmcnt(11)
    v_mfma_f32_32x32x16_bf16 a[80:95], v[36:39], v[64:67], a[80:95]
    ds_read_b128 v[36:39], v4 offset:32768
    v_exp_f32 v105, v105
    v_fma_f32 v108, v108, s44, v16
    v_fma_f32 v109, v109, s44, v16
    v_exp_f32 v106, v106
    v_exp_f32 v107, v107
    s_waitcnt lgkmcnt(10)
    v_mfma_f32_32x32x16_bf16 a[32:47], v[40:43], v[68:71], a[32:47]
    ds_read_b128 v[40:43], v5 offset:32768
    v_cvt_pk_bf16_f32 v56, v104, v105
    v_fma_f32 v110, v110, s44, v16
    v_fma_f32 v111, v111, s44, v16
    v_exp_f32 v108, v108
    v_exp_f32 v109, v109
    s_waitcnt lgkmcnt(9)
    v_mfma_f32_32x32x16_bf16 a[48:63], v[44:47], v[68:71], a[48:63]
    ds_read_b128 v[44:47], v6 offset:32768
    v_mfma_f32_16x16x32_bf16 v[148:151], v[144:147], v[68:71], v[148:151]
    v_cvt_pk_bf16_f32 v57, v106, v107
    v_fma_f32 v112, v112, s44, v16
    v_fma_f32 v113, v113, s44, v16
    v_exp_f32 v110, v110
    v_exp_f32 v111, v111
    s_waitcnt lgkmcnt(8)
    v_mfma_f32_32x32x16_bf16 a[64:79], v[48:51], v[68:71], a[64:79]
    ds_read_b128 v[48:51], v7 offset:32768
    v_cvt_pk_bf16_f32 v58, v108, v109
    v_fma_f32 v114, v114, s44, v16
    v_fma_f32 v115, v115, s44, v16
    v_exp_f32 v112, v112
    v_exp_f32 v113, v113
    s_waitcnt lgkmcnt(7)
    v_mfma_f32_32x32x16_bf16 a[80:95], v[52:55], v[68:71], a[80:95]
    ds_read_b128 v[52:55], v8 offset:32768
    v_cvt_pk_bf16_f32 v59, v110, v111
    v_fma_f32 v116, v116, s44, v16
    v_fma_f32 v117, v117, s44, v16
    v_exp_f32 v114, v114
    v_exp_f32 v115, v115
    s_cmp_lg_u32 s35, 0
    s_cbranch_scc1 LrareB_5
LbackB_6:
    s_waitcnt vmcnt(4)
    s_barrier
    s_waitcnt lgkmcnt(7)
    v_mfma_f32_32x32x16_bf16 v[72:87], v[24:27], a[0:3], 0
    ds_read_b128 v[24:27], v1 offset:40960
    s_cmp_lt_u32 s5, 4
    s_cbranch_scc0 Lpr_15
    s_setprio 2
    s_branch Lpr_16
Lpr_15:
    s_setprio 1
Lpr_16:
    v_cvt_pk_bf16_f32 v60, v112, v113
    v_fma_f32 v118, v118, s44, v16
    v_fma_f32 v119, v119, s44, v16
    v_exp_f32 v116, v116
    v_exp_f32 v117, v117
    s_waitcnt lgkmcnt(7)
    v_mfma_f32_32x32x16_bf16 v[72:87], v[28:31], a[4:7], v[72:87]
    ds_read_b128 v[28:31], v2 offset:40960
    v_cvt_pk_bf16_f32 v61, v114, v115
    v_fma_f32 v120, v120, s44, v16
    v_fma_f32 v121, v121, s44, v16
    v_exp_f32 v118, v118
    v_exp_f32 v119, v119
    s_add_u32 m0, s6, 16384
    s_nop 0
    buffer_load_dwordx4 v13, s[8:11], s28 offen lds
    s_add_u32 m0, s6, 24576
    s_add_u32 s30, s28, 8192
    buffer_load_dwordx4 v13, s[8:11], s30 offen lds
    s_add_u32 s28, s28, 16384
    s_waitcnt lgkmcnt(7)
    v_mfma_f32_32x32x16_bf16 v[72:87], v[32:35], a[8:11], v[72:87]
    ds_read_b128 v[32:35], v3 offset:40960
    v_cvt_pk_bf16_f32 v62, v116, v117
    v_fma_f32 v122, v122, s44, v16
    v_fma_f32 v123, v123, s44, v16
    v_exp_f32 v120, v120
    v_exp_f32 v121, v121
    s_waitcnt lgkmcnt(7)
    v_mfma_f32_32x32x16_bf16 v[72:87], v[36:39], a[12:15], v[72:87]
    ds_read_b128 v[36:39], v4 offset:40960
    v_cvt_pk_bf16_f32 v63, v118, v119
    v_fma_f32 v124, v124, s44, v16
    v_fma_f32 v125, v125, s44, v16
    v_exp_f32 v122, v122
    v_exp_f32 v123, v123
    s_waitcnt lgkmcnt(7)
    v_mfma_f32_32x32x16_bf16 v[72:87], v[40:43], a[16:19], v[72:87]
    ds_read_b128 v[40:43], v5 offset:40960
    v_cvt_pk_bf16_f32 v64, v120, v121
    v_fma_f32 v126, v126, s44, v16
    v_fma_f32 v127, v127, s44, v16
    v_exp_f32 v124, v124
    v_exp_f32 v125, v125
    s_waitcnt lgkmcnt(7)
    v_mfma_f32_32x32x16_bf16 v[72:87], v[44:47], a[20:23], v[72:87]
    ds_read_b128 v[44:47], v6 offset:40960
    v_cvt_pk_bf16_f32 v65, v122, v123
    v_fma_f32 v128, v128, s44, v16
    v_fma_f32 v129, v129, s44, v16
    v_exp_f32 v126, v126
    v_exp_f32 v127, v127
    s_waitcnt lgkmcnt(7)
    v_mfma_f32_32x32x16_bf16 v[72:87], v[48:51], a[24:27], v[72:87]
    ds_read_b128 v[48:51], v7 offset:40960
    v_cvt_pk_bf16_f32 v66, v124, v125
    v_fma_f32 v130, v130, s44, v16
    v_fma_f32 v131, v131, s44, v16
    v_exp_f32 v128, v128
    v_exp_f32 v129, v129
    s_add_u32 m0, s6, 65536
    s_nop 0
    buffer_load_dwordx4 v14, s[12:15], s29 offen lds
    s_add_u32 m0, s6, 73728
    s_add_u32 s30, s29, 8192
    buffer_load_dwordx4 v14, s[12:15], s30 offen lds
    s_add_u32 s29, s29, 16384
    s_waitcnt lgkmcnt(7)
    v_mfma_f32_32x32x16_bf16 v[72:87], v[52:55], a[28:31], v[72:87]
    ds_read_b128 v[52:55], v8 offset:40960
    v_cvt_pk_bf16_f32 v67, v126, v127
    v_fma_f32 v132, v132, s44, v16
    v_fma_f32 v133, v133, s44, v16
    v_exp_f32 v130, v130
    v_exp_f32 v131, v131
    s_waitcnt lgkmcnt(7)
    v_mfma_f32_32x32x16_bf16 v[88:103], v[24:27], a[0:3], 0
    ds_read_b64_tr_b16 v[24:25], v9 offset:16384
    ds_read_b64_tr_b16 v[26:27], v9 offset:18432
    v_cvt_pk_bf16_f32 v68, v128, v129
    v_fma_f32 v134, v134, s44, v16
    v_fma_f32 v135, v135, s44, v16
    v_exp_f32 v132, v132
    v_exp_f32 v133, v133
    s_waitcnt lgkmcnt(8)
    v_mfma_f32_32x32x16_bf16 v[88:103], v[28:31], a[4:7], v[88:103]
    ds_read_b64_tr_b16 v[28:29], v10 offset:16384
    ds_read_b64_tr_b16 v[30:31], v10 offset:18432
    v_cvt_pk_bf16_f32 v69, v130, v131
    v_exp_f32 v134, v134
    v_exp_f32 v135, v135
    v_cvt_pk_bf16_f32 v70, v132, v133
    v_cvt_pk_bf16_f32 v71, v134, v135
    s_waitcnt lgkmcnt(9)
    v_mfma_f32_32x32x16_bf16 v[88:103], v[32:35], a[8:11], v[88:103]
    ds_read_b64_tr_b16 v[32:33], v11 offset:16384
    ds_read_b64_tr_b16 v[34:35], v11 offset:18432
    v_cvt_pk_bf16_f32 v72, 0, v72
    v_cvt_pk_bf16_f32 v73, 0, v73
    v_cvt_pk_bf16_f32 v74, 0, v74
    v_cvt_pk_bf16_f32 v75, 0, v75
    v_mul_f32 v72, s46, v72
    v_mul_f32 v73, s46, v73
    v_cvt_pk_bf16_f32 v76, 0, v76
    s_waitcnt lgkmcnt(10)
    v_mfma_f32_32x32x16_bf16 v[88:103], v[36:39], a[12:15], v[88:103]
    ds_read_b64_tr_b16 v[36:37], v12 offset:16384
    ds_read_b64_tr_b16 v[38:39], v12 offset:18432
    v_cvt_pk_bf16_f32 v77, 0, v77
    v_mul_f32 v74, s46, v74
    v_mul_f32 v75, s46, v75
    v_cvt_pk_bf16_f32 v72, 0, v72
    v_cvt_pk_bf16_f32 v73, 0, v73
    v_cvt_pk_bf16_f32 v78, 0, v78
    v_cvt_pk_bf16_f32 v79, 0, v79
    s_waitcnt lgkmcnt(11)
    v_mfma_f32_32x32x16_bf16 v[88:103], v[40:43], a[16:19], v[88:103]
    ds_read_b64_tr_b16 v[40:41], v9 offset:20480
    ds_read_b64_tr_b16 v[42:43], v9 offset:22528
    v_mul_f32 v76, s46, v76
    v_mul_f32 v77, s46, v77
    v_cvt_pk_bf16_f32 v74, 0, v74
    v_cvt_pk_bf16_f32 v75, 0, v75
    v_max_f32 v141, v72, v73
    v_cvt_pk_bf16_f32 v80, 0, v80
    v_cvt_pk_bf16_f32 v81, 0, v81
    s_waitcnt lgkmcnt(12)
    v_mfma_f32_32x32x16_bf16 v[88:103], v[44:47], a[20:23], v[88:103]
    ds_read_b64_tr_b16 v[44:45], v10 offset:20480
    ds_read_b64_tr_b16 v[46:47], v10 offset:22528
    v_mul_f32 v78, s46, v78
    v_mul_f32 v79, s46, v79
    v_cvt_pk_bf16_f32 v76, 0, v76
    v_cvt_pk_bf16_f32 v77, 0, v77
    v_max3_f32 v141, v141, v74, v75
    v_cvt_pk_bf16_f32 v82, 0, v82
    v_cvt_pk_bf16_f32 v83, 0, v83
    s_waitcnt lgkmcnt(13)
    v_mfma_f32_32x32x16_bf16 v[88:103], v[48:51], a[24:27], v[88:103]
    ds_read_b64_tr_b16 v[48:49], v11 offset:20480
    ds_read_b64_tr_b16 v[50:51], v11 offset:22528
    v_mul_f32 v80, s46, v80
    v_mul_f32 v81, s46, v81
    v_cvt_pk_bf16_f32 v78, 0, v78
    v_cvt_pk_bf16_f32 v79, 0, v79
    v_max3_f32 v141, v141, v76, v77
    v_cvt_pk_bf16_f32 v84, 0, v84
    v_cvt_pk_bf16_f32 v85, 0, v85
    s_waitcnt lgkmcnt(14)
    v_mfma_f32_32x32x16_bf16 v[88:103], v[52:55], a[28:31], v[88:103]
    ds_read_b64_tr_b16 v[52:53], v12 offset:20480
    ds_read_b64_tr_b16 v[54:55], v12 offset:22528
    v_mul_f32 v82, s46, v82
    v_mul_f32 v83, s46, v83
    v_cvt_pk_bf16_f32 v80, 0, v80
    v_cvt_pk_bf16_f32 v81, 0, v81
    v_max3_f32 v141, v141, v78, v79
    v_cvt_pk_bf16_f32 v86, 0, v86
    v_cvt_pk_bf16_f32 v87, 0, v87
    s_waitcnt lgkmcnt(14)
    v_mfma_f32_32x32x16_bf16 a[32:47], v[24:27], v[56:59], a[32:47]
    ds_read_b64_tr_b16 v[24:25], v9 offset:24576
    ds_read_b64_tr_b16 v[26:27], v9 offset:26624
    v_mul_f32 v84, s46, v84
    v_mul_f32 v85, s46, v85
    v_cvt_pk_bf16_f32 v82, 0, v82
    v_cvt_pk_bf16_f32 v83, 0, v83
    v_max3_f32 v141, v141, v80, v81
    v_mul_f32 v86, s46, v86
    v_mul_f32 v87, s46, v87
    s_waitcnt lgkmcnt(14)
    v_mfma_f32_32x32x16_bf16 a[48:63], v[28:31], v[56:59], a[48:63]
    ds_read_b64_tr_b16 v[28:29], v10 offset:24576
    ds_read_b64_tr_b16 v[30:31], v10 offset:26624
    v_mfma_f32_16x16x32_bf16 v[148:151], v[144:147], v[56:59], v[148:151]
    v_cvt_pk_bf16_f32 v84, 0, v84
    v_cvt_pk_bf16_f32 v85, 0, v85
    v_max3_f32 v141, v141, v82, v83
    v_cvt_pk_bf16_f32 v86, 0, v86
    v_cvt_pk_bf16_f32 v87, 0, v87
    v_max3_f32 v141, v141, v84, v85
    v_max3_f32 v141, v141, v86, v87
    s_waitcnt lgkmcnt(14)
    v_mfma_f32_32x32x16_bf16 a[64:79], v[32:35], v[56:59], a[64:79]
    ds_read_b64_tr_b16 v[32:33], v11 offset:24576
    ds_read_b64_tr_b16 v[34:35], v11 offset:26624
    v_cvt_pk_bf16_f32 v88, 0, v88
    v_cvt_pk_bf16_f32 v89, 0, v89
    v_cvt_pk_bf16_f32 v90, 0, v90
    v_cvt_pk_bf16_f32 v91, 0, v91
    v_mul_f32 v88, s46, v88
    v_mul_f32 v89, s46, v89
    v_cvt_pk_bf16_f32 v92, 0, v92
    s_waitcnt lgkmcnt(14)
    v_mfma_f32_32x32x16_bf16 a[80:95], v[36:39], v[56:59], a[80:95]
    ds_read_b64_tr_b16 v[36:37], v12 offset:24576
    ds_read_b64_tr_b16 v[38:39], v12 offset:26624
    v_cvt_pk_bf16_f32 v93, 0, v93
    v_mul_f32 v90, s46, v90
    v_mul_f32 v91, s46, v91
    v_cvt_pk_bf16_f32 v88, 0, v88
    v_cvt_pk_bf16_f32 v89, 0, v89
    v_cvt_pk_bf16_f32 v94, 0, v94
    v_cvt_pk_bf16_f32 v95, 0, v95
    s_cmp_lt_u32 s5, 4
    s_cbranch_scc0 Lpr_17
    s_setprio 0
    s_branch Lpr_18
Lpr_17:
    s_setprio 1
Lpr_18:
    s_waitcnt lgkmcnt(14)
    v_mfma_f32_32x32x16_bf16 a[32:47], v[40:43], v[60:63], a[32:47]
    ds_read_b64_tr_b16 v[40:41], v9 offset:28672
    ds_read_b64_tr_b16 v[42:43], v9 offset:30720
    v_mul_f32 v92, s46, v92
    v_mul_f32 v93, s46, v93
    v_cvt_pk_bf16_f32 v90, 0, v90
    v_cvt_pk_bf16_f32 v91, 0, v91
    v_max3_f32 v141, v141, v88, v89
    v_cvt_pk_bf16_f32 v96, 0, v96
    v_cvt_pk_bf16_f32 v97, 0, v97
    s_waitcnt lgkmcnt(14)
    v_mfma_f32_32x32x16_bf16 a[48:63], v[44:47], v[60:63], a[48:63]
    ds_read_b64_tr_b16 v[44:45], v10 offset:28672
    ds_read_b64_tr_b16 v[46:47], v10 offset:30720
    v_mfma_f32_16x16x32_bf16 v[148:151], v[144:147], v[60:63], v[148:151]
    v_mul_f32 v94, s46, v94
    v_mul_f32 v95, s46, v95
    v_cvt_pk_bf16_f32 v92, 0, v92
    v_cvt_pk_bf16_f32 v93, 0, v93
    v_max3_f32 v141, v141, v90, v91
    v_cvt_pk_bf16_f32 v98, 0, v98
    v_cvt_pk_bf16_f32 v99, 0, v99
    s_waitcnt lgkmcnt(14)
    v_mfma_f32_32x32x16_bf16 a[64:79], v[48:51], v[60:63], a[64:79]
    ds_read_b64_tr_b16 v[48:49], v11 offset:28672
    ds_read_b64_tr_b16 v[50:51], v11 offset:30720
    v_mul_f32 v96, s46, v96
    v_mul_f32 v97, s46, v97
    v_cvt_pk_bf16_f32 v94, 0, v94
    v_cvt_pk_bf16_f32 v95, 0, v95
    v_max3_f32 v141, v141, v92, v93
    v_cvt_pk_bf16_f32 v100, 0, v100
    v_cvt_pk_bf16_f32 v101, 0, v101
    s_waitcnt lgkmcnt(14)
    v_mfma_f32_32x32x16_bf16 a[80:95], v[52:55], v[60:63], a[80:95]
    ds_read_b64_tr_b16 v[52:53], v12 offset:28672
    ds_read_b64_tr_b16 v[54:55], v12 offset:30720
    v_mul_f32 v98, s46, v98
    v_mul_f32 v99, s46, v99
    v_cvt_pk_bf16_f32 v96, 0, v96
    v_cvt_pk_bf16_f32 v97, 0, v97
    v_max3_f32 v141, v141, v94, v95
    v_cvt_pk_bf16_f32 v102, 0, v102
    v_cvt_pk_bf16_f32 v103, 0, v103
    s_waitcnt lgkmcnt(14)
    v_mfma_f32_32x32x16_bf16 a[32:47], v[24:27], v[64:67], a[32:47]
    ds_read_b128 v[24:27], v1 offset:49152
    v_mul_f32 v100, s46, v100
    v_mul_f32 v101, s46, v101
    v_cvt_pk_bf16_f32 v98, 0, v98
    v_cvt_pk_bf16_f32 v99, 0, v99
    v_max3_f32 v141, v141, v96, v97
    v_mul_f32 v102, s46, v102
    v_mul_f32 v103, s46, v103
    s_waitcnt lgkmcnt(13)
    v_mfma_f32_32x32x16_bf16 a[48:63], v[28:31], v[64:67], a[48:63]
    ds_read_b128 v[28:31], v2 offset:49152
    v_mfma_f32_16x16x32_bf16 v[148:151], v[144:147], v[64:67], v[148:151]
    v_cvt_pk_bf16_f32 v100, 0, v100
    v_cvt_pk_bf16_f32 v101, 0, v101
    v_max3_f32 v141, v141, v98, v99
    v_cvt_pk_bf16_f32 v102, 0, v102
    v_cvt_pk_bf16_f32 v103, 0, v103
    v_max3_f32 v141, v141, v100, v101
    v_max3_f32 v141, v141, v102, v103
    v_cmp_gt_f32 vcc, v141, v15
    s_cbranch_vccnz LrareA_11
LbackA_12:
    s_waitcnt lgkmcnt(12)
    v_mfma_f32_32x32x16_bf16 a[64:79], v[32:35], v[64:67], a[64:79]
    ds_read_b128 v[32:35], v3 offset:49152
    v_fma_f32 v72, v72, s44, v16
    v_fma_f32 v73, v73, s44, v16
    v_fma_f32 v74, v74, s44, v16
    v_fma_f32 v75, v75, s44, v16
    v_exp_f32 v72, v72
    s_waitcnt lgkmcnt(11)
    v_mfma_f32_32x32x16_bf16 a[80:95], v[36:39], v[64:67], a[80:95]
    ds_read_b128 v[36:39], v4 offset:49152
    v_exp_f32 v73, v73
    v_fma_f32 v76, v76, s44, v16
    v_fma_f32 v77, v77, s44, v16
    v_exp_f32 v74, v74
    v_exp_f32 v75, v75
    s_waitcnt lgkmcnt(10)
    v_mfma_f32_32x32x16_bf16 a[32:47], v[40:43], v[68:71], a[32:47]
    ds_read_b128 v[40:43], v5 offset:49152
    v_cvt_pk_bf16_f32 v56, v72, v73
    v_fma_f32 v78, v78, s44, v16
    v_fma_f32 v79, v79, s44, v16
    v_exp_f32 v76, v76
    v_exp_f32 v77, v77
    s_waitcnt lgkmcnt(9)
    v_mfma_f32_32x32x16_bf16 a[48:63], v[44:47], v[68:71], a[48:63]
    ds_read_b128 v[44:47], v6 offset:49152
    v_mfma_f32_16x16x32_bf16 v[148:151], v[144:147], v[68:71], v[148:151]
    v_cvt_pk_bf16_f32 v57, v74, v75
    v_fma_f32 v80, v80, s44, v16
    v_fma_f32 v81, v81, s44, v16
    v_exp_f32 v78, v78
    v_exp_f32 v79, v79
    s_waitcnt lgkmcnt(8)
    v_mfma_f32_32x32x16_bf16 a[64:79], v[48:51], v[68:71], a[64:79]
    ds_read_b128 v[48:51], v7 offset:49152
    v_cvt_pk_bf16_f32 v58, v76, v77
    v_fma_f32 v82, v82, s44, v16
    v_fma_f32 v83, v83, s44, v16
    v_exp_f32 v80, v80
    v_exp_f32 v81, v81
    s_waitcnt lgkmcnt(7)
    v_mfma_f32_32x32x16_bf16 a[80:95], v[52:55], v[68:71], a[80:95]
    ds_read_b128 v[52:55], v8 offset:49152
    v_cvt_pk_bf16_f32 v59, v78, v79
    v_fma_f32 v84, v84, s44, v16
    v_fma_f32 v85, v85, s44, v16
    v_exp_f32 v82, v82
    v_exp_f32 v83, v83
    s_cmp_lg_u32 s35, 0
    s_cbranch_scc1 LrareB_13
LbackB_14:
    s_waitcnt vmcnt(4)
    s_barrier
    s_waitcnt lgkmcnt(7)
    v_mfma_f32_32x32x16_bf16 v[104:119], v[24:27], a[0:3], 0
    ds_read_b128 v[24:27], v1 offset:57344
    s_cmp_lt_u32 s5, 4
    s_cbranch_scc0 Lpr_23
    s_setprio 2
    s_branch Lpr_24
Lpr_23:
    s_setprio 1
Lpr_24:
    v_cvt_pk_bf16_f32 v60, v80, v81
    v_fma_f32 v86, v86, s44, v16
    v_fma_f32 v87, v87, s44, v16
    v_exp_f32 v84, v84
    v_exp_f32 v85, v85
    s_waitcnt lgkmcnt(7)
    v_mfma_f32_32x32x16_bf16 v[104:119], v[28:31], a[4:7], v[104:119]
    ds_read_b128 v[28:31], v2 offset:57344
    v_cvt_pk_bf16_f32 v61, v82, v83
    v_fma_f32 v88, v88, s44, v16
    v_fma_f32 v89, v89, s44, v16
    v_exp_f32 v86, v86
    v_exp_f32 v87, v87
    s_add_u32 m0, s6, 32768
    s_nop 0
    buffer_load_dwordx4 v13, s[8:11], s28 offen lds
    s_add_u32 m0, s6, 40960
    s_add_u32 s30, s28, 8192
    buffer_load_dwordx4 v13, s[8:11], s30 offen lds
    s_add_u32 s28, s28, 16384
    s_waitcnt lgkmcnt(7)
    v_mfma_f32_32x32x16_bf16 v[104:119], v[32:35], a[8:11], v[104:119]
    ds_read_b128 v[32:35], v3 offset:57344
    v_cvt_pk_bf16_f32 v62, v84, v85
    v_fma_f32 v90, v90, s44, v16
    v_fma_f32 v91, v91, s44, v16
    v_exp_f32 v88, v88
    v_exp_f32 v89, v89
    s_waitcnt lgkmcnt(7)
    v_mfma_f32_32x32x16_bf16 v[104:119], v[36:39], a[12:15], v[104:119]
    ds_read_b128 v[36:39], v4 offset:57344
    v_cvt_pk_bf16_f32 v63, v86, v87
    v_fma_f32 v92, v92, s44, v16
    v_fma_f32 v93, v93, s44, v16
    v_exp_f32 v90, v90
    v_exp_f32 v91, v91
    s_waitcnt lgkmcnt(7)
    v_mfma_f32_32x32x16_bf16 v[104:119], v[40:43], a[16:19], v[104:119]
    ds_read_b128 v[40:43], v5 offset:57344
    v_cvt_pk_bf16_f32 v64, v88, v89
    v_fma_f32 v94, v94, s44, v16
    v_fma_f32 v95, v95, s44, v16
    v_exp_f32 v92, v92
    v_exp_f32 v93, v93
    s_waitcnt lgkmcnt(7)
    v_mfma_f32_32x32x16_bf16 v[104:119], v[44:47], a[20:23], v[104:119]
    ds_read_b128 v[44:47], v6 offset:57344
    v_cvt_pk_bf16_f32 v65, v90, v91
    v_fma_f32 v96, v96, s44, v16
    v_fma_f32 v97, v97, s44, v16
    v_exp_f32 v94, v94
    v_exp_f32 v95, v95
    s_waitcnt lgkmcnt(7)
    v_mfma_f32_32x32x16_bf16 v[104:119], v[48:51], a[24:27], v[104:119]
    ds_read_b128 v[48:51], v7 offset:57344
    v_cvt_pk_bf16_f32 v66, v92, v93
    v_fma_f32 v98, v98, s44, v16
    v_fma_f32 v99, v99, s44, v16
    v_exp_f32 v96, v96
    v_exp_f32 v97, v97
    s_add_u32 m0, s6, 81920
    s_nop 0
    buffer_load_dwordx4 v14, s[12:15], s29 offen lds
    s_add_u32 m0, s6, 90112
    s_add_u32 s30, s29, 8192
    buffer_load_dwordx4 v14, s[12:15], s30 offen lds
    s_add_u32 s29, s29, 16384
    s_waitcnt lgkmcnt(7)
    v_mfma_f32_32x32x16_bf16 v[104:119], v[52:55], a[28:31], v[104:119]
    ds_read_b128 v[52:55], v8 offset:57344
    v_cvt_pk_bf16_f32 v67, v94, v95
    v_fma_f32 v100, v100, s44, v16
    v_fma_f32 v101, v101, s44, v16
    v_exp_f32 v98, v98
    v_exp_f32 v99, v99
    s_waitcnt lgkmcnt(7)
    v_mfma_f32_32x32x16_bf16 v[120:135], v[24:27], a[0:3], 0
    ds_read_b64_tr_b16 v[24:25], v9 offset:32768
    ds_read_b64_tr_b16 v[26:27], v9 offset:34816
    v_cvt_pk_bf16_f32 v68, v96, v97
    v_fma_f32 v102, v102, s44, v16
    v_fma_f32 v103, v103, s44, v16
    v_exp_f32 v100, v100
    v_exp_f32 v101, v101
    s_waitcnt lgkmcnt(8)
    v_mfma_f32_32x32x16_bf16 v[120:135], v[28:31], a[4:7], v[120:135]
    ds_read_b64_tr_b16 v[28:29], v10 offset:32768
    ds_read_b64_tr_b16 v[30:31], v10 offset:34816
    v_cvt_pk_bf16_f32 v69, v98, v99
    v_exp_f32 v102, v102
    v_exp_f32 v103, v103
    v_cvt_pk_bf16_f32 v70, v100, v101
    v_cvt_pk_bf16_f32 v71, v102, v103
    s_waitcnt lgkmcnt(9)
    v_mfma_f32_32x32x16_bf16 v[120:135], v[32:35], a[8:11], v[120:135]
    ds_read_b64_tr_b16 v[32:33], v11 offset:32768
    ds_read_b64_tr_b16 v[34:35], v11 offset:34816
    v_cvt_pk_bf16_f32 v104, 0, v104
    v_cvt_pk_bf16_f32 v105, 0, v105
    v_cvt_pk_bf16_f32 v106, 0, v106
    v_cvt_pk_bf16_f32 v107, 0, v107
    v_mul_f32 v104, s46, v104
    v_mul_f32 v105, s46, v105
    v_cvt_pk_bf16_f32 v108, 0, v108
    s_waitcnt lgkmcnt(10)
    v_mfma_f32_32x32x16_bf16 v[120:135], v[36:39], a[12:15], v[120:135]
    ds_read_b64_tr_b16 v[36:37], v12 offset:32768
    ds_read_b64_tr_b16 v[38:39], v12 offset:34816
    v_cvt_pk_bf16_f32 v109, 0, v109
    v_mul_f32 v106, s46, v106
    v_mul_f32 v107, s46, v107
    v_cvt_pk_bf16_f32 v104, 0, v104
    v_cvt_pk_bf16_f32 v105, 0, v105
    v_cvt_pk_bf16_f32 v110, 0, v110
    v_cvt_pk_bf16_f32 v111, 0, v111
    s_waitcnt lgkmcnt(11)
    v_mfma_f32_32x32x16_bf16 v[120:135], v[40:43], a[16:19], v[120:135]
    ds_read_b64_tr_b16 v[40:41], v9 offset:36864
    ds_read_b64_tr_b16 v[42:43], v9 offset:38912
    v_mul_f32 v108, s46, v108
    v_mul_f32 v109, s46, v109
    v_cvt_pk_bf16_f32 v106, 0, v106
    v_cvt_pk_bf16_f32 v107, 0, v107
    v_max_f32 v141, v104, v105
    v_cvt_pk_bf16_f32 v112, 0, v112
    v_cvt_pk_bf16_f32 v113, 0, v113
    s_waitcnt lgkmcnt(12)
    v_mfma_f32_32x32x16_bf16 v[120:135], v[44:47], a[20:23], v[120:135]
    ds_read_b64_tr_b16 v[44:45], v10 offset:36864
    ds_read_b64_tr_b16 v[46:47], v10 offset:38912
    v_mul_f32 v110, s46, v110
    v_mul_f32 v111, s46, v111
    v_cvt_pk_bf16_f32 v108, 0, v108
    v_cvt_pk_bf16_f32 v109, 0, v109
    v_max3_f32 v141, v141, v106, v107
    v_cvt_pk_bf16_f32 v114, 0, v114
    v_cvt_pk_bf16_f32 v115, 0, v115
    s_waitcnt lgkmcnt(13)
    v_mfma_f32_32x32x16_bf16 v[120:135], v[48:51], a[24:27], v[120:135]
    ds_read_b64_tr_b16 v[48:49], v11 offset:36864
    ds_read_b64_tr_b16 v[50:51], v11 offset:38912
    v_mul_f32 v112, s46, v112
    v_mul_f32 v113, s46, v113
    v_cvt_pk_bf16_f32 v110, 0, v110
    v_cvt_pk_bf16_f32 v111, 0, v111
    v_max3_f32 v141, v141, v108, v109
    v_cvt_pk_bf16_f32 v116, 0, v116
    v_cvt_pk_bf16_f32 v117, 0, v117
    s_waitcnt lgkmcnt(14)
    v_mfma_f32_32x32x16_bf16 v[120:135], v[52:55], a[28:31], v[120:135]
    ds_read_b64_tr_b16 v[52:53], v12 offset:36864
    ds_read_b64_tr_b16 v[54:55], v12 offset:38912
    v_mul_f32 v114, s46, v114
    v_mul_f32 v115, s46, v115
    v_cvt_pk_bf16_f32 v112, 0, v112
    v_cvt_pk_bf16_f32 v113, 0, v113
    v_max3_f32 v141, v141, v110, v111
    v_cvt_pk_bf16_f32 v118, 0, v118
    v_cvt_pk_bf16_f32 v119, 0, v119
    s_waitcnt lgkmcnt(14)
    v_mfma_f32_32x32x16_bf16 a[32:47], v[24:27], v[56:59], a[32:47]
    ds_read_b64_tr_b16 v[24:25], v9 offset:40960
    ds_read_b64_tr_b16 v[26:27], v9 offset:43008
    v_mul_f32 v116, s46, v116
    v_mul_f32 v117, s46, v117
    v_cvt_pk_bf16_f32 v114, 0, v114
    v_cvt_pk_bf16_f32 v115, 0, v115
    v_max3_f32 v141, v141, v112, v113
    v_mul_f32 v118, s46, v118
    v_mul_f32 v119, s46, v119
    s_waitcnt lgkmcnt(14)
    v_mfma_f32_32x32x16_bf16 a[48:63], v[28:31], v[56:59], a[48:63]
    ds_read_b64_tr_b16 v[28:29], v10 offset:40960
    ds_read_b64_tr_b16 v[30:31], v10 offset:43008
    v_mfma_f32_16x16x32_bf16 v[148:151], v[144:147], v[56:59], v[148:151]
    v_cvt_pk_bf16_f32 v116, 0, v116
    v_cvt_pk_bf16_f32 v117, 0, v117
    v_max3_f32 v141, v141, v114, v115
    v_cvt_pk_bf16_f32 v118, 0, v118
    v_cvt_pk_bf16_f32 v119, 0, v119
    v_max3_f32 v141, v141, v116, v117
    v_max3_f32 v141, v141, v118, v119
    s_waitcnt lgkmcnt(14)
    v_mfma_f32_32x32x16_bf16 a[64:79], v[32:35], v[56:59], a[64:79]
    ds_read_b64_tr_b16 v[32:33], v11 offset:40960
    ds_read_b64_tr_b16 v[34:35], v11 offset:43008
    v_cvt_pk_bf16_f32 v120, 0, v120
    v_cvt_pk_bf16_f32 v121, 0, v121
    v_cvt_pk_bf16_f32 v122, 0, v122
    v_cvt_pk_bf16_f32 v123, 0, v123
    v_mul_f32 v120, s46, v120
    v_mul_f32 v121, s46, v121
    v_cvt_pk_bf16_f32 v124, 0, v124
    s_waitcnt lgkmcnt(14)
    v_mfma_f32_32x32x16_bf16 a[80:95], v[36:39], v[56:59], a[80:95]
    ds_read_b64_tr_b16 v[36:37], v12 offset:40960
    ds_read_b64_tr_b16 v[38:39], v12 offset:43008
    v_cvt_pk_bf16_f32 v125, 0, v125
    v_mul_f32 v122, s46, v122
    v_mul_f32 v123, s46, v123
    v_cvt_pk_bf16_f32 v120, 0, v120
    v_cvt_pk_bf16_f32 v121, 0, v121
    v_cvt_pk_bf16_f32 v126, 0, v126
    v_cvt_pk_bf16_f32 v127, 0, v127
    s_cmp_lt_u32 s5, 4
    s_cbranch_scc0 Lpr_25
    s_setprio 0
    s_branch Lpr_26
Lpr_25:
    s_setprio 1
Lpr_26:
    s_waitcnt lgkmcnt(14)
    v_mfma_f32_32x32x16_bf16 a[32:47], v[40:43], v[60:63], a[32:47]
    ds_read_b64_tr_b16 v[40:41], v9 offset:45056
    ds_read_b64_tr_b16 v[42:43], v9 offset:47104
    v_mul_f32 v124, s46, v124
    v_mul_f32 v125, s46, v125
    v_cvt_pk_bf16_f32 v122, 0, v122
    v_cvt_pk_bf16_f32 v123, 0, v123
    v_max3_f32 v141, v141, v120, v121
    v_cvt_pk_bf16_f32 v128, 0, v128
    v_cvt_pk_bf16_f32 v129, 0, v129
    s_waitcnt lgkmcnt(14)
    v_mfma_f32_32x32x16_bf16 a[48:63], v[44:47], v[60:63], a[48:63]
    ds_read_b64_tr_b16 v[44:45], v10 offset:45056
    ds_read_b64_tr_b16 v[46:47], v10 offset:47104
    v_mfma_f32_16x16x32_bf16 v[148:151], v[144:147], v[60:63], v[148:151]
    v_mul_f32 v126, s46, v126
    v_mul_f32 v127, s46, v127
    v_cvt_pk_bf16_f32 v124, 0, v124
    v_cvt_pk_bf16_f32 v125, 0, v125
    v_max3_f32 v141, v141, v122, v123
    v_cvt_pk_bf16_f32 v130, 0, v130
    v_cvt_pk_bf16_f32 v131, 0, v131
    s_waitcnt lgkmcnt(14)
    v_mfma_f32_32x32x16_bf16 a[64:79], v[48:51], v[60:63], a[64:79]
    ds_read_b64_tr_b16 v[48:49], v11 offset:45056
    ds_read_b64_tr_b16 v[50:51], v11 offset:47104
    v_mul_f32 v128, s46, v128
    v_mul_f32 v129, s46, v129
    v_cvt_pk_bf16_f32 v126, 0, v126
    v_cvt_pk_bf16_f32 v127, 0, v127
    v_max3_f32 v141, v141, v124, v125
    v_cvt_pk_bf16_f32 v132, 0, v132
    v_cvt_pk_bf16_f32 v133, 0, v133
    s_waitcnt lgkmcnt(14)
    v_mfma_f32_32x32x16_bf16 a[80:95], v[52:55], v[60:63], a[80:95]
    ds_read_b64_tr_b16 v[52:53], v12 offset:45056
    ds_read_b64_tr_b16 v[54:55], v12 offset:47104
    v_mul_f32 v130, s46, v130
    v_mul_f32 v131, s46, v131
    v_cvt_pk_bf16_f32 v128, 0, v128
    v_cvt_pk_bf16_f32 v129, 0, v129
    v_max3_f32 v141, v141, v126, v127
    v_cvt_pk_bf16_f32 v134, 0, v134
    v_cvt_pk_bf16_f32 v135, 0, v135
    s_waitcnt lgkmcnt(14)
    v_mfma_f32_32x32x16_bf16 a[32:47], v[24:27], v[64:67], a[32:47]
    ds_read_b128 v[24:27], v1 offset:0
    v_mul_f32 v132, s46, v132
    v_mul_f32 v133, s46, v133
    v_cvt_pk_bf16_f32 v130, 0, v130
    v_cvt_pk_bf16_f32 v131, 0, v131
    v_max3_f32 v141, v141, v128, v129
    v_mul_f32 v134, s46, v134
    v_mul_f32 v135, s46, v135
    s_waitcnt lgkmcnt(13)
    v_mfma_f32_32x32x16_bf16 a[48:63], v[28:31], v[64:67], a[48:63]
    ds_read_b128 v[28:31], v2 offset:0
    v_mfma_f32_16x16x32_bf16 v[148:151], v[144:147], v[64:67], v[148:151]
    v_cvt_pk_bf16_f32 v132, 0, v132
    v_cvt_pk_bf16_f32 v133, 0, v133
    v_max3_f32 v141, v141, v130, v131
    v_cvt_pk_bf16_f32 v134, 0, v134
    v_cvt_pk_bf16_f32 v135, 0, v135
    v_max3_f32 v141, v141, v132, v133
    v_max3_f32 v141, v141, v134, v135
    v_cmp_gt_f32 vcc, v141, v15
    s_cbranch_vccnz LrareA_19
LbackA_20:
    s_waitcnt lgkmcnt(12)
    v_mfma_f32_32x32x16_bf16 a[64:79], v[32:35], v[64:67], a[64:79]
    ds_read_b128 v[32:35], v3 offset:0
    v_fma_f32 v104, v104, s44, v16
    v_fma_f32 v105, v105, s44, v16
    v_fma_f32 v106, v106, s44, v16
    v_fma_f32 v107, v107, s44, v16
    v_exp_f32 v104, v104
    s_waitcnt lgkmcnt(11)
    v_mfma_f32_32x32x16_bf16 a[80:95], v[36:39], v[64:67], a[80:95]
    ds_read_b128 v[36:39], v4 offset:0
    v_exp_f32 v105, v105
    v_fma_f32 v108, v108, s44, v16
    v_fma_f32 v109, v109, s44, v16
    v_exp_f32 v106, v106
    v_exp_f32 v107, v107
    s_waitcnt lgkmcnt(10)
    v_mfma_f32_32x32x16_bf16 a[32:47], v[40:43], v[68:71], a[32:47]
    ds_read_b128 v[40:43], v5 offset:0
    v_cvt_pk_bf16_f32 v56, v104, v105
    v_fma_f32 v110, v110, s44, v16
    v_fma_f32 v111, v111, s44, v16
    v_exp_f32 v108, v108
    v_exp_f32 v109, v109
    s_waitcnt lgkmcnt(9)
    v_mfma_f32_32x32x16_bf16 a[48:63], v[44:47], v[68:71], a[48:63]
    ds_read_b128 v[44:47], v6 offset:0
    v_mfma_f32_16x16x32_bf16 v[148:151], v[144:147], v[68:71], v[148:151]
    v_cvt_pk_bf16_f32 v57, v106, v107
    v_fma_f32 v112, v112, s44, v16
    v_fma_f32 v113, v113, s44, v16
    v_exp_f32 v110, v110
    v_exp_f32 v111, v111
    s_waitcnt lgkmcnt(8)
    v_mfma_f32_32x32x16_bf16 a[64:79], v[48:51], v[68:71], a[64:79]
    ds_read_b128 v[48:51], v7 offset:0
    v_cvt_pk_bf16_f32 v58, v108, v109
    v_fma_f32 v114, v114, s44, v16
    v_fma_f32 v115, v115, s44, v16
    v_exp_f32 v112, v112
    v_exp_f32 v113, v113
    s_waitcnt lgkmcnt(7)
    v_mfma_f32_32x32x16_bf16 a[80:95], v[52:55], v[68:71], a[80:95]
    ds_read_b128 v[52:55], v8 offset:0
    v_cvt_pk_bf16_f32 v59, v110, v111
    v_fma_f32 v116, v116, s44, v16
    v_fma_f32 v117, v117, s44, v16
    v_exp_f32 v114, v114
    v_exp_f32 v115, v115
    s_cmp_lg_u32 s35, 0
    s_cbranch_scc1 LrareB_21
LbackB_22:
    s_waitcnt vmcnt(4)
    s_barrier
    s_waitcnt lgkmcnt(7)
    v_mfma_f32_32x32x16_bf16 v[72:87], v[24:27], a[0:3], 0
    ds_read_b128 v[24:27], v1 offset:8192
    s_cmp_lt_u32 s5, 4
    s_cbranch_scc0 Lpr_31
    s_setprio 2
    s_branch Lpr_32
Lpr_31:
    s_setprio 1
Lpr_32:
    v_cvt_pk_bf16_f32 v60, v112, v113
    v_fma_f32 v118, v118, s44, v16
    v_fma_f32 v119, v119, s44, v16
    v_exp_f32 v116, v116
    v_exp_f32 v117, v117
    s_waitcnt lgkmcnt(7)
    v_mfma_f32_32x32x16_bf16 v[72:87], v[28:31], a[4:7], v[72:87]
    ds_read_b128 v[28:31], v2 offset:8192
    v_cvt_pk_bf16_f32 v61, v114, v115
    v_fma_f32 v120, v120, s44, v16
    v_fma_f32 v121, v121, s44, v16
    v_exp_f32 v118, v118
    v_exp_f32 v119, v119
    s_add_u32 m0, s6, 49152
    s_nop 0
    buffer_load_dwordx4 v13, s[8:11], s28 offen lds
    s_add_u32 m0, s6, 57344
    s_add_u32 s30, s28, 8192
    buffer_load_dwordx4 v13, s[8:11], s30 offen lds
    s_add_u32 s28, s28, 16384
    s_waitcnt lgkmcnt(7)
    v_mfma_f32_32x32x16_bf16 v[72:87], v[32:35], a[8:11], v[72:87]
    ds_read_b128 v[32:35], v3 offset:8192
    v_cvt_pk_bf16_f32 v62, v116, v117
    v_fma_f32 v122, v122, s44, v16
    v_fma_f32 v123, v123, s44, v16
    v_exp_f32 v120, v120
    v_exp_f32 v121, v121
    s_waitcnt lgkmcnt(7)
    v_mfma_f32_32x32x16_bf16 v[72:87], v[36:39], a[12:15], v[72:87]
    ds_read_b128 v[36:39], v4 offset:8192
    v_cvt_pk_bf16_f32 v63, v118, v119
    v_fma_f32 v124, v124, s44, v16
    v_fma_f32 v125, v125, s44, v16
    v_exp_f32 v122, v122
    v_exp_f32 v123, v123
    s_waitcnt lgkmcnt(7)
    v_mfma_f32_32x32x16_bf16 v[72:87], v[40:43], a[16:19], v[72:87]
    ds_read_b128 v[40:43], v5 offset:8192
    v_cvt_pk_bf16_f32 v64, v120, v121
    v_fma_f32 v126, v126, s44, v16
    v_fma_f32 v127, v127, s44, v16
    v_exp_f32 v124, v124
    v_exp_f32 v125, v125
    s_waitcnt lgkmcnt(7)
    v_mfma_f32_32x32x16_bf16 v[72:87], v[44:47], a[20:23], v[72:87]
    ds_read_b128 v[44:47], v6 offset:8192
    v_cvt_pk_bf16_f32 v65, v122, v123
    v_fma_f32 v128, v128, s44, v16
    v_fma_f32 v129, v129, s44, v16
    v_exp_f32 v126, v126
    v_exp_f32 v127, v127
    s_waitcnt lgkmcnt(7)
    v_mfma_f32_32x32x16_bf16 v[72:87], v[48:51], a[24:27], v[72:87]
    ds_read_b128 v[48:51], v7 offset:8192
    v_cvt_pk_bf16_f32 v66, v124, v125
    v_fma_f32 v130, v130, s44, v16
    v_fma_f32 v131, v131, s44, v16
    v_exp_f32 v128, v128
    v_exp_f32 v129, v129
    s_add_u32 m0, s6, 98304
    s_nop 0
    buffer_load_dwordx4 v14, s[12:15], s29 offen lds
    s_add_u32 m0, s6, 106496
    s_add_u32 s30, s29, 8192
    buffer_load_dwordx4 v14, s[12:15], s30 offen lds
    s_add_u32 s29, s29, 16384
    s_waitcnt lgkmcnt(7)
    v_mfma_f32_32x32x16_bf16 v[72:87], v[52:55], a[28:31], v[72:87]
    ds_read_b128 v[52:55], v8 offset:8192
    v_cvt_pk_bf16_f32 v67, v126, v127
    v_fma_f32 v132, v132, s44, v16
    v_fma_f32 v133, v133, s44, v16
    v_exp_f32 v130, v130
    v_exp_f32 v131, v131
    s_waitcnt lgkmcnt(7)
    v_mfma_f32_32x32x16_bf16 v[88:103], v[24:27], a[0:3], 0
    ds_read_b64_tr_b16 v[24:25], v9 offset:49152
    ds_read_b64_tr_b16 v[26:27], v9 offset:51200
    v_cvt_pk_bf16_f32 v68, v128, v129
    v_fma_f32 v134, v134, s44, v16
    v_fma_f32 v135, v135, s44, v16
    v_exp_f32 v132, v132
    v_exp_f32 v133, v133
    s_waitcnt lgkmcnt(8)
    v_mfma_f32_32x32x16_bf16 v[88:103], v[28:31], a[4:7], v[88:103]
    ds_read_b64_tr_b16 v[28:29], v10 offset:49152
    ds_read_b64_tr_b16 v[30:31], v10 offset:51200
    v_cvt_pk_bf16_f32 v69, v130, v131
    v_exp_f32 v134, v134
    v_exp_f32 v135, v135
    v_cvt_pk_bf16_f32 v70, v132, v133
    v_cvt_pk_bf16_f32 v71, v134, v135
    s_waitcnt lgkmcnt(9)
    v_mfma_f32_32x32x16_bf16 v[88:103], v[32:35], a[8:11], v[88:103]
    ds_read_b64_tr_b16 v[32:33], v11 offset:49152
    ds_read_b64_tr_b16 v[34:35], v11 offset:51200
    v_cvt_pk_bf16_f32 v72, 0, v72
    v_cvt_pk_bf16_f32 v73, 0, v73
    v_cvt_pk_bf16_f32 v74, 0, v74
    v_cvt_pk_bf16_f32 v75, 0, v75
    v_mul_f32 v72, s46, v72
    v_mul_f32 v73, s46, v73
    v_cvt_pk_bf16_f32 v76, 0, v76
    s_waitcnt lgkmcnt(10)
    v_mfma_f32_32x32x16_bf16 v[88:103], v[36:39], a[12:15], v[88:103]
    ds_read_b64_tr_b16 v[36:37], v12 offset:49152
    ds_read_b64_tr_b16 v[38:39], v12 offset:51200
    v_cvt_pk_bf16_f32 v77, 0, v77
    v_mul_f32 v74, s46, v74
    v_mul_f32 v75, s46, v75
    v_cvt_pk_bf16_f32 v72, 0, v72
    v_cvt_pk_bf16_f32 v73, 0, v73
    v_cvt_pk_bf16_f32 v78, 0, v78
    v_cvt_pk_bf16_f32 v79, 0, v79
    s_waitcnt lgkmcnt(11)
    v_mfma_f32_32x32x16_bf16 v[88:103], v[40:43], a[16:19], v[88:103]
    ds_read_b64_tr_b16 v[40:41], v9 offset:53248
    ds_read_b64_tr_b16 v[42:43], v9 offset:55296
    v_mul_f32 v76, s46, v76
    v_mul_f32 v77, s46, v77
    v_cvt_pk_bf16_f32 v74, 0, v74
    v_cvt_pk_bf16_f32 v75, 0, v75
    v_max_f32 v141, v72, v73
    v_cvt_pk_bf16_f32 v80, 0, v80
    v_cvt_pk_bf16_f32 v81, 0, v81
    s_waitcnt lgkmcnt(12)
    v_mfma_f32_32x32x16_bf16 v[88:103], v[44:47], a[20:23], v[88:103]
    ds_read_b64_tr_b16 v[44:45], v10 offset:53248
    ds_read_b64_tr_b16 v[46:47], v10 offset:55296
    v_mul_f32 v78, s46, v78
    v_mul_f32 v79, s46, v79
    v_cvt_pk_bf16_f32 v76, 0, v76
    v_cvt_pk_bf16_f32 v77, 0, v77
    v_max3_f32 v141, v141, v74, v75
    v_cvt_pk_bf16_f32 v82, 0, v82
    v_cvt_pk_bf16_f32 v83, 0, v83
    s_waitcnt lgkmcnt(13)
    v_mfma_f32_32x32x16_bf16 v[88:103], v[48:51], a[24:27], v[88:103]
    ds_read_b64_tr_b16 v[48:49], v11 offset:53248
    ds_read_b64_tr_b16 v[50:51], v11 offset:55296
    v_mul_f32 v80, s46, v80
    v_mul_f32 v81, s46, v81
    v_cvt_pk_bf16_f32 v78, 0, v78
    v_cvt_pk_bf16_f32 v79, 0, v79
    v_max3_f32 v141, v141, v76, v77
    v_cvt_pk_bf16_f32 v84, 0, v84
    v_cvt_pk_bf16_f32 v85, 0, v85
    s_waitcnt lgkmcnt(14)
    v_mfma_f32_32x32x16_bf16 v[88:103], v[52:55], a[28:31], v[88:103]
    ds_read_b64_tr_b16 v[52:53], v12 offset:53248
    ds_read_b64_tr_b16 v[54:55], v12 offset:55296
    v_mul_f32 v82, s46, v82
    v_mul_f32 v83, s46, v83
    v_cvt_pk_bf16_f32 v80, 0, v80
    v_cvt_pk_bf16_f32 v81, 0, v81
    v_max3_f32 v141, v141, v78, v79
    v_cvt_pk_bf16_f32 v86, 0, v86
    v_cvt_pk_bf16_f32 v87, 0, v87
    s_waitcnt lgkmcnt(14)
    v_mfma_f32_32x32x16_bf16 a[32:47], v[24:27], v[56:59], a[32:47]
    ds_read_b64_tr_b16 v[24:25], v9 offset:57344
    ds_read_b64_tr_b16 v[26:27], v9 offset:59392
    v_mul_f32 v84, s46, v84
    v_mul_f32 v85, s46, v85
    v_cvt_pk_bf16_f32 v82, 0, v82
    v_cvt_pk_bf16_f32 v83, 0, v83
    v_max3_f32 v141, v141, v80, v81
    v_mul_f32 v86, s46, v86
    v_mul_f32 v87, s46, v87
    s_waitcnt lgkmcnt(14)
    v_mfma_f32_32x32x16_bf16 a[48:63], v[28:31], v[56:59], a[48:63]
    ds_read_b64_tr_b16 v[28:29], v10 offset:57344
    ds_read_b64_tr_b16 v[30:31], v10 offset:59392
    v_mfma_f32_16x16x32_bf16 v[148:151], v[144:147], v[56:59], v[148:151]
    v_cvt_pk_bf16_f32 v84, 0, v84
    v_cvt_pk_bf16_f32 v85, 0, v85
    v_max3_f32 v141, v141, v82, v83
    v_cvt_pk_bf16_f32 v86, 0, v86
    v_cvt_pk_bf16_f32 v87, 0, v87
    v_max3_f32 v141, v141, v84, v85
    v_max3_f32 v141, v141, v86, v87
    s_waitcnt lgkmcnt(14)
    v_mfma_f32_32x32x16_bf16 a[64:79], v[32:35], v[56:59], a[64:79]
    ds_read_b64_tr_b16 v[32:33], v11 offset:57344
    ds_read_b64_tr_b16 v[34:35], v11 offset:59392
    v_cvt_pk_bf16_f32 v88, 0, v88
    v_cvt_pk_bf16_f32 v89, 0, v89
    v_cvt_pk_bf16_f32 v90, 0, v90
    v_cvt_pk_bf16_f32 v91, 0, v91
    v_mul_f32 v88, s46, v88
    v_mul_f32 v89, s46, v89
    v_cvt_pk_bf16_f32 v92, 0, v92
    s_waitcnt lgkmcnt(14)
    v_mfma_f32_32x32x16_bf16 a[80:95], v[36:39], v[56:59], a[80:95]
    ds_read_b64_tr_b16 v[36:37], v12 offset:57344
    ds_read_b64_tr_b16 v[38:39], v12 offset:59392
    v_cvt_pk_bf16_f32 v93, 0, v93
    v_mul_f32 v90, s46, v90
    v_mul_f32 v91, s46, v91
    v_cvt_pk_bf16_f32 v88, 0, v88
    v_cvt_pk_bf16_f32 v89, 0, v89
    v_cvt_pk_bf16_f32 v94, 0, v94
    v_cvt_pk_bf16_f32 v95, 0, v95
    s_cmp_lt_u32 s5, 4
    s_cbranch_scc0 Lpr_33
    s_setprio 0
    s_branch Lpr_34
Lpr_33:
    s_setprio 1
Lpr_34:
    s_waitcnt lgkmcnt(14)
    v_mfma_f32_32x32x16_bf16 a[32:47], v[40:43], v[60:63], a[32:47]
    ds_read_b64_tr_b16 v[40:41], v9 offset:61440
    ds_read_b64_tr_b16 v[42:43], v9 offset:63488
    v_mul_f32 v92, s46, v92
    v_mul_f32 v93, s46, v93
    v_cvt_pk_bf16_f32 v90, 0, v90
    v_cvt_pk_bf16_f32 v91, 0, v91
    v_max3_f32 v141, v141, v88, v89
    v_cvt_pk_bf16_f32 v96, 0, v96
    v_cvt_pk_bf16_f32 v97, 0, v97
    s_waitcnt lgkmcnt(14)
    v_mfma_f32_32x32x16_bf16 a[48:63], v[44:47], v[60:63], a[48:63]
    ds_read_b64_tr_b16 v[44:45], v10 offset:61440
    ds_read_b64_tr_b16 v[46:47], v10 offset:63488
    v_mfma_f32_16x16x32_bf16 v[148:151], v[144:147], v[60:63], v[148:151]
    v_mul_f32 v94, s46, v94
    v_mul_f32 v95, s46, v95
    v_cvt_pk_bf16_f32 v92, 0, v92
    v_cvt_pk_bf16_f32 v93, 0, v93
    v_max3_f32 v141, v141, v90, v91
    v_cvt_pk_bf16_f32 v98, 0, v98
    v_cvt_pk_bf16_f32 v99, 0, v99
    s_waitcnt lgkmcnt(14)
    v_mfma_f32_32x32x16_bf16 a[64:79], v[48:51], v[60:63], a[64:79]
    ds_read_b64_tr_b16 v[48:49], v11 offset:61440
    ds_read_b64_tr_b16 v[50:51], v11 offset:63488
    v_mul_f32 v96, s46, v96
    v_mul_f32 v97, s46, v97
    v_cvt_pk_bf16_f32 v94, 0, v94
    v_cvt_pk_bf16_f32 v95, 0, v95
    v_max3_f32 v141, v141, v92, v93
    v_cvt_pk_bf16_f32 v100, 0, v100
    v_cvt_pk_bf16_f32 v101, 0, v101
    s_waitcnt lgkmcnt(14)
    v_mfma_f32_32x32x16_bf16 a[80:95], v[52:55], v[60:63], a[80:95]
    ds_read_b64_tr_b16 v[52:53], v12 offset:61440
    ds_read_b64_tr_b16 v[54:55], v12 offset:63488
    v_mul_f32 v98, s46, v98
    v_mul_f32 v99, s46, v99
    v_cvt_pk_bf16_f32 v96, 0, v96
    v_cvt_pk_bf16_f32 v97, 0, v97
    v_max3_f32 v141, v141, v94, v95
    v_cvt_pk_bf16_f32 v102, 0, v102
    v_cvt_pk_bf16_f32 v103, 0, v103
    s_waitcnt lgkmcnt(14)
    v_mfma_f32_32x32x16_bf16 a[32:47], v[24:27], v[64:67], a[32:47]
    ds_read_b128 v[24:27], v1 offset:16384
    v_mul_f32 v100, s46, v100
    v_mul_f32 v101, s46, v101
    v_cvt_pk_bf16_f32 v98, 0, v98
    v_cvt_pk_bf16_f32 v99, 0, v99
    v_max3_f32 v141, v141, v96, v97
    v_mul_f32 v102, s46, v102
    v_mul_f32 v103, s46, v103
    s_waitcnt lgkmcnt(13)
    v_mfma_f32_32x32x16_bf16 a[48:63], v[28:31], v[64:67], a[48:63]
    ds_read_b128 v[28:31], v2 offset:16384
    v_mfma_f32_16x16x32_bf16 v[148:151], v[144:147], v[64:67], v[148:151]
    v_cvt_pk_bf16_f32 v100, 0, v100
    v_cvt_pk_bf16_f32 v101, 0, v101
    v_max3_f32 v141, v141, v98, v99
    v_cvt_pk_bf16_f32 v102, 0, v102
    v_cvt_pk_bf16_f32 v103, 0, v103
    v_max3_f32 v141, v141, v100, v101
    v_max3_f32 v141, v141, v102, v103
    v_cmp_gt_f32 vcc, v141, v15
    s_cbranch_vccnz LrareA_27
LbackA_28:
    s_waitcnt lgkmcnt(12)
    v_mfma_f32_32x32x16_bf16 a[64:79], v[32:35], v[64:67], a[64:79]
    ds_read_b128 v[32:35], v3 offset:16384
    v_fma_f32 v72, v72, s44, v16
    v_fma_f32 v73, v73, s44, v16
    v_fma_f32 v74, v74, s44, v16
    v_fma_f32 v75, v75, s44, v16
    v_exp_f32 v72, v72
    s_waitcnt lgkmcnt(11)
    v_mfma_f32_32x32x16_bf16 a[80:95], v[36:39], v[64:67], a[80:95]
    ds_read_b128 v[36:39], v4 offset:16384
    v_exp_f32 v73, v73
    v_fma_f32 v76, v76, s44, v16
    v_fma_f32 v77, v77, s44, v16
    v_exp_f32 v74, v74
    v_exp_f32 v75, v75
    s_waitcnt lgkmcnt(10)
    v_mfma_f32_32x32x16_bf16 a[32:47], v[40:43], v[68:71], a[32:47]
    ds_read_b128 v[40:43], v5 offset:16384
    v_cvt_pk_bf16_f32 v56, v72, v73
    v_fma_f32 v78, v78, s44, v16
    v_fma_f32 v79, v79, s44, v16
    v_exp_f32 v76, v76
    v_exp_f32 v77, v77
    s_waitcnt lgkmcnt(9)
    v_mfma_f32_32x32x16_bf16 a[48:63], v[44:47], v[68:71], a[48:63]
    ds_read_b128 v[44:47], v6 offset:16384
    v_mfma_f32_16x16x32_bf16 v[148:151], v[144:147], v[68:71], v[148:151]
    v_cvt_pk_bf16_f32 v57, v74, v75
    v_fma_f32 v80, v80, s44, v16
    v_fma_f32 v81, v81, s44, v16
    v_exp_f32 v78, v78
    v_exp_f32 v79, v79
    s_waitcnt lgkmcnt(8)
    v_mfma_f32_32x32x16_bf16 a[64:79], v[48:51], v[68:71], a[64:79]
    ds_read_b128 v[48:51], v7 offset:16384
    v_cvt_pk_bf16_f32 v58, v76, v77
    v_fma_f32 v82, v82, s44, v16
    v_fma_f32 v83, v83, s44, v16
    v_exp_f32 v80, v80
    v_exp_f32 v81, v81
    s_waitcnt lgkmcnt(7)
    v_mfma_f32_32x32x16_bf16 a[80:95], v[52:55], v[68:71], a[80:95]
    ds_read_b128 v[52:55], v8 offset:16384
    v_cvt_pk_bf16_f32 v59, v78, v79
    v_fma_f32 v84, v84, s44, v16
    v_fma_f32 v85, v85, s44, v16
    v_exp_f32 v82, v82
    v_exp_f32 v83, v83
    s_cmp_lg_u32 s35, 0
    s_cbranch_scc1 LrareB_29
LbackB_30:
    s_sub_u32 s32, s32, 1
    s_cmp_lg_u32 s32, 0
    s_cbranch_scc1 Lk2_loop
    s_waitcnt vmcnt(4)
    s_barrier
    s_waitcnt lgkmcnt(7)
    v_mfma_f32_32x32x16_bf16 v[104:119], v[24:27], a[0:3], 0
    ds_read_b128 v[24:27], v1 offset:24576
    s_cmp_lt_u32 s5, 4
    s_cbranch_scc0 Lpr_39
    s_setprio 2
    s_branch Lpr_40
Lpr_39:
    s_setprio 1
Lpr_40:
    v_cvt_pk_bf16_f32 v60, v80, v81
    v_fma_f32 v86, v86, s44, v16
    v_fma_f32 v87, v87, s44, v16
    v_exp_f32 v84, v84
    v_exp_f32 v85, v85
    s_waitcnt lgkmcnt(7)
    v_mfma_f32_32x32x16_bf16 v[104:119], v[28:31], a[4:7], v[104:119]
    ds_read_b128 v[28:31], v2 offset:24576
    v_cvt_pk_bf16_f32 v61, v82, v83
    v_fma_f32 v88, v88, s44, v16
    v_fma_f32 v89, v89, s44, v16
    v_exp_f32 v86, v86
    v_exp_f32 v87, v87
    s_waitcnt lgkmcnt(7)
    v_mfma_f32_32x32x16_bf16 v[104:119], v[32:35], a[8:11], v[104:119]
    ds_read_b128 v[32:35], v3 offset:24576
    v_cvt_pk_bf16_f32 v62, v84, v85
    v_fma_f32 v90, v90, s44, v16
    v_fma_f32 v91, v91, s44, v16
    v_exp_f32 v88, v88
    v_exp_f32 v89, v89
    s_waitcnt lgkmcnt(7)
    v_mfma_f32_32x32x16_bf16 v[104:119], v[36:39], a[12:15], v[104:119]
    ds_read_b128 v[36:39], v4 offset:24576
    v_cvt_pk_bf16_f32 v63, v86, v87
    v_fma_f32 v92, v92, s44, v16
    v_fma_f32 v93, v93, s44, v16
    v_exp_f32 v90, v90
    v_exp_f32 v91, v91
    s_waitcnt lgkmcnt(7)
    v_mfma_f32_32x32x16_bf16 v[104:119], v[40:43], a[16:19], v[104:119]
    ds_read_b128 v[40:43], v5 offset:24576
    v_cvt_pk_bf16_f32 v64, v88, v89
    v_fma_f32 v94, v94, s44, v16
    v_fma_f32 v95, v95, s44, v16
    v_exp_f32 v92, v92
    v_exp_f32 v93, v93
    s_waitcnt lgkmcnt(7)
    v_mfma_f32_32x32x16_bf16 v[104:119], v[44:47], a[20:23], v[104:119]
    ds_read_b128 v[44:47], v6 offset:24576
    v_cvt_pk_bf16_f32 v65, v90, v91
    v_fma_f32 v96, v96, s44, v16
    v_fma_f32 v97, v97, s44, v16
    v_exp_f32 v94, v94
    v_exp_f32 v95, v95
    s_waitcnt lgkmcnt(7)
    v_mfma_f32_32x32x16_bf16 v[104:119], v[48:51], a[24:27], v[104:119]
    ds_read_b128 v[48:51], v7 offset:24576
    v_cvt_pk_bf16_f32 v66, v92, v93
    v_fma_f32 v98, v98, s44, v16
    v_fma_f32 v99, v99, s44, v16
    v_exp_f32 v96, v96
    v_exp_f32 v97, v97
    s_add_u32 m0, s6, 114688
    s_nop 0
    buffer_load_dwordx4 v14, s[12:15], s29 offen lds
    s_add_u32 m0, s6, 122880
    s_add_u32 s30, s29, 8192
    buffer_load_dwordx4 v14, s[12:15], s30 offen lds
    s_add_u32 s29, s29, 16384
    s_waitcnt lgkmcnt(7)
    v_mfma_f32_32x32x16_bf16 v[104:119], v[52:55], a[28:31], v[104:119]
    ds_read_b128 v[52:55], v8 offset:24576
    v_cvt_pk_bf16_f32 v67, v94, v95
    v_fma_f32 v100, v100, s44, v16
    v_fma_f32 v101, v101, s44, v16
    v_exp_f32 v98, v98
    v_exp_f32 v99, v99
    s_waitcnt lgkmcnt(7)
    v_mfma_f32_32x32x16_bf16 v[120:135], v[24:27], a[0:3], 0
    ds_read_b64_tr_b16 v[24:25], v9 offset:0
    ds_read_b64_tr_b16 v[26:27], v9 offset:2048
    v_cvt_pk_bf16_f32 v68, v96, v97
    v_fma_f32 v102, v102, s44, v16
    v_fma_f32 v103, v103, s44, v16
    v_exp_f32 v100, v100
    v_exp_f32 v101, v101
    s_waitcnt lgkmcnt(8)
    v_mfma_f32_32x32x16_bf16 v[120:135], v[28:31], a[4:7], v[120:135]
    ds_read_b64_tr_b16 v[28:29], v10 offset:0
    ds_read_b64_tr_b16 v[30:31], v10 offset:2048
    v_cvt_pk_bf16_f32 v69, v98, v99
    v_exp_f32 v102, v102
    v_exp_f32 v103, v103
    v_cvt_pk_bf16_f32 v70, v100, v101
    v_cvt_pk_bf16_f32 v71, v102, v103
    v_lshlrev_b32 v153, 3, v142
    buffer_load_dword v152, v153, s[72:75], s77 offen
    s_waitcnt lgkmcnt(9)
    v_mfma_f32_32x32x16_bf16 v[120:135], v[32:35], a[8:11], v[120:135]
    ds_read_b64_tr_b16 v[32:33], v11 offset:0
    ds_read_b64_tr_b16 v[34:35], v11 offset:2048
    v_cvt_pk_bf16_f32 v104, 0, v104
    v_cvt_pk_bf16_f32 v105, 0, v105
    v_cvt_pk_bf16_f32 v106, 0, v106
    v_cvt_pk_bf16_f32 v107, 0, v107
    v_mul_f32 v104, s46, v104
    v_mul_f32 v105, s46, v105
    v_cvt_pk_bf16_f32 v108, 0, v108
    s_waitcnt lgkmcnt(10)
    v_mfma_f32_32x32x16_bf16 v[120:135], v[36:39], a[12:15], v[120:135]
    ds_read_b64_tr_b16 v[36:37], v12 offset:0
    ds_read_b64_tr_b16 v[38:39], v12 offset:2048
    v_cvt_pk_bf16_f32 v109, 0, v109
    v_mul_f32 v106, s46, v106
    v_mul_f32 v107, s46, v107
    v_cvt_pk_bf16_f32 v104, 0, v104
    v_cvt_pk_bf16_f32 v105, 0, v105
    v_cvt_pk_bf16_f32 v110, 0, v110
    v_cvt_pk_bf16_f32 v111, 0, v111
    s_waitcnt lgkmcnt(11)
    v_mfma_f32_32x32x16_bf16 v[120:135], v[40:43], a[16:19], v[120:135]
    ds_read_b64_tr_b16 v[40:41], v9 offset:4096
    ds_read_b64_tr_b16 v[42:43], v9 offset:6144
    v_mul_f32 v108, s46, v108
    v_mul_f32 v109, s46, v109
    v_cvt_pk_bf16_f32 v106, 0, v106
    v_cvt_pk_bf16_f32 v107, 0, v107
    v_max_f32 v141, v104, v105
    v_cvt_pk_bf16_f32 v112, 0, v112
    v_cvt_pk_bf16_f32 v113, 0, v113
    s_waitcnt lgkmcnt(12)
    v_mfma_f32_32x32x16_bf16 v[120:135], v[44:47], a[20:23], v[120:135]
    ds_read_b64_tr_b16 v[44:45], v10 offset:4096
    ds_read_b64_tr_b16 v[46:47], v10 offset:6144
    v_mul_f32 v110, s46, v110
    v_mul_f32 v111, s46, v111
    v_cvt_pk_bf16_f32 v108, 0, v108
    v_cvt_pk_bf16_f32 v109, 0, v109
    v_max3_f32 v141, v141, v106, v107
    v_cvt_pk_bf16_f32 v114, 0, v114
    v_cvt_pk_bf16_f32 v115, 0, v115
    s_waitcnt lgkmcnt(13)
    v_mfma_f32_32x32x16_bf16 v[120:135], v[48:51], a[24:27], v[120:135]
    ds_read_b64_tr_b16 v[48:49], v11 offset:4096
    ds_read_b64_tr_b16 v[50:51], v11 offset:6144
    v_mul_f32 v112, s46, v112
    v_mul_f32 v113, s46, v113
    v_cvt_pk_bf16_f32 v110, 0, v110
    v_cvt_pk_bf16_f32 v111, 0, v111
    v_max3_f32 v141, v141, v108, v109
    v_cvt_pk_bf16_f32 v116, 0, v116
    v_cvt_pk_bf16_f32 v117, 0, v117
    s_waitcnt lgkmcnt(14)
    v_mfma_f32_32x32x16_bf16 v[120:135], v[52:55], a[28:31], v[120:135]
    ds_read_b64_tr_b16 v[52:53], v12 offset:4096
    ds_read_b64_tr_b16 v[54:55], v12 offset:6144
    v_mul_f32 v114, s46, v114
    v_mul_f32 v115, s46, v115
    v_cvt_pk_bf16_f32 v112, 0, v112
    v_cvt_pk_bf16_f32 v113, 0, v113
    v_max3_f32 v141, v141, v110, v111
    v_cvt_pk_bf16_f32 v118, 0, v118
    v_cvt_pk_bf16_f32 v119, 0, v119
    s_waitcnt lgkmcnt(14)
    v_mfma_f32_32x32x16_bf16 a[32:47], v[24:27], v[56:59], a[32:47]
    ds_read_b64_tr_b16 v[24:25], v9 offset:8192
    ds_read_b64_tr_b16 v[26:27], v9 offset:10240
    v_mul_f32 v116, s46, v116
    v_mul_f32 v117, s46, v117
    v_cvt_pk_bf16_f32 v114, 0, v114
    v_cvt_pk_bf16_f32 v115, 0, v115
    v_max3_f32 v141, v141, v112, v113
    v_mul_f32 v118, s46, v118
    v_mul_f32 v119, s46, v119
    s_waitcnt lgkmcnt(14)
    v_mfma_f32_32x32x16_bf16 a[48:63], v[28:31], v[56:59], a[48:63]
    ds_read_b64_tr_b16 v[28:29], v10 offset:8192
    ds_read_b64_tr_b16 v[30:31], v10 offset:10240
    v_mfma_f32_16x16x32_bf16 v[148:151], v[144:147], v[56:59], v[148:151]
    v_cvt_pk_bf16_f32 v116, 0, v116
    v_cvt_pk_bf16_f32 v117, 0, v117
    v_max3_f32 v141, v141, v114, v115
    v_cvt_pk_bf16_f32 v118, 0, v118
    v_cvt_pk_bf16_f32 v119, 0, v119
    v_max3_f32 v141, v141, v116, v117
    v_max3_f32 v141, v141, v118, v119
    s_waitcnt lgkmcnt(14)
    v_mfma_f32_32x32x16_bf16 a[64:79], v[32:35], v[56:59], a[64:79]
    ds_read_b64_tr_b16 v[32:33], v11 offset:8192
    ds_read_b64_tr_b16 v[34:35], v11 offset:10240
    v_cvt_pk_bf16_f32 v120, 0, v120
    v_cvt_pk_bf16_f32 v121, 0, v121
    v_cvt_pk_bf16_f32 v122, 0, v122
    v_cvt_pk_bf16_f32 v123, 0, v123
    v_mul_f32 v120, s46, v120
    v_mul_f32 v121, s46, v121
    v_cvt_pk_bf16_f32 v124, 0, v124
    s_waitcnt lgkmcnt(14)
    v_mfma_f32_32x32x16_bf16 a[80:95], v[36:39], v[56:59], a[80:95]
    ds_read_b64_tr_b16 v[36:37], v12 offset:8192
    ds_read_b64_tr_b16 v[38:39], v12 offset:10240
    v_cvt_pk_bf16_f32 v125, 0, v125
    v_mul_f32 v122, s46, v122
    v_mul_f32 v123, s46, v123
    v_cvt_pk_bf16_f32 v120, 0, v120
    v_cvt_pk_bf16_f32 v121, 0, v121
    v_cvt_pk_bf16_f32 v126, 0, v126
    v_cvt_pk_bf16_f32 v127, 0, v127
    s_cmp_lt_u32 s5, 4
    s_cbranch_scc0 Lpr_41
    s_setprio 0
    s_branch Lpr_42
Lpr_41:
    s_setprio 1
Lpr_42:
    s_waitcnt lgkmcnt(14)
    v_mfma_f32_32x32x16_bf16 a[32:47], v[40:43], v[60:63], a[32:47]
    ds_read_b64_tr_b16 v[40:41], v9 offset:12288
    ds_read_b64_tr_b16 v[42:43], v9 offset:14336
    v_mul_f32 v124, s46, v124
    v_mul_f32 v125, s46, v125
    v_cvt_pk_bf16_f32 v122, 0, v122
    v_cvt_pk_bf16_f32 v123, 0, v123
    v_max3_f32 v141, v141, v120, v121
    v_cvt_pk_bf16_f32 v128, 0, v128
    v_cvt_pk_bf16_f32 v129, 0, v129
    s_waitcnt lgkmcnt(14)
    v_mfma_f32_32x32x16_bf16 a[48:63], v[44:47], v[60:63], a[48:63]
    ds_read_b64_tr_b16 v[44:45], v10 offset:12288
    ds_read_b64_tr_b16 v[46:47], v10 offset:14336
    v_mfma_f32_16x16x32_bf16 v[148:151], v[144:147], v[60:63], v[148:151]
    v_mul_f32 v126, s46, v126
    v_mul_f32 v127, s46, v127
    v_cvt_pk_bf16_f32 v124, 0, v124
    v_cvt_pk_bf16_f32 v125, 0, v125
    v_max3_f32 v141, v141, v122, v123
    v_cvt_pk_bf16_f32 v130, 0, v130
    v_cvt_pk_bf16_f32 v131, 0, v131
    s_waitcnt lgkmcnt(14)
    v_mfma_f32_32x32x16_bf16 a[64:79], v[48:51], v[60:63], a[64:79]
    ds_read_b64_tr_b16 v[48:49], v11 offset:12288
    ds_read_b64_tr_b16 v[50:51], v11 offset:14336
    v_mul_f32 v128, s46, v128
    v_mul_f32 v129, s46, v129
    v_cvt_pk_bf16_f32 v126, 0, v126
    v_cvt_pk_bf16_f32 v127, 0, v127
    v_max3_f32 v141, v141, v124, v125
    v_cvt_pk_bf16_f32 v132, 0, v132
    v_cvt_pk_bf16_f32 v133, 0, v133
    s_waitcnt lgkmcnt(14)
    v_mfma_f32_32x32x16_bf16 a[80:95], v[52:55], v[60:63], a[80:95]
    ds_read_b64_tr_b16 v[52:53], v12 offset:12288
    ds_read_b64_tr_b16 v[54:55], v12 offset:14336
    v_mul_f32 v130, s46, v130
    v_mul_f32 v131, s46, v131
    v_cvt_pk_bf16_f32 v128, 0, v128
    v_cvt_pk_bf16_f32 v129, 0, v129
    v_max3_f32 v141, v141, v126, v127
    v_cvt_pk_bf16_f32 v134, 0, v134
    v_cvt_pk_bf16_f32 v135, 0, v135
    s_waitcnt lgkmcnt(14)
    v_mfma_f32_32x32x16_bf16 a[32:47], v[24:27], v[64:67], a[32:47]
    ds_read_b128 v[24:27], v1 offset:32768
    v_mul_f32 v132, s46, v132
    v_mul_f32 v133, s46, v133
    v_cvt_pk_bf16_f32 v130, 0, v130
    v_cvt_pk_bf16_f32 v131, 0, v131
    v_max3_f32 v141, v141, v128, v129
    v_mul_f32 v134, s46, v134
    v_mul_f32 v135, s46, v135
    s_waitcnt lgkmcnt(13)
    v_mfma_f32_32x32x16_bf16 a[48:63], v[28:31], v[64:67], a[48:63]
    ds_read_b128 v[28:31], v2 offset:32768
    v_mfma_f32_16x16x32_bf16 v[148:151], v[144:147], v[64:67], v[148:151]
    v_cvt_pk_bf16_f32 v132, 0, v132
    v_cvt_pk_bf16_f32 v133, 0, v133
    v_max3_f32 v141, v141, v130, v131
    v_cvt_pk_bf16_f32 v134, 0, v134
    v_cvt_pk_bf16_f32 v135, 0, v135
    v_max3_f32 v141, v141, v132, v133
    v_max3_f32 v141, v141, v134, v135
    v_cmp_gt_f32 vcc, v141, v15
    s_cbranch_vccnz LrareA_35
LbackA_36:
    s_waitcnt lgkmcnt(12)
    v_mfma_f32_32x32x16_bf16 a[64:79], v[32:35], v[64:67], a[64:79]
    ds_read_b128 v[32:35], v3 offset:32768
    v_fma_f32 v104, v104, s44, v16
    v_fma_f32 v105, v105, s44, v16
    v_fma_f32 v106, v106, s44, v16
    v_fma_f32 v107, v107, s44, v16
    v_exp_f32 v104, v104
    s_waitcnt lgkmcnt(11)
    v_mfma_f32_32x32x16_bf16 a[80:95], v[36:39], v[64:67], a[80:95]
    ds_read_b128 v[36:39], v4 offset:32768
    v_exp_f32 v105, v105
    v_fma_f32 v108, v108, s44, v16
    v_fma_f32 v109, v109, s44, v16
    v_exp_f32 v106, v106
    v_exp_f32 v107, v107
    s_waitcnt lgkmcnt(10)
    v_mfma_f32_32x32x16_bf16 a[32:47], v[40:43], v[68:71], a[32:47]
    ds_read_b128 v[40:43], v5 offset:32768
    v_cvt_pk_bf16_f32 v56, v104, v105
    v_fma_f32 v110, v110, s44, v16
    v_fma_f32 v111, v111, s44, v16
    v_exp_f32 v108, v108
    v_exp_f32 v109, v109
    s_waitcnt lgkmcnt(9)
    v_mfma_f32_32x32x16_bf16 a[48:63], v[44:47], v[68:71], a[48:63]
    ds_read_b128 v[44:47], v6 offset:32768
    v_mfma_f32_16x16x32_bf16 v[148:151], v[144:147], v[68:71], v[148:151]
    v_cvt_pk_bf16_f32 v57, v106, v107
    v_fma_f32 v112, v112, s44, v16
    v_fma_f32 v113, v113, s44, v16
    v_exp_f32 v110, v110
    v_exp_f32 v111, v111
    s_waitcnt lgkmcnt(8)
    v_mfma_f32_32x32x16_bf16 a[64:79], v[48:51], v[68:71], a[64:79]
    ds_read_b128 v[48:51], v7 offset:32768
    v_cvt_pk_bf16_f32 v58, v108, v109
    v_fma_f32 v114, v114, s44, v16
    v_fma_f32 v115, v115, s44, v16
    v_exp_f32 v112, v112
    v_exp_f32 v113, v113
    s_waitcnt lgkmcnt(7)
    v_mfma_f32_32x32x16_bf16 a[80:95], v[52:55], v[68:71], a[80:95]
    ds_read_b128 v[52:55], v8 offset:32768
    v_cvt_pk_bf16_f32 v59, v110, v111
    v_fma_f32 v116, v116, s44, v16
    v_fma_f32 v117, v117, s44, v16
    v_exp_f32 v114, v114
    v_exp_f32 v115, v115
    s_cmp_lg_u32 s35, 0
    s_cbranch_scc1 LrareB_37
LbackB_38:
    s_waitcnt vmcnt(3)
    s_barrier
    s_waitcnt lgkmcnt(7)
    v_mfma_f32_32x32x16_bf16 v[72:87], v[24:27], a[0:3], 0
    ds_read_b128 v[24:27], v1 offset:40960
    s_cmp_lt_u32 s5, 4
    s_cbranch_scc0 Lpr_47
    s_setprio 2
    s_branch Lpr_48
Lpr_47:
    s_setprio 1
Lpr_48:
    v_cvt_pk_bf16_f32 v60, v112, v113
    v_fma_f32 v118, v118, s44, v16
    v_fma_f32 v119, v119, s44, v16
    v_exp_f32 v116, v116
    v_exp_f32 v117, v117
    s_waitcnt lgkmcnt(7)
    v_mfma_f32_32x32x16_bf16 v[72:87], v[28:31], a[4:7], v[72:87]
    ds_read_b128 v[28:31], v2 offset:40960
    v_cvt_pk_bf16_f32 v61, v114, v115
    v_fma_f32 v120, v120, s44, v16
    v_fma_f32 v121, v121, s44, v16
    v_exp_f32 v118, v118
    v_exp_f32 v119, v119
    s_waitcnt lgkmcnt(7)
    v_mfma_f32_32x32x16_bf16 v[72:87], v[32:35], a[8:11], v[72:87]
    ds_read_b128 v[32:35], v3 offset:40960
    v_cvt_pk_bf16_f32 v62, v116, v117
    v_fma_f32 v122, v122, s44, v16
    v_fma_f32 v123, v123, s44, v16
    v_exp_f32 v120, v120
    v_exp_f32 v121, v121
    s_waitcnt lgkmcnt(7)
    v_mfma_f32_32x32x16_bf16 v[72:87], v[36:39], a[12:15], v[72:87]
    ds_read_b128 v[36:39], v4 offset:40960
    v_cvt_pk_bf16_f32 v63, v118, v119
    v_fma_f32 v124, v124, s44, v16
    v_fma_f32 v125, v125, s44, v16
    v_exp_f32 v122, v122
    v_exp_f32 v123, v123
    s_waitcnt lgkmcnt(7)
    v_mfma_f32_32x32x16_bf16 v[72:87], v[40:43], a[16:19], v[72:87]
    ds_read_b128 v[40:43], v5 offset:40960
    v_cvt_pk_bf16_f32 v64, v120, v121
    v_fma_f32 v126, v126, s44, v16
    v_fma_f32 v127, v127, s44, v16
    v_exp_f32 v124, v124
    v_exp_f32 v125, v125
    s_waitcnt lgkmcnt(7)
    v_mfma_f32_32x32x16_bf16 v[72:87], v[44:47], a[20:23], v[72:87]
    ds_read_b128 v[44:47], v6 offset:40960
    v_cvt_pk_bf16_f32 v65, v122, v123
    v_fma_f32 v128, v128, s44, v16
    v_fma_f32 v129, v129, s44, v16
    v_exp_f32 v126, v126
    v_exp_f32 v127, v127
    s_waitcnt lgkmcnt(7)
    v_mfma_f32_32x32x16_bf16 v[72:87], v[48:51], a[24:27], v[72:87]
    ds_read_b128 v[48:51], v7 offset:40960
    v_cvt_pk_bf16_f32 v66, v124, v125
    v_fma_f32 v130, v130, s44, v16
    v_fma_f32 v131, v131, s44, v16
    v_exp_f32 v128, v128
    v_exp_f32 v129, v129
    s_waitcnt lgkmcnt(7)
    v_mfma_f32_32x32x16_bf16 v[72:87], v[52:55], a[28:31], v[72:87]
    ds_read_b128 v[52:55], v8 offset:40960
    v_cvt_pk_bf16_f32 v67, v126, v127
    v_fma_f32 v132, v132, s44, v16
    v_fma_f32 v133, v133, s44, v16
    v_exp_f32 v130, v130
    v_exp_f32 v131, v131
    s_waitcnt lgkmcnt(7)
    v_mfma_f32_32x32x16_bf16 v[88:103], v[24:27], a[0:3], 0
    ds_read_b64_tr_b16 v[24:25], v9 offset:16384
    ds_read_b64_tr_b16 v[26:27], v9 offset:18432
    v_cvt_pk_bf16_f32 v68, v128, v129
    v_fma_f32 v134, v134, s44, v16
    v_fma_f32 v135, v135, s44, v16
    v_exp_f32 v132, v132
    v_exp_f32 v133, v133
    s_waitcnt lgkmcnt(8)
    v_mfma_f32_32x32x16_bf16 v[88:103], v[28:31], a[4:7], v[88:103]
    ds_read_b64_tr_b16 v[28:29], v10 offset:16384
    ds_read_b64_tr_b16 v[30:31], v10 offset:18432
    v_cvt_pk_bf16_f32 v69, v130, v131
    v_exp_f32 v134, v134
    v_exp_f32 v135, v135
    v_cvt_pk_bf16_f32 v70, v132, v133
    v_cvt_pk_bf16_f32 v71, v134, v135
    s_waitcnt lgkmcnt(9)
    v_mfma_f32_32x32x16_bf16 v[88:103], v[32:35], a[8:11], v[88:103]
    ds_read_b64_tr_b16 v[32:33], v11 offset:16384
    ds_read_b64_tr_b16 v[34:35], v11 offset:18432
    v_cvt_pk_bf16_f32 v72, 0, v72
    v_cvt_pk_bf16_f32 v73, 0, v73
    v_cvt_pk_bf16_f32 v74, 0, v74
    v_cvt_pk_bf16_f32 v75, 0, v75
    v_mul_f32 v72, s46, v72
    v_mul_f32 v73, s46, v73
    v_cvt_pk_bf16_f32 v76, 0, v76
    s_waitcnt lgkmcnt(10)
    v_mfma_f32_32x32x16_bf16 v[88:103], v[36:39], a[12:15], v[88:103]
    ds_read_b64_tr_b16 v[36:37], v12 offset:16384
    ds_read_b64_tr_b16 v[38:39], v12 offset:18432
    v_cvt_pk_bf16_f32 v77, 0, v77
    v_mul_f32 v74, s46, v74
    v_mul_f32 v75, s46, v75
    v_cvt_pk_bf16_f32 v72, 0, v72
    v_cvt_pk_bf16_f32 v73, 0, v73
    v_cvt_pk_bf16_f32 v78, 0, v78
    v_cvt_pk_bf16_f32 v79, 0, v79
    s_waitcnt lgkmcnt(11)
    v_mfma_f32_32x32x16_bf16 v[88:103], v[40:43], a[16:19], v[88:103]
    ds_read_b64_tr_b16 v[40:41], v9 offset:20480
    ds_read_b64_tr_b16 v[42:43], v9 offset:22528
    v_mul_f32 v76, s46, v76
    v_mul_f32 v77, s46, v77
    v_cvt_pk_bf16_f32 v74, 0, v74
    v_cvt_pk_bf16_f32 v75, 0, v75
    v_max_f32 v141, v72, v73
    v_cvt_pk_bf16_f32 v80, 0, v80
    v_cvt_pk_bf16_f32 v81, 0, v81
    s_waitcnt lgkmcnt(12)
    v_mfma_f32_32x32x16_bf16 v[88:103], v[44:47], a[20:23], v[88:103]
    ds_read_b64_tr_b16 v[44:45], v10 offset:20480
    ds_read_b64_tr_b16 v[46:47], v10 offset:22528
    v_mul_f32 v78, s46, v78
    v_mul_f32 v79, s46, v79
    v_cvt_pk_bf16_f32 v76, 0, v76
    v_cvt_pk_bf16_f32 v77, 0, v77
    v_max3_f32 v141, v141, v74, v75
    v_cvt_pk_bf16_f32 v82, 0, v82
    v_cvt_pk_bf16_f32 v83, 0, v83
    s_waitcnt lgkmcnt(13)
    v_mfma_f32_32x32x16_bf16 v[88:103], v[48:51], a[24:27], v[88:103]
    ds_read_b64_tr_b16 v[48:49], v11 offset:20480
    ds_read_b64_tr_b16 v[50:51], v11 offset:22528
    v_mul_f32 v80, s46, v80
    v_mul_f32 v81, s46, v81
    v_cvt_pk_bf16_f32 v78, 0, v78
    v_cvt_pk_bf16_f32 v79, 0, v79
    v_max3_f32 v141, v141, v76, v77
    v_cvt_pk_bf16_f32 v84, 0, v84
    v_cvt_pk_bf16_f32 v85, 0, v85
    s_waitcnt lgkmcnt(14)
    v_mfma_f32_32x32x16_bf16 v[88:103], v[52:55], a[28:31], v[88:103]
    ds_read_b64_tr_b16 v[52:53], v12 offset:20480
    ds_read_b64_tr_b16 v[54:55], v12 offset:22528
    v_mul_f32 v82, s46, v82
    v_mul_f32 v83, s46, v83
    v_cvt_pk_bf16_f32 v80, 0, v80
    v_cvt_pk_bf16_f32 v81, 0, v81
    v_max3_f32 v141, v141, v78, v79
    v_cvt_pk_bf16_f32 v86, 0, v86
    v_cvt_pk_bf16_f32 v87, 0, v87
    s_waitcnt lgkmcnt(14)
    v_mfma_f32_32x32x16_bf16 a[32:47], v[24:27], v[56:59], a[32:47]
    ds_read_b64_tr_b16 v[24:25], v9 offset:24576
    ds_read_b64_tr_b16 v[26:27], v9 offset:26624
    v_mul_f32 v84, s46, v84
    v_mul_f32 v85, s46, v85
    v_cvt_pk_bf16_f32 v82, 0, v82
    v_cvt_pk_bf16_f32 v83, 0, v83
    v_max3_f32 v141, v141, v80, v81
    v_mul_f32 v86, s46, v86
    v_mul_f32 v87, s46, v87
    s_waitcnt lgkmcnt(14)
    v_mfma_f32_32x32x16_bf16 a[48:63], v[28:31], v[56:59], a[48:63]
    ds_read_b64_tr_b16 v[28:29], v10 offset:24576
    ds_read_b64_tr_b16 v[30:31], v10 offset:26624
    v_mfma_f32_16x16x32_bf16 v[148:151], v[144:147], v[56:59], v[148:151]
    v_cvt_pk_bf16_f32 v84, 0, v84
    v_cvt_pk_bf16_f32 v85, 0, v85
    v_max3_f32 v141, v141, v82, v83
    v_cvt_pk_bf16_f32 v86, 0, v86
    v_cvt_pk_bf16_f32 v87, 0, v87
    v_max3_f32 v141, v141, v84, v85
    v_max3_f32 v141, v141, v86, v87
    s_waitcnt lgkmcnt(14)
    v_mfma_f32_32x32x16_bf16 a[64:79], v[32:35], v[56:59], a[64:79]
    ds_read_b64_tr_b16 v[32:33], v11 offset:24576
    ds_read_b64_tr_b16 v[34:35], v11 offset:26624
    v_cvt_pk_bf16_f32 v88, 0, v88
    v_cvt_pk_bf16_f32 v89, 0, v89
    v_cvt_pk_bf16_f32 v90, 0, v90
    v_cvt_pk_bf16_f32 v91, 0, v91
    v_mul_f32 v88, s46, v88
    v_mul_f32 v89, s46, v89
    v_cvt_pk_bf16_f32 v92, 0, v92
    s_waitcnt lgkmcnt(14)
    v_mfma_f32_32x32x16_bf16 a[80:95], v[36:39], v[56:59], a[80:95]
    ds_read_b64_tr_b16 v[36:37], v12 offset:24576
    ds_read_b64_tr_b16 v[38:39], v12 offset:26624
    v_cvt_pk_bf16_f32 v93, 0, v93
    v_mul_f32 v90, s46, v90
    v_mul_f32 v91, s46, v91
    v_cvt_pk_bf16_f32 v88, 0, v88
    v_cvt_pk_bf16_f32 v89, 0, v89
    v_cvt_pk_bf16_f32 v94, 0, v94
    v_cvt_pk_bf16_f32 v95, 0, v95
    s_cmp_lt_u32 s5, 4
    s_cbranch_scc0 Lpr_49
    s_setprio 0
    s_branch Lpr_50
Lpr_49:
    s_setprio 1
Lpr_50:
    s_waitcnt lgkmcnt(14)
    v_mfma_f32_32x32x16_bf16 a[32:47], v[40:43], v[60:63], a[32:47]
    ds_read_b64_tr_b16 v[40:41], v9 offset:28672
    ds_read_b64_tr_b16 v[42:43], v9 offset:30720
    v_mul_f32 v92, s46, v92
    v_mul_f32 v93, s46, v93
    v_cvt_pk_bf16_f32 v90, 0, v90
    v_cvt_pk_bf16_f32 v91, 0, v91
    v_max3_f32 v141, v141, v88, v89
    v_cvt_pk_bf16_f32 v96, 0, v96
    v_cvt_pk_bf16_f32 v97, 0, v97
    s_waitcnt lgkmcnt(14)
    v_mfma_f32_32x32x16_bf16 a[48:63], v[44:47], v[60:63], a[48:63]
    ds_read_b64_tr_b16 v[44:45], v10 offset:28672
    ds_read_b64_tr_b16 v[46:47], v10 offset:30720
    v_mfma_f32_16x16x32_bf16 v[148:151], v[144:147], v[60:63], v[148:151]
    v_mul_f32 v94, s46, v94
    v_mul_f32 v95, s46, v95
    v_cvt_pk_bf16_f32 v92, 0, v92
    v_cvt_pk_bf16_f32 v93, 0, v93
    v_max3_f32 v141, v141, v90, v91
    v_cvt_pk_bf16_f32 v98, 0, v98
    v_cvt_pk_bf16_f32 v99, 0, v99
    s_waitcnt lgkmcnt(14)
    v_mfma_f32_32x32x16_bf16 a[64:79], v[48:51], v[60:63], a[64:79]
    ds_read_b64_tr_b16 v[48:49], v11 offset:28672
    ds_read_b64_tr_b16 v[50:51], v11 offset:30720
    v_mul_f32 v96, s46, v96
    v_mul_f32 v97, s46, v97
    v_cvt_pk_bf16_f32 v94, 0, v94
    v_cvt_pk_bf16_f32 v95, 0, v95
    v_max3_f32 v141, v141, v92, v93
    v_cvt_pk_bf16_f32 v100, 0, v100
    v_cvt_pk_bf16_f32 v101, 0, v101
    s_waitcnt lgkmcnt(14)
    v_mfma_f32_32x32x16_bf16 a[80:95], v[52:55], v[60:63], a[80:95]
    ds_read_b64_tr_b16 v[52:53], v12 offset:28672
    ds_read_b64_tr_b16 v[54:55], v12 offset:30720
    v_mul_f32 v98, s46, v98
    v_mul_f32 v99, s46, v99
    v_cvt_pk_bf16_f32 v96, 0, v96
    v_cvt_pk_bf16_f32 v97, 0, v97
    v_max3_f32 v141, v141, v94, v95
    v_cvt_pk_bf16_f32 v102, 0, v102
    v_cvt_pk_bf16_f32 v103, 0, v103
    s_waitcnt lgkmcnt(14)
    v_mfma_f32_32x32x16_bf16 a[32:47], v[24:27], v[64:67], a[32:47]
    ds_read_b128 v[24:27], v1 offset:49152
    v_mul_f32 v100, s46, v100
    v_mul_f32 v101, s46, v101
    v_cvt_pk_bf16_f32 v98, 0, v98
    v_cvt_pk_bf16_f32 v99, 0, v99
    v_max3_f32 v141, v141, v96, v97
    v_mul_f32 v102, s46, v102
    v_mul_f32 v103, s46, v103
    s_waitcnt lgkmcnt(13)
    v_mfma_f32_32x32x16_bf16 a[48:63], v[28:31], v[64:67], a[48:63]
    ds_read_b128 v[28:31], v2 offset:49152
    v_mfma_f32_16x16x32_bf16 v[148:151], v[144:147], v[64:67], v[148:151]
    v_cvt_pk_bf16_f32 v100, 0, v100
    v_cvt_pk_bf16_f32 v101, 0, v101
    v_max3_f32 v141, v141, v98, v99
    v_cvt_pk_bf16_f32 v102, 0, v102
    v_cvt_pk_bf16_f32 v103, 0, v103
    v_max3_f32 v141, v141, v100, v101
    v_max3_f32 v141, v141, v102, v103
    v_cmp_gt_f32 vcc, v141, v15
    s_cbranch_vccnz LrareA_43
LbackA_44:
    s_waitcnt lgkmcnt(12)
    v_mfma_f32_32x32x16_bf16 a[64:79], v[32:35], v[64:67], a[64:79]
    ds_read_b128 v[32:35], v3 offset:49152
    v_fma_f32 v72, v72, s44, v16
    v_fma_f32 v73, v73, s44, v16
    v_fma_f32 v74, v74, s44, v16
    v_fma_f32 v75, v75, s44, v16
    v_exp_f32 v72, v72
    s_waitcnt lgkmcnt(11)
    v_mfma_f32_32x32x16_bf16 a[80:95], v[36:39], v[64:67], a[80:95]
    ds_read_b128 v[36:39], v4 offset:49152
    v_exp_f32 v73, v73
    v_fma_f32 v76, v76, s44, v16
    v_fma_f32 v77, v77, s44, v16
    v_exp_f32 v74, v74
    v_exp_f32 v75, v75
    s_waitcnt lgkmcnt(10)
    v_mfma_f32_32x32x16_bf16 a[32:47], v[40:43], v[68:71], a[32:47]
    ds_read_b128 v[40:43], v5 offset:49152
    v_cvt_pk_bf16_f32 v56, v72, v73
    v_fma_f32 v78, v78, s44, v16
    v_fma_f32 v79, v79, s44, v16
    v_exp_f32 v76, v76
    v_exp_f32 v77, v77
    s_waitcnt lgkmcnt(9)
    v_mfma_f32_32x32x16_bf16 a[48:63], v[44:47], v[68:71], a[48:63]
    ds_read_b128 v[44:47], v6 offset:49152
    v_mfma_f32_16x16x32_bf16 v[148:151], v[144:147], v[68:71], v[148:151]
    v_cvt_pk_bf16_f32 v57, v74, v75
    v_fma_f32 v80, v80, s44, v16
    v_fma_f32 v81, v81, s44, v16
    v_exp_f32 v78, v78
    v_exp_f32 v79, v79
    s_waitcnt lgkmcnt(8)
    v_mfma_f32_32x32x16_bf16 a[64:79], v[48:51], v[68:71], a[64:79]
    ds_read_b128 v[48:51], v7 offset:49152
    v_cvt_pk_bf16_f32 v58, v76, v77
    v_fma_f32 v82, v82, s44, v16
    v_fma_f32 v83, v83, s44, v16
    v_exp_f32 v80, v80
    v_exp_f32 v81, v81
    s_waitcnt lgkmcnt(7)
    v_mfma_f32_32x32x16_bf16 a[80:95], v[52:55], v[68:71], a[80:95]
    ds_read_b128 v[52:55], v8 offset:49152
    v_cvt_pk_bf16_f32 v59, v78, v79
    v_fma_f32 v84, v84, s44, v16
    v_fma_f32 v85, v85, s44, v16
    v_exp_f32 v82, v82
    v_exp_f32 v83, v83
    s_cmp_lg_u32 s35, 0
    s_cbranch_scc1 LrareB_45
LbackB_46:
    s_waitcnt vmcnt(0)
    s_barrier
    s_waitcnt lgkmcnt(7)
    v_mfma_f32_32x32x16_bf16 v[104:119], v[24:27], a[0:3], 0
    ds_read_b128 v[24:27], v1 offset:57344
    s_cmp_lt_u32 s5, 4
    s_cbranch_scc0 Lpr_55
    s_setprio 2
    s_branch Lpr_56
Lpr_55:
    s_setprio 1
Lpr_56:
    v_cvt_pk_bf16_f32 v60, v80, v81
    v_fma_f32 v86, v86, s44, v16
    v_fma_f32 v87, v87, s44, v16
    v_exp_f32 v84, v84
    v_exp_f32 v85, v85
    s_waitcnt lgkmcnt(7)
    v_mfma_f32_32x32x16_bf16 v[104:119], v[28:31], a[4:7], v[104:119]
    ds_read_b128 v[28:31], v2 offset:57344
    v_cvt_pk_bf16_f32 v61, v82, v83
    v_fma_f32 v88, v88, s44, v16
    v_fma_f32 v89, v89, s44, v16
    v_exp_f32 v86, v86
    v_exp_f32 v87, v87
    s_waitcnt lgkmcnt(7)
    v_mfma_f32_32x32x16_bf16 v[104:119], v[32:35], a[8:11], v[104:119]
    ds_read_b128 v[32:35], v3 offset:57344
    v_cvt_pk_bf16_f32 v62, v84, v85
    v_fma_f32 v90, v90, s44, v16
    v_fma_f32 v91, v91, s44, v16
    v_exp_f32 v88, v88
    v_exp_f32 v89, v89
    s_waitcnt lgkmcnt(7)
    v_mfma_f32_32x32x16_bf16 v[104:119], v[36:39], a[12:15], v[104:119]
    ds_read_b128 v[36:39], v4 offset:57344
    v_cvt_pk_bf16_f32 v63, v86, v87
    v_fma_f32 v92, v92, s44, v16
    v_fma_f32 v93, v93, s44, v16
    v_exp_f32 v90, v90
    v_exp_f32 v91, v91
    s_waitcnt lgkmcnt(7)
    v_mfma_f32_32x32x16_bf16 v[104:119], v[40:43], a[16:19], v[104:119]
    ds_read_b128 v[40:43], v5 offset:57344
    v_cvt_pk_bf16_f32 v64, v88, v89
    v_fma_f32 v94, v94, s44, v16
    v_fma_f32 v95, v95, s44, v16
    v_exp_f32 v92, v92
    v_exp_f32 v93, v93
    s_waitcnt lgkmcnt(7)
    v_mfma_f32_32x32x16_bf16 v[104:119], v[44:47], a[20:23], v[104:119]
    ds_read_b128 v[44:47], v6 offset:57344
    v_cvt_pk_bf16_f32 v65, v90, v91
    v_fma_f32 v96, v96, s44, v16
    v_fma_f32 v97, v97, s44, v16
    v_exp_f32 v94, v94
    v_exp_f32 v95, v95
    s_waitcnt lgkmcnt(7)
    v_mfma_f32_32x32x16_bf16 v[104:119], v[48:51], a[24:27], v[104:119]
    ds_read_b128 v[48:51], v7 offset:57344
    v_cvt_pk_bf16_f32 v66, v92, v93
    v_fma_f32 v98, v98, s44, v16
    v_fma_f32 v99, v99, s44, v16
    v_exp_f32 v96, v96
    v_exp_f32 v97, v97
    s_waitcnt lgkmcnt(7)
    v_mfma_f32_32x32x16_bf16 v[104:119], v[52:55], a[28:31], v[104:119]
    ds_read_b128 v[52:55], v8 offset:57344
    v_cvt_pk_bf16_f32 v67, v94, v95
    v_fma_f32 v100, v100, s44, v16
    v_fma_f32 v101, v101, s44, v16
    v_exp_f32 v98, v98
    v_exp_f32 v99, v99
    s_waitcnt lgkmcnt(7)
    v_mfma_f32_32x32x16_bf16 v[120:135], v[24:27], a[0:3], 0
    ds_read_b64_tr_b16 v[24:25], v9 offset:32768
    ds_read_b64_tr_b16 v[26:27], v9 offset:34816
    v_cvt_pk_bf16_f32 v68, v96, v97
    v_fma_f32 v102, v102, s44, v16
    v_fma_f32 v103, v103, s44, v16
    v_exp_f32 v100, v100
    v_exp_f32 v101, v101
    s_waitcnt lgkmcnt(8)
    v_mfma_f32_32x32x16_bf16 v[120:135], v[28:31], a[4:7], v[120:135]
    ds_read_b64_tr_b16 v[28:29], v10 offset:32768
    ds_read_b64_tr_b16 v[30:31], v10 offset:34816
    v_cvt_pk_bf16_f32 v69, v98, v99
    v_exp_f32 v102, v102
    v_exp_f32 v103, v103
    v_cvt_pk_bf16_f32 v70, v100, v101
    v_cvt_pk_bf16_f32 v71, v102, v103
    s_waitcnt lgkmcnt(9)
    v_mfma_f32_32x32x16_bf16 v[120:135], v[32:35], a[8:11], v[120:135]
    ds_read_b64_tr_b16 v[32:33], v11 offset:32768
    ds_read_b64_tr_b16 v[34:35], v11 offset:34816
    v_cvt_pk_bf16_f32 v104, 0, v104
    v_cvt_pk_bf16_f32 v105, 0, v105
    v_cvt_pk_bf16_f32 v106, 0, v106
    v_cvt_pk_bf16_f32 v107, 0, v107
    v_mul_f32 v104, s46, v104
    v_mul_f32 v105, s46, v105
    v_cvt_pk_bf16_f32 v108, 0, v108
    s_waitcnt lgkmcnt(10)
    v_mfma_f32_32x32x16_bf16 v[120:135], v[36:39], a[12:15], v[120:135]
    ds_read_b64_tr_b16 v[36:37], v12 offset:32768
    ds_read_b64_tr_b16 v[38:39], v12 offset:34816
    v_cvt_pk_bf16_f32 v109, 0, v109
    v_mul_f32 v106, s46, v106
    v_mul_f32 v107, s46, v107
    v_cvt_pk_bf16_f32 v104, 0, v104
    v_cvt_pk_bf16_f32 v105, 0, v105
    v_cvt_pk_bf16_f32 v110, 0, v110
    v_cvt_pk_bf16_f32 v111, 0, v111
    s_waitcnt lgkmcnt(11)
    v_mfma_f32_32x32x16_bf16 v[120:135], v[40:43], a[16:19], v[120:135]
    ds_read_b64_tr_b16 v[40:41], v9 offset:36864
    ds_read_b64_tr_b16 v[42:43], v9 offset:38912
    v_mul_f32 v108, s46, v108
    v_mul_f32 v109, s46, v109
    v_cvt_pk_bf16_f32 v106, 0, v106
    v_cvt_pk_bf16_f32 v107, 0, v107
    v_max_f32 v141, v104, v105
    v_cvt_pk_bf16_f32 v112, 0, v112
    v_cvt_pk_bf16_f32 v113, 0, v113
    s_waitcnt lgkmcnt(12)
    v_mfma_f32_32x32x16_bf16 v[120:135], v[44:47], a[20:23], v[120:135]
    ds_read_b64_tr_b16 v[44:45], v10 offset:36864
    ds_read_b64_tr_b16 v[46:47], v10 offset:38912
    v_mul_f32 v110, s46, v110
    v_mul_f32 v111, s46, v111
    v_cvt_pk_bf16_f32 v108, 0, v108
    v_cvt_pk_bf16_f32 v109, 0, v109
    v_max3_f32 v141, v141, v106, v107
    v_cvt_pk_bf16_f32 v114, 0, v114
    v_cvt_pk_bf16_f32 v115, 0, v115
    s_waitcnt lgkmcnt(13)
    v_mfma_f32_32x32x16_bf16 v[120:135], v[48:51], a[24:27], v[120:135]
    ds_read_b64_tr_b16 v[48:49], v11 offset:36864
    ds_read_b64_tr_b16 v[50:51], v11 offset:38912
    v_mul_f32 v112, s46, v112
    v_mul_f32 v113, s46, v113
    v_cvt_pk_bf16_f32 v110, 0, v110
    v_cvt_pk_bf16_f32 v111, 0, v111
    v_max3_f32 v141, v141, v108, v109
    v_cvt_pk_bf16_f32 v116, 0, v116
    v_cvt_pk_bf16_f32 v117, 0, v117
    s_waitcnt lgkmcnt(14)
    v_mfma_f32_32x32x16_bf16 v[120:135], v[52:55], a[28:31], v[120:135]
    ds_read_b64_tr_b16 v[52:53], v12 offset:36864
    ds_read_b64_tr_b16 v[54:55], v12 offset:38912
    v_mul_f32 v114, s46, v114
    v_mul_f32 v115, s46, v115
    v_cvt_pk_bf16_f32 v112, 0, v112
    v_cvt_pk_bf16_f32 v113, 0, v113
    v_max3_f32 v141, v141, v110, v111
    v_cvt_pk_bf16_f32 v118, 0, v118
    v_cvt_pk_bf16_f32 v119, 0, v119
    s_waitcnt lgkmcnt(14)
    v_mfma_f32_32x32x16_bf16 a[32:47], v[24:27], v[56:59], a[32:47]
    ds_read_b64_tr_b16 v[24:25], v9 offset:40960
    ds_read_b64_tr_b16 v[26:27], v9 offset:43008
    v_mul_f32 v116, s46, v116
    v_mul_f32 v117, s46, v117
    v_cvt_pk_bf16_f32 v114, 0, v114
    v_cvt_pk_bf16_f32 v115, 0, v115
    v_max3_f32 v141, v141, v112, v113
    v_mul_f32 v118, s46, v118
    v_mul_f32 v119, s46, v119
    s_waitcnt lgkmcnt(14)
    v_mfma_f32_32x32x16_bf16 a[48:63], v[28:31], v[56:59], a[48:63]
    ds_read_b64_tr_b16 v[28:29], v10 offset:40960
    ds_read_b64_tr_b16 v[30:31], v10 offset:43008
    v_mfma_f32_16x16x32_bf16 v[148:151], v[144:147], v[56:59], v[148:151]
    v_cvt_pk_bf16_f32 v116, 0, v116
    v_cvt_pk_bf16_f32 v117, 0, v117
    v_max3_f32 v141, v141, v114, v115
    v_cvt_pk_bf16_f32 v118, 0, v118
    v_cvt_pk_bf16_f32 v119, 0, v119
    v_max3_f32 v141, v141, v116, v117
    v_max3_f32 v141, v141, v118, v119
    s_waitcnt lgkmcnt(14)
    v_mfma_f32_32x32x16_bf16 a[64:79], v[32:35], v[56:59], a[64:79]
    ds_read_b64_tr_b16 v[32:33], v11 offset:40960
    ds_read_b64_tr_b16 v[34:35], v11 offset:43008
    v_cvt_pk_bf16_f32 v120, 0, v120
    v_cvt_pk_bf16_f32 v121, 0, v121
    v_cvt_pk_bf16_f32 v122, 0, v122
    v_cvt_pk_bf16_f32 v123, 0, v123
    v_mul_f32 v120, s46, v120
    v_mul_f32 v121, s46, v121
    v_cvt_pk_bf16_f32 v124, 0, v124
    s_waitcnt lgkmcnt(14)
    v_mfma_f32_32x32x16_bf16 a[80:95], v[36:39], v[56:59], a[80:95]
    ds_read_b64_tr_b16 v[36:37], v12 offset:40960
    ds_read_b64_tr_b16 v[38:39], v12 offset:43008
    v_cvt_pk_bf16_f32 v125, 0, v125
    v_mul_f32 v122, s46, v122
    v_mul_f32 v123, s46, v123
    v_cvt_pk_bf16_f32 v120, 0, v120
    v_cvt_pk_bf16_f32 v121, 0, v121
    v_cvt_pk_bf16_f32 v126, 0, v126
    v_cvt_pk_bf16_f32 v127, 0, v127
    s_cmp_lt_u32 s5, 4
    s_cbranch_scc0 Lpr_57
    s_setprio 0
    s_branch Lpr_58
Lpr_57:
    s_setprio 1
Lpr_58:
    s_waitcnt lgkmcnt(14)
    v_mfma_f32_32x32x16_bf16 a[32:47], v[40:43], v[60:63], a[32:47]
    ds_read_b64_tr_b16 v[40:41], v9 offset:45056
    ds_read_b64_tr_b16 v[42:43], v9 offset:47104
    v_mul_f32 v124, s46, v124
    v_mul_f32 v125, s46, v125
    v_cvt_pk_bf16_f32 v122, 0, v122
    v_cvt_pk_bf16_f32 v123, 0, v123
    v_max3_f32 v141, v141, v120, v121
    v_cvt_pk_bf16_f32 v128, 0, v128
    v_cvt_pk_bf16_f32 v129, 0, v129
    s_waitcnt lgkmcnt(14)
    v_mfma_f32_32x32x16_bf16 a[48:63], v[44:47], v[60:63], a[48:63]
    ds_read_b64_tr_b16 v[44:45], v10 offset:45056
    ds_read_b64_tr_b16 v[46:47], v10 offset:47104
    v_mfma_f32_16x16x32_bf16 v[148:151], v[144:147], v[60:63], v[148:151]
    v_mul_f32 v126, s46, v126
    v_mul_f32 v127, s46, v127
    v_cvt_pk_bf16_f32 v124, 0, v124
    v_cvt_pk_bf16_f32 v125, 0, v125
    v_max3_f32 v141, v141, v122, v123
    v_cvt_pk_bf16_f32 v130, 0, v130
    v_cvt_pk_bf16_f32 v131, 0, v131
    s_waitcnt lgkmcnt(14)
    v_mfma_f32_32x32x16_bf16 a[64:79], v[48:51], v[60:63], a[64:79]
    ds_read_b64_tr_b16 v[48:49], v11 offset:45056
    ds_read_b64_tr_b16 v[50:51], v11 offset:47104
    v_mul_f32 v128, s46, v128
    v_mul_f32 v129, s46, v129
    v_cvt_pk_bf16_f32 v126, 0, v126
    v_cvt_pk_bf16_f32 v127, 0, v127
    v_max3_f32 v141, v141, v124, v125
    v_cvt_pk_bf16_f32 v132, 0, v132
    v_cvt_pk_bf16_f32 v133, 0, v133
    s_waitcnt lgkmcnt(14)
    v_mfma_f32_32x32x16_bf16 a[80:95], v[52:55], v[60:63], a[80:95]
    ds_read_b64_tr_b16 v[52:53], v12 offset:45056
    ds_read_b64_tr_b16 v[54:55], v12 offset:47104
    v_mul_f32 v130, s46, v130
    v_mul_f32 v131, s46, v131
    v_cvt_pk_bf16_f32 v128, 0, v128
    v_cvt_pk_bf16_f32 v129, 0, v129
    v_max3_f32 v141, v141, v126, v127
    v_cvt_pk_bf16_f32 v134, 0, v134
    v_cvt_pk_bf16_f32 v135, 0, v135
    s_waitcnt lgkmcnt(14)
    v_mfma_f32_32x32x16_bf16 a[32:47], v[24:27], v[64:67], a[32:47]
    v_mul_f32 v132, s46, v132
    v_mul_f32 v133, s46, v133
    v_cvt_pk_bf16_f32 v130, 0, v130
    v_cvt_pk_bf16_f32 v131, 0, v131
    v_max3_f32 v141, v141, v128, v129
    v_mul_f32 v134, s46, v134
    v_mul_f32 v135, s46, v135
    s_waitcnt lgkmcnt(12)
    v_mfma_f32_32x32x16_bf16 a[48:63], v[28:31], v[64:67], a[48:63]
    v_mfma_f32_16x16x32_bf16 v[148:151], v[144:147], v[64:67], v[148:151]
    v_cvt_pk_bf16_f32 v132, 0, v132
    v_cvt_pk_bf16_f32 v133, 0, v133
    v_max3_f32 v141, v141, v130, v131
    v_cvt_pk_bf16_f32 v134, 0, v134
    v_cvt_pk_bf16_f32 v135, 0, v135
    v_max3_f32 v141, v141, v132, v133
    v_max3_f32 v141, v141, v134, v135
    v_cmp_gt_f32 vcc, v141, v15
    s_cbranch_vccnz LrareA_51
LbackA_52:
    s_waitcnt lgkmcnt(10)
    v_mfma_f32_32x32x16_bf16 a[64:79], v[32:35], v[64:67], a[64:79]
    v_fma_f32 v104, v104, s44, v16
    v_fma_f32 v105, v105, s44, v16
    v_fma_f32 v106, v106, s44, v16
    v_fma_f32 v107, v107, s44, v16
    v_exp_f32 v104, v104
    s_waitcnt lgkmcnt(8)
    v_mfma_f32_32x32x16_bf16 a[80:95], v[36:39], v[64:67], a[80:95]
    v_exp_f32 v105, v105
    v_fma_f32 v108, v108, s44, v16
    v_fma_f32 v109, v109, s44, v16
    v_exp_f32 v106, v106
    v_exp_f32 v107, v107
    s_waitcnt lgkmcnt(6)
    v_mfma_f32_32x32x16_bf16 a[32:47], v[40:43], v[68:71], a[32:47]
    v_cvt_pk_bf16_f32 v56, v104, v105
    v_fma_f32 v110, v110, s44, v16
    v_fma_f32 v111, v111, s44, v16
    v_exp_f32 v108, v108
    v_exp_f32 v109, v109
    s_waitcnt lgkmcnt(4)
    v_mfma_f32_32x32x16_bf16 a[48:63], v[44:47], v[68:71], a[48:63]
    v_mfma_f32_16x16x32_bf16 v[148:151], v[144:147], v[68:71], v[148:151]
    v_cvt_pk_bf16_f32 v57, v106, v107
    v_fma_f32 v112, v112, s44, v16
    v_fma_f32 v113, v113, s44, v16
    v_exp_f32 v110, v110
    v_exp_f32 v111, v111
    s_waitcnt lgkmcnt(2)
    v_mfma_f32_32x32x16_bf16 a[64:79], v[48:51], v[68:71], a[64:79]
    v_cvt_pk_bf16_f32 v58, v108, v109
    v_fma_f32 v114, v114, s44, v16
    v_fma_f32 v115, v115, s44, v16
    v_exp_f32 v112, v112
    v_exp_f32 v113, v113
    s_waitcnt lgkmcnt(0)
    v_mfma_f32_32x32x16_bf16 a[80:95], v[52:55], v[68:71], a[80:95]
    v_cvt_pk_bf16_f32 v59, v110, v111
    v_fma_f32 v116, v116, s44, v16
    v_fma_f32 v117, v117, s44, v16
    v_exp_f32 v114, v114
    v_exp_f32 v115, v115
    s_cmp_lg_u32 s35, 0
    s_cbranch_scc1 LrareB_53
LbackB_54:
    s_waitcnt vmcnt(0)
    s_barrier
    v_cvt_pk_bf16_f32 v60, v112, v113
    v_fma_f32 v118, v118, s44, v16
    v_fma_f32 v119, v119, s44, v16
    v_exp_f32 v116, v116
    v_exp_f32 v117, v117
    v_cvt_pk_bf16_f32 v61, v114, v115
    v_fma_f32 v120, v120, s44, v16
    v_fma_f32 v121, v121, s44, v16
    v_exp_f32 v118, v118
    v_exp_f32 v119, v119
    v_cvt_pk_bf16_f32 v62, v116, v117
    v_fma_f32 v122, v122, s44, v16
    v_fma_f32 v123, v123, s44, v16
    v_exp_f32 v120, v120
    v_exp_f32 v121, v121
    v_cvt_pk_bf16_f32 v63, v118, v119
    v_fma_f32 v124, v124, s44, v16
    v_fma_f32 v125, v125, s44, v16
    v_exp_f32 v122, v122
    v_exp_f32 v123, v123
    v_cvt_pk_bf16_f32 v64, v120, v121
    v_fma_f32 v126, v126, s44, v16
    v_fma_f32 v127, v127, s44, v16
    v_exp_f32 v124, v124
    v_exp_f32 v125, v125
    v_cvt_pk_bf16_f32 v65, v122, v123
    v_fma_f32 v128, v128, s44, v16
    v_fma_f32 v129, v129, s44, v16
    v_exp_f32 v126, v126
    v_exp_f32 v127, v127
    v_cvt_pk_bf16_f32 v66, v124, v125
    v_fma_f32 v130, v130, s44, v16
    v_fma_f32 v131, v131, s44, v16
    v_exp_f32 v128, v128
    v_exp_f32 v129, v129
    v_cvt_pk_bf16_f32 v67, v126, v127
    v_fma_f32 v132, v132, s44, v16
    v_fma_f32 v133, v133, s44, v16
    v_exp_f32 v130, v130
    v_exp_f32 v131, v131
    v_cvt_pk_bf16_f32 v68, v128, v129
    v_fma_f32 v134, v134, s44, v16
    v_fma_f32 v135, v135, s44, v16
    v_exp_f32 v132, v132
    v_exp_f32 v133, v133
    v_cvt_pk_bf16_f32 v69, v130, v131
    v_exp_f32 v134, v134
    v_exp_f32 v135, v135
    v_cvt_pk_bf16_f32 v70, v132, v133
    v_cvt_pk_bf16_f32 v71, v134, v135
    s_nop 1
    ds_read_b64_tr_b16 v[24:25], v9 offset:49152
    ds_read_b64_tr_b16 v[26:27], v9 offset:51200
    ds_read_b64_tr_b16 v[28:29], v10 offset:49152
    ds_read_b64_tr_b16 v[30:31], v10 offset:51200
    ds_read_b64_tr_b16 v[32:33], v11 offset:49152
    ds_read_b64_tr_b16 v[34:35], v11 offset:51200
    ds_read_b64_tr_b16 v[36:37], v12 offset:49152
    ds_read_b64_tr_b16 v[38:39], v12 offset:51200
    ds_read_b64_tr_b16 v[40:41], v9 offset:53248
    ds_read_b64_tr_b16 v[42:43], v9 offset:55296
    ds_read_b64_tr_b16 v[44:45], v10 offset:53248
    ds_read_b64_tr_b16 v[46:47], v10 offset:55296
    ds_read_b64_tr_b16 v[48:49], v11 offset:53248
    ds_read_b64_tr_b16 v[50:51], v11 offset:55296
    ds_read_b64_tr_b16 v[52:53], v12 offset:53248
    ds_read_b64_tr_b16 v[54:55], v12 offset:55296
    s_waitcnt lgkmcnt(14)
    v_mfma_f32_32x32x16_bf16 a[32:47], v[24:27], v[56:59], a[32:47]
    ds_read_b64_tr_b16 v[24:25], v9 offset:57344
    ds_read_b64_tr_b16 v[26:27], v9 offset:59392
    s_waitcnt lgkmcnt(14)
    v_mfma_f32_32x32x16_bf16 a[48:63], v[28:31], v[56:59], a[48:63]
    ds_read_b64_tr_b16 v[28:29], v10 offset:57344
    ds_read_b64_tr_b16 v[30:31], v10 offset:59392
    v_mfma_f32_16x16x32_bf16 v[148:151], v[144:147], v[56:59], v[148:151]
    s_waitcnt lgkmcnt(14)
    v_mfma_f32_32x32x16_bf16 a[64:79], v[32:35], v[56:59], a[64:79]
    ds_read_b64_tr_b16 v[32:33], v11 offset:57344
    ds_read_b64_tr_b16 v[34:35], v11 offset:59392
    s_waitcnt lgkmcnt(14)
    v_mfma_f32_32x32x16_bf16 a[80:95], v[36:39], v[56:59], a[80:95]
    ds_read_b64_tr_b16 v[36:37], v12 offset:57344
    ds_read_b64_tr_b16 v[38:39], v12 offset:59392
    s_waitcnt lgkmcnt(14)
    v_mfma_f32_32x32x16_bf16 a[32:47], v[40:43], v[60:63], a[32:47]
    ds_read_b64_tr_b16 v[40:41], v9 offset:61440
    ds_read_b64_tr_b16 v[42:43], v9 offset:63488
    s_waitcnt lgkmcnt(14)
    v_mfma_f32_32x32x16_bf16 a[48:63], v[44:47], v[60:63], a[48:63]
    ds_read_b64_tr_b16 v[44:45], v10 offset:61440
    ds_read_b64_tr_b16 v[46:47], v10 offset:63488
    v_mfma_f32_16x16x32_bf16 v[148:151], v[144:147], v[60:63], v[148:151]
    s_waitcnt lgkmcnt(14)
    v_mfma_f32_32x32x16_bf16 a[64:79], v[48:51], v[60:63], a[64:79]
    ds_read_b64_tr_b16 v[48:49], v11 offset:61440
    ds_read_b64_tr_b16 v[50:51], v11 offset:63488
    s_waitcnt lgkmcnt(14)
    v_mfma_f32_32x32x16_bf16 a[80:95], v[52:55], v[60:63], a[80:95]
    ds_read_b64_tr_b16 v[52:53], v12 offset:61440
    ds_read_b64_tr_b16 v[54:55], v12 offset:63488
    s_waitcnt lgkmcnt(14)
    v_mfma_f32_32x32x16_bf16 a[32:47], v[24:27], v[64:67], a[32:47]
    s_waitcnt lgkmcnt(12)
    v_mfma_f32_32x32x16_bf16 a[48:63], v[28:31], v[64:67], a[48:63]
    v_mfma_f32_16x16x32_bf16 v[148:151], v[144:147], v[64:67], v[148:151]
    s_waitcnt lgkmcnt(10)
    v_mfma_f32_32x32x16_bf16 a[64:79], v[32:35], v[64:67], a[64:79]
    s_waitcnt lgkmcnt(8)
    v_mfma_f32_32x32x16_bf16 a[80:95], v[36:39], v[64:67], a[80:95]
    s_waitcnt lgkmcnt(6)
    v_mfma_f32_32x32x16_bf16 a[32:47], v[40:43], v[68:71], a[32:47]
    s_waitcnt lgkmcnt(4)
    v_mfma_f32_32x32x16_bf16 a[48:63], v[44:47], v[68:71], a[48:63]
    v_mfma_f32_16x16x32_bf16 v[148:151], v[144:147], v[68:71], v[148:151]
    s_waitcnt lgkmcnt(2)
    v_mfma_f32_32x32x16_bf16 a[64:79], v[48:51], v[68:71], a[64:79]
    s_waitcnt lgkmcnt(0)
    v_mfma_f32_32x32x16_bf16 a[80:95], v[52:55], v[68:71], a[80:95]
    v_and_b32 v20, 16, v0
    v_cmp_eq_u32 vcc, 0, v20
    s_nop 15
    v_cndmask_b32 v20, v149, v148, vcc

    v_rcp_f32 v20, v20
    s_lshl_b32 s34, s4, 3
    s_add_u32 s34, s34, s5
    s_lshl_b32 s34, s34, 18
    s_lshl_b32 s30, s3, 13
    s_add_u32 s34, s34, s30
    s_nop 15

    v_accvgpr_read_b32 v72, a32
    v_accvgpr_read_b32 v73, a33
    v_accvgpr_read_b32 v74, a34
    v_accvgpr_read_b32 v75, a35
    v_accvgpr_read_b32 v76, a36
    v_accvgpr_read_b32 v77, a37
    v_accvgpr_read_b32 v78, a38
    v_accvgpr_read_b32 v79, a39
    v_mul_f32 v72, v72, v20
    v_mul_f32 v73, v73, v20
    v_mul_f32 v74, v74, v20
    v_mul_f32 v75, v75, v20
    v_mul_f32 v76, v76, v20
    v_mul_f32 v77, v77, v20
    v_mul_f32 v78, v78, v20
    v_mul_f32 v79, v79, v20
    v_cvt_pk_bf16_f32 v72, v72, v73
    v_cvt_pk_bf16_f32 v73, v74, v75
    v_cvt_pk_bf16_f32 v74, v76, v77
    v_cvt_pk_bf16_f32 v75, v78, v79
    buffer_store_dwordx4 v[72:75], v142, s[24:27], s34 offen offset:0 sc1
    v_accvgpr_read_b32 v80, a40
    v_accvgpr_read_b32 v81, a41
    v_accvgpr_read_b32 v82, a42
    v_accvgpr_read_b32 v83, a43
    v_accvgpr_read_b32 v84, a44
    v_accvgpr_read_b32 v85, a45
    v_accvgpr_read_b32 v86, a46
    v_accvgpr_read_b32 v87, a47
    v_mul_f32 v80, v80, v20
    v_mul_f32 v81, v81, v20
    v_mul_f32 v82, v82, v20
    v_mul_f32 v83, v83, v20
    v_mul_f32 v84, v84, v20
    v_mul_f32 v85, v85, v20
    v_mul_f32 v86, v86, v20
    v_mul_f32 v87, v87, v20
    v_cvt_pk_bf16_f32 v80, v80, v81
    v_cvt_pk_bf16_f32 v81, v82, v83
    v_cvt_pk_bf16_f32 v82, v84, v85
    v_cvt_pk_bf16_f32 v83, v86, v87
    buffer_store_dwordx4 v[80:83], v142, s[24:27], s34 offen offset:1024 sc1
    v_accvgpr_read_b32 v88, a48
    v_accvgpr_read_b32 v89, a49
    v_accvgpr_read_b32 v90, a50
    v_accvgpr_read_b32 v91, a51
    v_accvgpr_read_b32 v92, a52
    v_accvgpr_read_b32 v93, a53
    v_accvgpr_read_b32 v94, a54
    v_accvgpr_read_b32 v95, a55
    v_mul_f32 v88, v88, v20
    v_mul_f32 v89, v89, v20
    v_mul_f32 v90, v90, v20
    v_mul_f32 v91, v91, v20
    v_mul_f32 v92, v92, v20
    v_mul_f32 v93, v93, v20
    v_mul_f32 v94, v94, v20
    v_mul_f32 v95, v95, v20
    v_cvt_pk_bf16_f32 v88, v88, v89
    v_cvt_pk_bf16_f32 v89, v90, v91
    v_cvt_pk_bf16_f32 v90, v92, v93
    v_cvt_pk_bf16_f32 v91, v94, v95
    buffer_store_dwordx4 v[88:91], v142, s[24:27], s34 offen offset:2048 sc1
    v_accvgpr_read_b32 v96, a56
    v_accvgpr_read_b32 v97, a57
    v_accvgpr_read_b32 v98, a58
    v_accvgpr_read_b32 v99, a59
    v_accvgpr_read_b32 v100, a60
    v_accvgpr_read_b32 v101, a61
    v_accvgpr_read_b32 v102, a62
    v_accvgpr_read_b32 v103, a63
    v_mul_f32 v96, v96, v20
    v_mul_f32 v97, v97, v20
    v_mul_f32 v98, v98, v20
    v_mul_f32 v99, v99, v20
    v_mul_f32 v100, v100, v20
    v_mul_f32 v101, v101, v20
    v_mul_f32 v102, v102, v20
    v_mul_f32 v103, v103, v20
    v_cvt_pk_bf16_f32 v96, v96, v97
    v_cvt_pk_bf16_f32 v97, v98, v99
    v_cvt_pk_bf16_f32 v98, v100, v101
    v_cvt_pk_bf16_f32 v99, v102, v103
    buffer_store_dwordx4 v[96:99], v142, s[24:27], s34 offen offset:3072 sc1
    v_accvgpr_read_b32 v104, a64
    v_accvgpr_read_b32 v105, a65
    v_accvgpr_read_b32 v106, a66
    v_accvgpr_read_b32 v107, a67
    v_accvgpr_read_b32 v108, a68
    v_accvgpr_read_b32 v109, a69
    v_accvgpr_read_b32 v110, a70
    v_accvgpr_read_b32 v111, a71
    v_mul_f32 v104, v104, v20
    v_mul_f32 v105, v105, v20
    v_mul_f32 v106, v106, v20
    v_mul_f32 v107, v107, v20
    v_mul_f32 v108, v108, v20
    v_mul_f32 v109, v109, v20
    v_mul_f32 v110, v110, v20
    v_mul_f32 v111, v111, v20
    v_cvt_pk_bf16_f32 v104, v104, v105
    v_cvt_pk_bf16_f32 v105, v106, v107
    v_cvt_pk_bf16_f32 v106, v108, v109
    v_cvt_pk_bf16_f32 v107, v110, v111
    s_add_u32 s34, s34, 4096
    buffer_store_dwordx4 v[104:107], v142, s[24:27], s34 offen offset:0 sc1
    v_accvgpr_read_b32 v112, a72
    v_accvgpr_read_b32 v113, a73
    v_accvgpr_read_b32 v114, a74
    v_accvgpr_read_b32 v115, a75
    v_accvgpr_read_b32 v116, a76
    v_accvgpr_read_b32 v117, a77
    v_accvgpr_read_b32 v118, a78
    v_accvgpr_read_b32 v119, a79
    v_mul_f32 v112, v112, v20
    v_mul_f32 v113, v113, v20
    v_mul_f32 v114, v114, v20
    v_mul_f32 v115, v115, v20
    v_mul_f32 v116, v116, v20
    v_mul_f32 v117, v117, v20
    v_mul_f32 v118, v118, v20
    v_mul_f32 v119, v119, v20
    v_cvt_pk_bf16_f32 v112, v112, v113
    v_cvt_pk_bf16_f32 v113, v114, v115
    v_cvt_pk_bf16_f32 v114, v116, v117
    v_cvt_pk_bf16_f32 v115, v118, v119
    buffer_store_dwordx4 v[112:115], v142, s[24:27], s34 offen offset:1024 sc1
    v_accvgpr_read_b32 v120, a80
    v_accvgpr_read_b32 v121, a81
    v_accvgpr_read_b32 v122, a82
    v_accvgpr_read_b32 v123, a83
    v_accvgpr_read_b32 v124, a84
    v_accvgpr_read_b32 v125, a85
    v_accvgpr_read_b32 v126, a86
    v_accvgpr_read_b32 v127, a87
    v_mul_f32 v120, v120, v20
    v_mul_f32 v121, v121, v20
    v_mul_f32 v122, v122, v20
    v_mul_f32 v123, v123, v20
    v_mul_f32 v124, v124, v20
    v_mul_f32 v125, v125, v20
    v_mul_f32 v126, v126, v20
    v_mul_f32 v127, v127, v20
    v_cvt_pk_bf16_f32 v120, v120, v121
    v_cvt_pk_bf16_f32 v121, v122, v123
    v_cvt_pk_bf16_f32 v122, v124, v125
    v_cvt_pk_bf16_f32 v123, v126, v127
    buffer_store_dwordx4 v[120:123], v142, s[24:27], s34 offen offset:2048 sc1
    v_accvgpr_read_b32 v128, a88
    v_accvgpr_read_b32 v129, a89
    v_accvgpr_read_b32 v130, a90
    v_accvgpr_read_b32 v131, a91
    v_accvgpr_read_b32 v132, a92
    v_accvgpr_read_b32 v133, a93
    v_accvgpr_read_b32 v134, a94
    v_accvgpr_read_b32 v135, a95
    v_mul_f32 v128, v128, v20
    v_mul_f32 v129, v129, v20
    v_mul_f32 v130, v130, v20
    v_mul_f32 v131, v131, v20
    v_mul_f32 v132, v132, v20
    v_mul_f32 v133, v133, v20
    v_mul_f32 v134, v134, v20
    v_mul_f32 v135, v135, v20
    v_cvt_pk_bf16_f32 v128, v128, v129
    v_cvt_pk_bf16_f32 v129, v130, v131
    v_cvt_pk_bf16_f32 v130, v132, v133
    v_cvt_pk_bf16_f32 v131, v134, v135
    buffer_store_dwordx4 v[128:131], v142, s[24:27], s34 offen offset:3072 sc1
Lk2_end:
    s_endpgm
LrareA_1:
    v_max_f32 v141, v141, v143
    v_mov_b32 v20, v141
    v_mov_b32 v21, v141
    s_nop 1
    v_permlane32_swap_b32 v20, v21
    s_nop 1
    v_max_f32 v141, v20, v21
    v_sub_f32 v20, v143, v141
    v_mul_f32 v20, s44, v20
    v_exp_f32 v17, v20
    v_mov_b32 v143, v141
    v_mul_f32 v16, s44, v141
    v_sub_f32 v16, 0, v16
    v_add_f32 v15, 0x40b00000, v141
    v_mul_f32 v18, v18, v17
    v_mul_f32 v19, v19, v17
    s_mov_b32 s35, 1
    s_branch LbackA_2
LrareA_3:
    v_max_f32 v141, v141, v143
    v_mov_b32 v20, v141
    v_mov_b32 v21, v141
    s_nop 1
    v_permlane32_swap_b32 v20, v21
    s_nop 1
    v_max_f32 v141, v20, v21
    v_sub_f32 v20, v143, v141
    v_mul_f32 v20, s44, v20
    v_exp_f32 v17, v20
    v_mov_b32 v143, v141
    v_mul_f32 v16, s44, v141
    v_sub_f32 v16, 0, v16
    v_add_f32 v15, 0x40b00000, v141
    v_mul_f32 v18, v18, v17
    v_mul_f32 v19, v19, v17
    s_mov_b32 s35, 1
    s_branch LbackA_4
LrareB_5:
    s_nop 15
    v_accvgpr_read_b32 v21, a32
    v_mul_f32 v21, v21, v17
    v_accvgpr_write_b32 a32, v21
    v_accvgpr_read_b32 v21, a33
    v_mul_f32 v21, v21, v17
    v_accvgpr_write_b32 a33, v21
    v_accvgpr_read_b32 v21, a34
    v_mul_f32 v21, v21, v17
    v_accvgpr_write_b32 a34, v21
    v_accvgpr_read_b32 v21, a35
    v_mul_f32 v21, v21, v17
    v_accvgpr_write_b32 a35, v21
    v_accvgpr_read_b32 v21, a36
    v_mul_f32 v21, v21, v17
    v_accvgpr_write_b32 a36, v21
    v_accvgpr_read_b32 v21, a37
    v_mul_f32 v21, v21, v17
    v_accvgpr_write_b32 a37, v21
    v_accvgpr_read_b32 v21, a38
    v_mul_f32 v21, v21, v17
    v_accvgpr_write_b32 a38, v21
    v_accvgpr_read_b32 v21, a39
    v_mul_f32 v21, v21, v17
    v_accvgpr_write_b32 a39, v21
    v_accvgpr_read_b32 v21, a40
    v_mul_f32 v21, v21, v17
    v_accvgpr_write_b32 a40, v21
    v_accvgpr_read_b32 v21, a41
    v_mul_f32 v21, v21, v17
    v_accvgpr_write_b32 a41, v21
    v_accvgpr_read_b32 v21, a42
    v_mul_f32 v21, v21, v17
    v_accvgpr_write_b32 a42, v21
    v_accvgpr_read_b32 v21, a43
    v_mul_f32 v21, v21, v17
    v_accvgpr_write_b32 a43, v21
    v_accvgpr_read_b32 v21, a44
    v_mul_f32 v21, v21, v17
    v_accvgpr_write_b32 a44, v21
    v_accvgpr_read_b32 v21, a45
    v_mul_f32 v21, v21, v17
    v_accvgpr_write_b32 a45, v21
    v_accvgpr_read_b32 v21, a46
    v_mul_f32 v21, v21, v17
    v_accvgpr_write_b32 a46, v21
    v_accvgpr_read_b32 v21, a47
    v_mul_f32 v21, v21, v17
    v_accvgpr_write_b32 a47, v21
    v_accvgpr_read_b32 v21, a48
    v_mul_f32 v21, v21, v17
    v_accvgpr_write_b32 a48, v21
    v_accvgpr_read_b32 v21, a49
    v_mul_f32 v21, v21, v17
    v_accvgpr_write_b32 a49, v21
    v_accvgpr_read_b32 v21, a50
    v_mul_f32 v21, v21, v17
    v_accvgpr_write_b32 a50, v21
    v_accvgpr_read_b32 v21, a51
    v_mul_f32 v21, v21, v17
    v_accvgpr_write_b32 a51, v21
    v_accvgpr_read_b32 v21, a52
    v_mul_f32 v21, v21, v17
    v_accvgpr_write_b32 a52, v21
    v_accvgpr_read_b32 v21, a53
    v_mul_f32 v21, v21, v17
    v_accvgpr_write_b32 a53, v21
    v_accvgpr_read_b32 v21, a54
    v_mul_f32 v21, v21, v17
    v_accvgpr_write_b32 a54, v21
    v_accvgpr_read_b32 v21, a55
    v_mul_f32 v21, v21, v17
    v_accvgpr_write_b32 a55, v21
    v_accvgpr_read_b32 v21, a56
    v_mul_f32 v21, v21, v17
    v_accvgpr_write_b32 a56, v21
    v_accvgpr_read_b32 v21, a57
    v_mul_f32 v21, v21, v17
    v_accvgpr_write_b32 a57, v21
    v_accvgpr_read_b32 v21, a58
    v_mul_f32 v21, v21, v17
    v_accvgpr_write_b32 a58, v21
    v_accvgpr_read_b32 v21, a59
    v_mul_f32 v21, v21, v17
    v_accvgpr_write_b32 a59, v21
    v_accvgpr_read_b32 v21, a60
    v_mul_f32 v21, v21, v17
    v_accvgpr_write_b32 a60, v21
    v_accvgpr_read_b32 v21, a61
    v_mul_f32 v21, v21, v17
    v_accvgpr_write_b32 a61, v21
    v_accvgpr_read_b32 v21, a62
    v_mul_f32 v21, v21, v17
    v_accvgpr_write_b32 a62, v21
    v_accvgpr_read_b32 v21, a63
    v_mul_f32 v21, v21, v17
    v_accvgpr_write_b32 a63, v21
    v_accvgpr_read_b32 v21, a64
    v_mul_f32 v21, v21, v17
    v_accvgpr_write_b32 a64, v21
    v_accvgpr_read_b32 v21, a65
    v_mul_f32 v21, v21, v17
    v_accvgpr_write_b32 a65, v21
    v_accvgpr_read_b32 v21, a66
    v_mul_f32 v21, v21, v17
    v_accvgpr_write_b32 a66, v21
    v_accvgpr_read_b32 v21, a67
    v_mul_f32 v21, v21, v17
    v_accvgpr_write_b32 a67, v21
    v_accvgpr_read_b32 v21, a68
    v_mul_f32 v21, v21, v17
    v_accvgpr_write_b32 a68, v21
    v_accvgpr_read_b32 v21, a69
    v_mul_f32 v21, v21, v17
    v_accvgpr_write_b32 a69, v21
    v_accvgpr_read_b32 v21, a70
    v_mul_f32 v21, v21, v17
    v_accvgpr_write_b32 a70, v21
    v_accvgpr_read_b32 v21, a71
    v_mul_f32 v21, v21, v17
    v_accvgpr_write_b32 a71, v21
    v_accvgpr_read_b32 v21, a72
    v_mul_f32 v21, v21, v17
    v_accvgpr_write_b32 a72, v21
    v_accvgpr_read_b32 v21, a73
    v_mul_f32 v21, v21, v17
    v_accvgpr_write_b32 a73, v21
    v_accvgpr_read_b32 v21, a74
    v_mul_f32 v21, v21, v17
    v_accvgpr_write_b32 a74, v21
    v_accvgpr_read_b32 v21, a75
    v_mul_f32 v21, v21, v17
    v_accvgpr_write_b32 a75, v21
    v_accvgpr_read_b32 v21, a76
    v_mul_f32 v21, v21, v17
    v_accvgpr_write_b32 a76, v21
    v_accvgpr_read_b32 v21, a77
    v_mul_f32 v21, v21, v17
    v_accvgpr_write_b32 a77, v21
    v_accvgpr_read_b32 v21, a78
    v_mul_f32 v21, v21, v17
    v_accvgpr_write_b32 a78, v21
    v_accvgpr_read_b32 v21, a79
    v_mul_f32 v21, v21, v17
    v_accvgpr_write_b32 a79, v21
    v_accvgpr_read_b32 v21, a80
    v_mul_f32 v21, v21, v17
    v_accvgpr_write_b32 a80, v21
    v_accvgpr_read_b32 v21, a81
    v_mul_f32 v21, v21, v17
    v_accvgpr_write_b32 a81, v21
    v_accvgpr_read_b32 v21, a82
    v_mul_f32 v21, v21, v17
    v_accvgpr_write_b32 a82, v21
    v_accvgpr_read_b32 v21, a83
    v_mul_f32 v21, v21, v17
    v_accvgpr_write_b32 a83, v21
    v_accvgpr_read_b32 v21, a84
    v_mul_f32 v21, v21, v17
    v_accvgpr_write_b32 a84, v21
    v_accvgpr_read_b32 v21, a85
    v_mul_f32 v21, v21, v17
    v_accvgpr_write_b32 a85, v21
    v_accvgpr_read_b32 v21, a86
    v_mul_f32 v21, v21, v17
    v_accvgpr_write_b32 a86, v21
    v_accvgpr_read_b32 v21, a87
    v_mul_f32 v21, v21, v17
    v_accvgpr_write_b32 a87, v21
    v_accvgpr_read_b32 v21, a88
    v_mul_f32 v21, v21, v17
    v_accvgpr_write_b32 a88, v21
    v_accvgpr_read_b32 v21, a89
    v_mul_f32 v21, v21, v17
    v_accvgpr_write_b32 a89, v21
    v_accvgpr_read_b32 v21, a90
    v_mul_f32 v21, v21, v17
    v_accvgpr_write_b32 a90, v21
    v_accvgpr_read_b32 v21, a91
    v_mul_f32 v21, v21, v17
    v_accvgpr_write_b32 a91, v21
    v_accvgpr_read_b32 v21, a92
    v_mul_f32 v21, v21, v17
    v_accvgpr_write_b32 a92, v21
    v_accvgpr_read_b32 v21, a93
    v_mul_f32 v21, v21, v17
    v_accvgpr_write_b32 a93, v21
    v_accvgpr_read_b32 v21, a94
    v_mul_f32 v21, v21, v17
    v_accvgpr_write_b32 a94, v21
    v_accvgpr_read_b32 v21, a95
    v_mul_f32 v21, v21, v17
    v_accvgpr_write_b32 a95, v21
    v_mov_b32 v20, v17
    v_mov_b32 v21, v17
    s_nop 1
    v_permlane16_swap_b32 v20, v21
    s_nop 1
    v_mul_f32 v148, v148, v20
    v_mul_f32 v149, v149, v21
    v_mul_f32 v150, v150, v20
    v_mul_f32 v151, v151, v21
    s_mov_b32 s35, 0
    s_nop 1
    s_branch LbackB_6
LrareA_11:
    v_max_f32 v141, v141, v143
    v_mov_b32 v20, v141
    v_mov_b32 v21, v141
    s_nop 1
    v_permlane32_swap_b32 v20, v21
    s_nop 1
    v_max_f32 v141, v20, v21
    v_sub_f32 v20, v143, v141
    v_mul_f32 v20, s44, v20
    v_exp_f32 v17, v20
    v_mov_b32 v143, v141
    v_mul_f32 v16, s44, v141
    v_sub_f32 v16, 0, v16
    v_add_f32 v15, 0x40b00000, v141
    v_mul_f32 v18, v18, v17
    v_mul_f32 v19, v19, v17
    s_mov_b32 s35, 1
    s_branch LbackA_12
LrareB_13:
    s_nop 15
    v_accvgpr_read_b32 v21, a32
    v_mul_f32 v21, v21, v17
    v_accvgpr_write_b32 a32, v21
    v_accvgpr_read_b32 v21, a33
    v_mul_f32 v21, v21, v17
    v_accvgpr_write_b32 a33, v21
    v_accvgpr_read_b32 v21, a34
    v_mul_f32 v21, v21, v17
    v_accvgpr_write_b32 a34, v21
    v_accvgpr_read_b32 v21, a35
    v_mul_f32 v21, v21, v17
    v_accvgpr_write_b32 a35, v21
    v_accvgpr_read_b32 v21, a36
    v_mul_f32 v21, v21, v17
    v_accvgpr_write_b32 a36, v21
    v_accvgpr_read_b32 v21, a37
    v_mul_f32 v21, v21, v17
    v_accvgpr_write_b32 a37, v21
    v_accvgpr_read_b32 v21, a38
    v_mul_f32 v21, v21, v17
    v_accvgpr_write_b32 a38, v21
    v_accvgpr_read_b32 v21, a39
    v_mul_f32 v21, v21, v17
    v_accvgpr_write_b32 a39, v21
    v_accvgpr_read_b32 v21, a40
    v_mul_f32 v21, v21, v17
    v_accvgpr_write_b32 a40, v21
    v_accvgpr_read_b32 v21, a41
    v_mul_f32 v21, v21, v17
    v_accvgpr_write_b32 a41, v21
    v_accvgpr_read_b32 v21, a42
    v_mul_f32 v21, v21, v17
    v_accvgpr_write_b32 a42, v21
    v_accvgpr_read_b32 v21, a43
    v_mul_f32 v21, v21, v17
    v_accvgpr_write_b32 a43, v21
    v_accvgpr_read_b32 v21, a44
    v_mul_f32 v21, v21, v17
    v_accvgpr_write_b32 a44, v21
    v_accvgpr_read_b32 v21, a45
    v_mul_f32 v21, v21, v17
    v_accvgpr_write_b32 a45, v21
    v_accvgpr_read_b32 v21, a46
    v_mul_f32 v21, v21, v17
    v_accvgpr_write_b32 a46, v21
    v_accvgpr_read_b32 v21, a47
    v_mul_f32 v21, v21, v17
    v_accvgpr_write_b32 a47, v21
    v_accvgpr_read_b32 v21, a48
    v_mul_f32 v21, v21, v17
    v_accvgpr_write_b32 a48, v21
    v_accvgpr_read_b32 v21, a49
    v_mul_f32 v21, v21, v17
    v_accvgpr_write_b32 a49, v21
    v_accvgpr_read_b32 v21, a50
    v_mul_f32 v21, v21, v17
    v_accvgpr_write_b32 a50, v21
    v_accvgpr_read_b32 v21, a51
    v_mul_f32 v21, v21, v17
    v_accvgpr_write_b32 a51, v21
    v_accvgpr_read_b32 v21, a52
    v_mul_f32 v21, v21, v17
    v_accvgpr_write_b32 a52, v21
    v_accvgpr_read_b32 v21, a53
    v_mul_f32 v21, v21, v17
    v_accvgpr_write_b32 a53, v21
    v_accvgpr_read_b32 v21, a54
    v_mul_f32 v21, v21, v17
    v_accvgpr_write_b32 a54, v21
    v_accvgpr_read_b32 v21, a55
    v_mul_f32 v21, v21, v17
    v_accvgpr_write_b32 a55, v21
    v_accvgpr_read_b32 v21, a56
    v_mul_f32 v21, v21, v17
    v_accvgpr_write_b32 a56, v21
    v_accvgpr_read_b32 v21, a57
    v_mul_f32 v21, v21, v17
    v_accvgpr_write_b32 a57, v21
    v_accvgpr_read_b32 v21, a58
    v_mul_f32 v21, v21, v17
    v_accvgpr_write_b32 a58, v21
    v_accvgpr_read_b32 v21, a59
    v_mul_f32 v21, v21, v17
    v_accvgpr_write_b32 a59, v21
    v_accvgpr_read_b32 v21, a60
    v_mul_f32 v21, v21, v17
    v_accvgpr_write_b32 a60, v21
    v_accvgpr_read_b32 v21, a61
    v_mul_f32 v21, v21, v17
    v_accvgpr_write_b32 a61, v21
    v_accvgpr_read_b32 v21, a62
    v_mul_f32 v21, v21, v17
    v_accvgpr_write_b32 a62, v21
    v_accvgpr_read_b32 v21, a63
    v_mul_f32 v21, v21, v17
    v_accvgpr_write_b32 a63, v21
    v_accvgpr_read_b32 v21, a64
    v_mul_f32 v21, v21, v17
    v_accvgpr_write_b32 a64, v21
    v_accvgpr_read_b32 v21, a65
    v_mul_f32 v21, v21, v17
    v_accvgpr_write_b32 a65, v21
    v_accvgpr_read_b32 v21, a66
    v_mul_f32 v21, v21, v17
    v_accvgpr_write_b32 a66, v21
    v_accvgpr_read_b32 v21, a67
    v_mul_f32 v21, v21, v17
    v_accvgpr_write_b32 a67, v21
    v_accvgpr_read_b32 v21, a68
    v_mul_f32 v21, v21, v17
    v_accvgpr_write_b32 a68, v21
    v_accvgpr_read_b32 v21, a69
    v_mul_f32 v21, v21, v17
    v_accvgpr_write_b32 a69, v21
    v_accvgpr_read_b32 v21, a70
    v_mul_f32 v21, v21, v17
    v_accvgpr_write_b32 a70, v21
    v_accvgpr_read_b32 v21, a71
    v_mul_f32 v21, v21, v17
    v_accvgpr_write_b32 a71, v21
    v_accvgpr_read_b32 v21, a72
    v_mul_f32 v21, v21, v17
    v_accvgpr_write_b32 a72, v21
    v_accvgpr_read_b32 v21, a73
    v_mul_f32 v21, v21, v17
    v_accvgpr_write_b32 a73, v21
    v_accvgpr_read_b32 v21, a74
    v_mul_f32 v21, v21, v17
    v_accvgpr_write_b32 a74, v21
    v_accvgpr_read_b32 v21, a75
    v_mul_f32 v21, v21, v17
    v_accvgpr_write_b32 a75, v21
    v_accvgpr_read_b32 v21, a76
    v_mul_f32 v21, v21, v17
    v_accvgpr_write_b32 a76, v21
    v_accvgpr_read_b32 v21, a77
    v_mul_f32 v21, v21, v17
    v_accvgpr_write_b32 a77, v21
    v_accvgpr_read_b32 v21, a78
    v_mul_f32 v21, v21, v17
    v_accvgpr_write_b32 a78, v21
    v_accvgpr_read_b32 v21, a79
    v_mul_f32 v21, v21, v17
    v_accvgpr_write_b32 a79, v21
    v_accvgpr_read_b32 v21, a80
    v_mul_f32 v21, v21, v17
    v_accvgpr_write_b32 a80, v21
    v_accvgpr_read_b32 v21, a81
    v_mul_f32 v21, v21, v17
    v_accvgpr_write_b32 a81, v21
    v_accvgpr_read_b32 v21, a82
    v_mul_f32 v21, v21, v17
    v_accvgpr_write_b32 a82, v21
    v_accvgpr_read_b32 v21, a83
    v_mul_f32 v21, v21, v17
    v_accvgpr_write_b32 a83, v21
    v_accvgpr_read_b32 v21, a84
    v_mul_f32 v21, v21, v17
    v_accvgpr_write_b32 a84, v21
    v_accvgpr_read_b32 v21, a85
    v_mul_f32 v21, v21, v17
    v_accvgpr_write_b32 a85, v21
    v_accvgpr_read_b32 v21, a86
    v_mul_f32 v21, v21, v17
    v_accvgpr_write_b32 a86, v21
    v_accvgpr_read_b32 v21, a87
    v_mul_f32 v21, v21, v17
    v_accvgpr_write_b32 a87, v21
    v_accvgpr_read_b32 v21, a88
    v_mul_f32 v21, v21, v17
    v_accvgpr_write_b32 a88, v21
    v_accvgpr_read_b32 v21, a89
    v_mul_f32 v21, v21, v17
    v_accvgpr_write_b32 a89, v21
    v_accvgpr_read_b32 v21, a90
    v_mul_f32 v21, v21, v17
    v_accvgpr_write_b32 a90, v21
    v_accvgpr_read_b32 v21, a91
    v_mul_f32 v21, v21, v17
    v_accvgpr_write_b32 a91, v21
    v_accvgpr_read_b32 v21, a92
    v_mul_f32 v21, v21, v17
    v_accvgpr_write_b32 a92, v21
    v_accvgpr_read_b32 v21, a93
    v_mul_f32 v21, v21, v17
    v_accvgpr_write_b32 a93, v21
    v_accvgpr_read_b32 v21, a94
    v_mul_f32 v21, v21, v17
    v_accvgpr_write_b32 a94, v21
    v_accvgpr_read_b32 v21, a95
    v_mul_f32 v21, v21, v17
    v_accvgpr_write_b32 a95, v21
    v_mov_b32 v20, v17
    v_mov_b32 v21, v17
    s_nop 1
    v_permlane16_swap_b32 v20, v21
    s_nop 1
    v_mul_f32 v148, v148, v20
    v_mul_f32 v149, v149, v21
    v_mul_f32 v150, v150, v20
    v_mul_f32 v151, v151, v21
    s_mov_b32 s35, 0
    s_nop 1
    s_branch LbackB_14
LrareA_19:
    v_max_f32 v141, v141, v143
    v_mov_b32 v20, v141
    v_mov_b32 v21, v141
    s_nop 1
    v_permlane32_swap_b32 v20, v21
    s_nop 1
    v_max_f32 v141, v20, v21
    v_sub_f32 v20, v143, v141
    v_mul_f32 v20, s44, v20
    v_exp_f32 v17, v20
    v_mov_b32 v143, v141
    v_mul_f32 v16, s44, v141
    v_sub_f32 v16, 0, v16
    v_add_f32 v15, 0x40b00000, v141
    v_mul_f32 v18, v18, v17
    v_mul_f32 v19, v19, v17
    s_mov_b32 s35, 1
    s_branch LbackA_20
LrareB_21:
    s_nop 15
    v_accvgpr_read_b32 v21, a32
    v_mul_f32 v21, v21, v17
    v_accvgpr_write_b32 a32, v21
    v_accvgpr_read_b32 v21, a33
    v_mul_f32 v21, v21, v17
    v_accvgpr_write_b32 a33, v21
    v_accvgpr_read_b32 v21, a34
    v_mul_f32 v21, v21, v17
    v_accvgpr_write_b32 a34, v21
    v_accvgpr_read_b32 v21, a35
    v_mul_f32 v21, v21, v17
    v_accvgpr_write_b32 a35, v21
    v_accvgpr_read_b32 v21, a36
    v_mul_f32 v21, v21, v17
    v_accvgpr_write_b32 a36, v21
    v_accvgpr_read_b32 v21, a37
    v_mul_f32 v21, v21, v17
    v_accvgpr_write_b32 a37, v21
    v_accvgpr_read_b32 v21, a38
    v_mul_f32 v21, v21, v17
    v_accvgpr_write_b32 a38, v21
    v_accvgpr_read_b32 v21, a39
    v_mul_f32 v21, v21, v17
    v_accvgpr_write_b32 a39, v21
    v_accvgpr_read_b32 v21, a40
    v_mul_f32 v21, v21, v17
    v_accvgpr_write_b32 a40, v21
    v_accvgpr_read_b32 v21, a41
    v_mul_f32 v21, v21, v17
    v_accvgpr_write_b32 a41, v21
    v_accvgpr_read_b32 v21, a42
    v_mul_f32 v21, v21, v17
    v_accvgpr_write_b32 a42, v21
    v_accvgpr_read_b32 v21, a43
    v_mul_f32 v21, v21, v17
    v_accvgpr_write_b32 a43, v21
    v_accvgpr_read_b32 v21, a44
    v_mul_f32 v21, v21, v17
    v_accvgpr_write_b32 a44, v21
    v_accvgpr_read_b32 v21, a45
    v_mul_f32 v21, v21, v17
    v_accvgpr_write_b32 a45, v21
    v_accvgpr_read_b32 v21, a46
    v_mul_f32 v21, v21, v17
    v_accvgpr_write_b32 a46, v21
    v_accvgpr_read_b32 v21, a47
    v_mul_f32 v21, v21, v17
    v_accvgpr_write_b32 a47, v21
    v_accvgpr_read_b32 v21, a48
    v_mul_f32 v21, v21, v17
    v_accvgpr_write_b32 a48, v21
    v_accvgpr_read_b32 v21, a49
    v_mul_f32 v21, v21, v17
    v_accvgpr_write_b32 a49, v21
    v_accvgpr_read_b32 v21, a50
    v_mul_f32 v21, v21, v17
    v_accvgpr_write_b32 a50, v21
    v_accvgpr_read_b32 v21, a51
    v_mul_f32 v21, v21, v17
    v_accvgpr_write_b32 a51, v21
    v_accvgpr_read_b32 v21, a52
    v_mul_f32 v21, v21, v17
    v_accvgpr_write_b32 a52, v21
    v_accvgpr_read_b32 v21, a53
    v_mul_f32 v21, v21, v17
    v_accvgpr_write_b32 a53, v21
    v_accvgpr_read_b32 v21, a54
    v_mul_f32 v21, v21, v17
    v_accvgpr_write_b32 a54, v21
    v_accvgpr_read_b32 v21, a55
    v_mul_f32 v21, v21, v17
    v_accvgpr_write_b32 a55, v21
    v_accvgpr_read_b32 v21, a56
    v_mul_f32 v21, v21, v17
    v_accvgpr_write_b32 a56, v21
    v_accvgpr_read_b32 v21, a57
    v_mul_f32 v21, v21, v17
    v_accvgpr_write_b32 a57, v21
    v_accvgpr_read_b32 v21, a58
    v_mul_f32 v21, v21, v17
    v_accvgpr_write_b32 a58, v21
    v_accvgpr_read_b32 v21, a59
    v_mul_f32 v21, v21, v17
    v_accvgpr_write_b32 a59, v21
    v_accvgpr_read_b32 v21, a60
    v_mul_f32 v21, v21, v17
    v_accvgpr_write_b32 a60, v21
    v_accvgpr_read_b32 v21, a61
    v_mul_f32 v21, v21, v17
    v_accvgpr_write_b32 a61, v21
    v_accvgpr_read_b32 v21, a62
    v_mul_f32 v21, v21, v17
    v_accvgpr_write_b32 a62, v21
    v_accvgpr_read_b32 v21, a63
    v_mul_f32 v21, v21, v17
    v_accvgpr_write_b32 a63, v21
    v_accvgpr_read_b32 v21, a64
    v_mul_f32 v21, v21, v17
    v_accvgpr_write_b32 a64, v21
    v_accvgpr_read_b32 v21, a65
    v_mul_f32 v21, v21, v17
    v_accvgpr_write_b32 a65, v21
    v_accvgpr_read_b32 v21, a66
    v_mul_f32 v21, v21, v17
    v_accvgpr_write_b32 a66, v21
    v_accvgpr_read_b32 v21, a67
    v_mul_f32 v21, v21, v17
    v_accvgpr_write_b32 a67, v21
    v_accvgpr_read_b32 v21, a68
    v_mul_f32 v21, v21, v17
    v_accvgpr_write_b32 a68, v21
    v_accvgpr_read_b32 v21, a69
    v_mul_f32 v21, v21, v17
    v_accvgpr_write_b32 a69, v21
    v_accvgpr_read_b32 v21, a70
    v_mul_f32 v21, v21, v17
    v_accvgpr_write_b32 a70, v21
    v_accvgpr_read_b32 v21, a71
    v_mul_f32 v21, v21, v17
    v_accvgpr_write_b32 a71, v21
    v_accvgpr_read_b32 v21, a72
    v_mul_f32 v21, v21, v17
    v_accvgpr_write_b32 a72, v21
    v_accvgpr_read_b32 v21, a73
    v_mul_f32 v21, v21, v17
    v_accvgpr_write_b32 a73, v21
    v_accvgpr_read_b32 v21, a74
    v_mul_f32 v21, v21, v17
    v_accvgpr_write_b32 a74, v21
    v_accvgpr_read_b32 v21, a75
    v_mul_f32 v21, v21, v17
    v_accvgpr_write_b32 a75, v21
    v_accvgpr_read_b32 v21, a76
    v_mul_f32 v21, v21, v17
    v_accvgpr_write_b32 a76, v21
    v_accvgpr_read_b32 v21, a77
    v_mul_f32 v21, v21, v17
    v_accvgpr_write_b32 a77, v21
    v_accvgpr_read_b32 v21, a78
    v_mul_f32 v21, v21, v17
    v_accvgpr_write_b32 a78, v21
    v_accvgpr_read_b32 v21, a79
    v_mul_f32 v21, v21, v17
    v_accvgpr_write_b32 a79, v21
    v_accvgpr_read_b32 v21, a80
    v_mul_f32 v21, v21, v17
    v_accvgpr_write_b32 a80, v21
    v_accvgpr_read_b32 v21, a81
    v_mul_f32 v21, v21, v17
    v_accvgpr_write_b32 a81, v21
    v_accvgpr_read_b32 v21, a82
    v_mul_f32 v21, v21, v17
    v_accvgpr_write_b32 a82, v21
    v_accvgpr_read_b32 v21, a83
    v_mul_f32 v21, v21, v17
    v_accvgpr_write_b32 a83, v21
    v_accvgpr_read_b32 v21, a84
    v_mul_f32 v21, v21, v17
    v_accvgpr_write_b32 a84, v21
    v_accvgpr_read_b32 v21, a85
    v_mul_f32 v21, v21, v17
    v_accvgpr_write_b32 a85, v21
    v_accvgpr_read_b32 v21, a86
    v_mul_f32 v21, v21, v17
    v_accvgpr_write_b32 a86, v21
    v_accvgpr_read_b32 v21, a87
    v_mul_f32 v21, v21, v17
    v_accvgpr_write_b32 a87, v21
    v_accvgpr_read_b32 v21, a88
    v_mul_f32 v21, v21, v17
    v_accvgpr_write_b32 a88, v21
    v_accvgpr_read_b32 v21, a89
    v_mul_f32 v21, v21, v17
    v_accvgpr_write_b32 a89, v21
    v_accvgpr_read_b32 v21, a90
    v_mul_f32 v21, v21, v17
    v_accvgpr_write_b32 a90, v21
    v_accvgpr_read_b32 v21, a91
    v_mul_f32 v21, v21, v17
    v_accvgpr_write_b32 a91, v21
    v_accvgpr_read_b32 v21, a92
    v_mul_f32 v21, v21, v17
    v_accvgpr_write_b32 a92, v21
    v_accvgpr_read_b32 v21, a93
    v_mul_f32 v21, v21, v17
    v_accvgpr_write_b32 a93, v21
    v_accvgpr_read_b32 v21, a94
    v_mul_f32 v21, v21, v17
    v_accvgpr_write_b32 a94, v21
    v_accvgpr_read_b32 v21, a95
    v_mul_f32 v21, v21, v17
    v_accvgpr_write_b32 a95, v21
    v_mov_b32 v20, v17
    v_mov_b32 v21, v17
    s_nop 1
    v_permlane16_swap_b32 v20, v21
    s_nop 1
    v_mul_f32 v148, v148, v20
    v_mul_f32 v149, v149, v21
    v_mul_f32 v150, v150, v20
    v_mul_f32 v151, v151, v21
    s_mov_b32 s35, 0
    s_nop 1
    s_branch LbackB_22
LrareA_27:
    v_max_f32 v141, v141, v143
    v_mov_b32 v20, v141
    v_mov_b32 v21, v141
    s_nop 1
    v_permlane32_swap_b32 v20, v21
    s_nop 1
    v_max_f32 v141, v20, v21
    v_sub_f32 v20, v143, v141
    v_mul_f32 v20, s44, v20
    v_exp_f32 v17, v20
    v_mov_b32 v143, v141
    v_mul_f32 v16, s44, v141
    v_sub_f32 v16, 0, v16
    v_add_f32 v15, 0x40b00000, v141
    v_mul_f32 v18, v18, v17
    v_mul_f32 v19, v19, v17
    s_mov_b32 s35, 1
    s_branch LbackA_28
LrareB_29:
    s_nop 15
    v_accvgpr_read_b32 v21, a32
    v_mul_f32 v21, v21, v17
    v_accvgpr_write_b32 a32, v21
    v_accvgpr_read_b32 v21, a33
    v_mul_f32 v21, v21, v17
    v_accvgpr_write_b32 a33, v21
    v_accvgpr_read_b32 v21, a34
    v_mul_f32 v21, v21, v17
    v_accvgpr_write_b32 a34, v21
    v_accvgpr_read_b32 v21, a35
    v_mul_f32 v21, v21, v17
    v_accvgpr_write_b32 a35, v21
    v_accvgpr_read_b32 v21, a36
    v_mul_f32 v21, v21, v17
    v_accvgpr_write_b32 a36, v21
    v_accvgpr_read_b32 v21, a37
    v_mul_f32 v21, v21, v17
    v_accvgpr_write_b32 a37, v21
    v_accvgpr_read_b32 v21, a38
    v_mul_f32 v21, v21, v17
    v_accvgpr_write_b32 a38, v21
    v_accvgpr_read_b32 v21, a39
    v_mul_f32 v21, v21, v17
    v_accvgpr_write_b32 a39, v21
    v_accvgpr_read_b32 v21, a40
    v_mul_f32 v21, v21, v17
    v_accvgpr_write_b32 a40, v21
    v_accvgpr_read_b32 v21, a41
    v_mul_f32 v21, v21, v17
    v_accvgpr_write_b32 a41, v21
    v_accvgpr_read_b32 v21, a42
    v_mul_f32 v21, v21, v17
    v_accvgpr_write_b32 a42, v21
    v_accvgpr_read_b32 v21, a43
    v_mul_f32 v21, v21, v17
    v_accvgpr_write_b32 a43, v21
    v_accvgpr_read_b32 v21, a44
    v_mul_f32 v21, v21, v17
    v_accvgpr_write_b32 a44, v21
    v_accvgpr_read_b32 v21, a45
    v_mul_f32 v21, v21, v17
    v_accvgpr_write_b32 a45, v21
    v_accvgpr_read_b32 v21, a46
    v_mul_f32 v21, v21, v17
    v_accvgpr_write_b32 a46, v21
    v_accvgpr_read_b32 v21, a47
    v_mul_f32 v21, v21, v17
    v_accvgpr_write_b32 a47, v21
    v_accvgpr_read_b32 v21, a48
    v_mul_f32 v21, v21, v17
    v_accvgpr_write_b32 a48, v21
    v_accvgpr_read_b32 v21, a49
    v_mul_f32 v21, v21, v17
    v_accvgpr_write_b32 a49, v21
    v_accvgpr_read_b32 v21, a50
    v_mul_f32 v21, v21, v17
    v_accvgpr_write_b32 a50, v21
    v_accvgpr_read_b32 v21, a51
    v_mul_f32 v21, v21, v17
    v_accvgpr_write_b32 a51, v21
    v_accvgpr_read_b32 v21, a52
    v_mul_f32 v21, v21, v17
    v_accvgpr_write_b32 a52, v21
    v_accvgpr_read_b32 v21, a53
    v_mul_f32 v21, v21, v17
    v_accvgpr_write_b32 a53, v21
    v_accvgpr_read_b32 v21, a54
    v_mul_f32 v21, v21, v17
    v_accvgpr_write_b32 a54, v21
    v_accvgpr_read_b32 v21, a55
    v_mul_f32 v21, v21, v17
    v_accvgpr_write_b32 a55, v21
    v_accvgpr_read_b32 v21, a56
    v_mul_f32 v21, v21, v17
    v_accvgpr_write_b32 a56, v21
    v_accvgpr_read_b32 v21, a57
    v_mul_f32 v21, v21, v17
    v_accvgpr_write_b32 a57, v21
    v_accvgpr_read_b32 v21, a58
    v_mul_f32 v21, v21, v17
    v_accvgpr_write_b32 a58, v21
    v_accvgpr_read_b32 v21, a59
    v_mul_f32 v21, v21, v17
    v_accvgpr_write_b32 a59, v21
    v_accvgpr_read_b32 v21, a60
    v_mul_f32 v21, v21, v17
    v_accvgpr_write_b32 a60, v21
    v_accvgpr_read_b32 v21, a61
    v_mul_f32 v21, v21, v17
    v_accvgpr_write_b32 a61, v21
    v_accvgpr_read_b32 v21, a62
    v_mul_f32 v21, v21, v17
    v_accvgpr_write_b32 a62, v21
    v_accvgpr_read_b32 v21, a63
    v_mul_f32 v21, v21, v17
    v_accvgpr_write_b32 a63, v21
    v_accvgpr_read_b32 v21, a64
    v_mul_f32 v21, v21, v17
    v_accvgpr_write_b32 a64, v21
    v_accvgpr_read_b32 v21, a65
    v_mul_f32 v21, v21, v17
    v_accvgpr_write_b32 a65, v21
    v_accvgpr_read_b32 v21, a66
    v_mul_f32 v21, v21, v17
    v_accvgpr_write_b32 a66, v21
    v_accvgpr_read_b32 v21, a67
    v_mul_f32 v21, v21, v17
    v_accvgpr_write_b32 a67, v21
    v_accvgpr_read_b32 v21, a68
    v_mul_f32 v21, v21, v17
    v_accvgpr_write_b32 a68, v21
    v_accvgpr_read_b32 v21, a69
    v_mul_f32 v21, v21, v17
    v_accvgpr_write_b32 a69, v21
    v_accvgpr_read_b32 v21, a70
    v_mul_f32 v21, v21, v17
    v_accvgpr_write_b32 a70, v21
    v_accvgpr_read_b32 v21, a71
    v_mul_f32 v21, v21, v17
    v_accvgpr_write_b32 a71, v21
    v_accvgpr_read_b32 v21, a72
    v_mul_f32 v21, v21, v17
    v_accvgpr_write_b32 a72, v21
    v_accvgpr_read_b32 v21, a73
    v_mul_f32 v21, v21, v17
    v_accvgpr_write_b32 a73, v21
    v_accvgpr_read_b32 v21, a74
    v_mul_f32 v21, v21, v17
    v_accvgpr_write_b32 a74, v21
    v_accvgpr_read_b32 v21, a75
    v_mul_f32 v21, v21, v17
    v_accvgpr_write_b32 a75, v21
    v_accvgpr_read_b32 v21, a76
    v_mul_f32 v21, v21, v17
    v_accvgpr_write_b32 a76, v21
    v_accvgpr_read_b32 v21, a77
    v_mul_f32 v21, v21, v17
    v_accvgpr_write_b32 a77, v21
    v_accvgpr_read_b32 v21, a78
    v_mul_f32 v21, v21, v17
    v_accvgpr_write_b32 a78, v21
    v_accvgpr_read_b32 v21, a79
    v_mul_f32 v21, v21, v17
    v_accvgpr_write_b32 a79, v21
    v_accvgpr_read_b32 v21, a80
    v_mul_f32 v21, v21, v17
    v_accvgpr_write_b32 a80, v21
    v_accvgpr_read_b32 v21, a81
    v_mul_f32 v21, v21, v17
    v_accvgpr_write_b32 a81, v21
    v_accvgpr_read_b32 v21, a82
    v_mul_f32 v21, v21, v17
    v_accvgpr_write_b32 a82, v21
    v_accvgpr_read_b32 v21, a83
    v_mul_f32 v21, v21, v17
    v_accvgpr_write_b32 a83, v21
    v_accvgpr_read_b32 v21, a84
    v_mul_f32 v21, v21, v17
    v_accvgpr_write_b32 a84, v21
    v_accvgpr_read_b32 v21, a85
    v_mul_f32 v21, v21, v17
    v_accvgpr_write_b32 a85, v21
    v_accvgpr_read_b32 v21, a86
    v_mul_f32 v21, v21, v17
    v_accvgpr_write_b32 a86, v21
    v_accvgpr_read_b32 v21, a87
    v_mul_f32 v21, v21, v17
    v_accvgpr_write_b32 a87, v21
    v_accvgpr_read_b32 v21, a88
    v_mul_f32 v21, v21, v17
    v_accvgpr_write_b32 a88, v21
    v_accvgpr_read_b32 v21, a89
    v_mul_f32 v21, v21, v17
    v_accvgpr_write_b32 a89, v21
    v_accvgpr_read_b32 v21, a90
    v_mul_f32 v21, v21, v17
    v_accvgpr_write_b32 a90, v21
    v_accvgpr_read_b32 v21, a91
    v_mul_f32 v21, v21, v17
    v_accvgpr_write_b32 a91, v21
    v_accvgpr_read_b32 v21, a92
    v_mul_f32 v21, v21, v17
    v_accvgpr_write_b32 a92, v21
    v_accvgpr_read_b32 v21, a93
    v_mul_f32 v21, v21, v17
    v_accvgpr_write_b32 a93, v21
    v_accvgpr_read_b32 v21, a94
    v_mul_f32 v21, v21, v17
    v_accvgpr_write_b32 a94, v21
    v_accvgpr_read_b32 v21, a95
    v_mul_f32 v21, v21, v17
    v_accvgpr_write_b32 a95, v21
    v_mov_b32 v20, v17
    v_mov_b32 v21, v17
    s_nop 1
    v_permlane16_swap_b32 v20, v21
    s_nop 1
    v_mul_f32 v148, v148, v20
    v_mul_f32 v149, v149, v21
    v_mul_f32 v150, v150, v20
    v_mul_f32 v151, v151, v21
    s_mov_b32 s35, 0
    s_nop 1
    s_branch LbackB_30
LrareA_35:
    v_max_f32 v141, v141, v143
    v_mov_b32 v20, v141
    v_mov_b32 v21, v141
    s_nop 1
    v_permlane32_swap_b32 v20, v21
    s_nop 1
    v_max_f32 v141, v20, v21
    v_sub_f32 v20, v143, v141
    v_mul_f32 v20, s44, v20
    v_exp_f32 v17, v20
    v_mov_b32 v143, v141
    v_mul_f32 v16, s44, v141
    v_sub_f32 v16, 0, v16
    v_add_f32 v15, 0x40b00000, v141
    v_mul_f32 v18, v18, v17
    v_mul_f32 v19, v19, v17
    s_mov_b32 s35, 1
    s_branch LbackA_36
LrareB_37:
    s_nop 15
    v_accvgpr_read_b32 v21, a32
    v_mul_f32 v21, v21, v17
    v_accvgpr_write_b32 a32, v21
    v_accvgpr_read_b32 v21, a33
    v_mul_f32 v21, v21, v17
    v_accvgpr_write_b32 a33, v21
    v_accvgpr_read_b32 v21, a34
    v_mul_f32 v21, v21, v17
    v_accvgpr_write_b32 a34, v21
    v_accvgpr_read_b32 v21, a35
    v_mul_f32 v21, v21, v17
    v_accvgpr_write_b32 a35, v21
    v_accvgpr_read_b32 v21, a36
    v_mul_f32 v21, v21, v17
    v_accvgpr_write_b32 a36, v21
    v_accvgpr_read_b32 v21, a37
    v_mul_f32 v21, v21, v17
    v_accvgpr_write_b32 a37, v21
    v_accvgpr_read_b32 v21, a38
    v_mul_f32 v21, v21, v17
    v_accvgpr_write_b32 a38, v21
    v_accvgpr_read_b32 v21, a39
    v_mul_f32 v21, v21, v17
    v_accvgpr_write_b32 a39, v21
    v_accvgpr_read_b32 v21, a40
    v_mul_f32 v21, v21, v17
    v_accvgpr_write_b32 a40, v21
    v_accvgpr_read_b32 v21, a41
    v_mul_f32 v21, v21, v17
    v_accvgpr_write_b32 a41, v21
    v_accvgpr_read_b32 v21, a42
    v_mul_f32 v21, v21, v17
    v_accvgpr_write_b32 a42, v21
    v_accvgpr_read_b32 v21, a43
    v_mul_f32 v21, v21, v17
    v_accvgpr_write_b32 a43, v21
    v_accvgpr_read_b32 v21, a44
    v_mul_f32 v21, v21, v17
    v_accvgpr_write_b32 a44, v21
    v_accvgpr_read_b32 v21, a45
    v_mul_f32 v21, v21, v17
    v_accvgpr_write_b32 a45, v21
    v_accvgpr_read_b32 v21, a46
    v_mul_f32 v21, v21, v17
    v_accvgpr_write_b32 a46, v21
    v_accvgpr_read_b32 v21, a47
    v_mul_f32 v21, v21, v17
    v_accvgpr_write_b32 a47, v21
    v_accvgpr_read_b32 v21, a48
    v_mul_f32 v21, v21, v17
    v_accvgpr_write_b32 a48, v21
    v_accvgpr_read_b32 v21, a49
    v_mul_f32 v21, v21, v17
    v_accvgpr_write_b32 a49, v21
    v_accvgpr_read_b32 v21, a50
    v_mul_f32 v21, v21, v17
    v_accvgpr_write_b32 a50, v21
    v_accvgpr_read_b32 v21, a51
    v_mul_f32 v21, v21, v17
    v_accvgpr_write_b32 a51, v21
    v_accvgpr_read_b32 v21, a52
    v_mul_f32 v21, v21, v17
    v_accvgpr_write_b32 a52, v21
    v_accvgpr_read_b32 v21, a53
    v_mul_f32 v21, v21, v17
    v_accvgpr_write_b32 a53, v21
    v_accvgpr_read_b32 v21, a54
    v_mul_f32 v21, v21, v17
    v_accvgpr_write_b32 a54, v21
    v_accvgpr_read_b32 v21, a55
    v_mul_f32 v21, v21, v17
    v_accvgpr_write_b32 a55, v21
    v_accvgpr_read_b32 v21, a56
    v_mul_f32 v21, v21, v17
    v_accvgpr_write_b32 a56, v21
    v_accvgpr_read_b32 v21, a57
    v_mul_f32 v21, v21, v17
    v_accvgpr_write_b32 a57, v21
    v_accvgpr_read_b32 v21, a58
    v_mul_f32 v21, v21, v17
    v_accvgpr_write_b32 a58, v21
    v_accvgpr_read_b32 v21, a59
    v_mul_f32 v21, v21, v17
    v_accvgpr_write_b32 a59, v21
    v_accvgpr_read_b32 v21, a60
    v_mul_f32 v21, v21, v17
    v_accvgpr_write_b32 a60, v21
    v_accvgpr_read_b32 v21, a61
    v_mul_f32 v21, v21, v17
    v_accvgpr_write_b32 a61, v21
    v_accvgpr_read_b32 v21, a62
    v_mul_f32 v21, v21, v17
    v_accvgpr_write_b32 a62, v21
    v_accvgpr_read_b32 v21, a63
    v_mul_f32 v21, v21, v17
    v_accvgpr_write_b32 a63, v21
    v_accvgpr_read_b32 v21, a64
    v_mul_f32 v21, v21, v17
    v_accvgpr_write_b32 a64, v21
    v_accvgpr_read_b32 v21, a65
    v_mul_f32 v21, v21, v17
    v_accvgpr_write_b32 a65, v21
    v_accvgpr_read_b32 v21, a66
    v_mul_f32 v21, v21, v17
    v_accvgpr_write_b32 a66, v21
    v_accvgpr_read_b32 v21, a67
    v_mul_f32 v21, v21, v17
    v_accvgpr_write_b32 a67, v21
    v_accvgpr_read_b32 v21, a68
    v_mul_f32 v21, v21, v17
    v_accvgpr_write_b32 a68, v21
    v_accvgpr_read_b32 v21, a69
    v_mul_f32 v21, v21, v17
    v_accvgpr_write_b32 a69, v21
    v_accvgpr_read_b32 v21, a70
    v_mul_f32 v21, v21, v17
    v_accvgpr_write_b32 a70, v21
    v_accvgpr_read_b32 v21, a71
    v_mul_f32 v21, v21, v17
    v_accvgpr_write_b32 a71, v21
    v_accvgpr_read_b32 v21, a72
    v_mul_f32 v21, v21, v17
    v_accvgpr_write_b32 a72, v21
    v_accvgpr_read_b32 v21, a73
    v_mul_f32 v21, v21, v17
    v_accvgpr_write_b32 a73, v21
    v_accvgpr_read_b32 v21, a74
    v_mul_f32 v21, v21, v17
    v_accvgpr_write_b32 a74, v21
    v_accvgpr_read_b32 v21, a75
    v_mul_f32 v21, v21, v17
    v_accvgpr_write_b32 a75, v21
    v_accvgpr_read_b32 v21, a76
    v_mul_f32 v21, v21, v17
    v_accvgpr_write_b32 a76, v21
    v_accvgpr_read_b32 v21, a77
    v_mul_f32 v21, v21, v17
    v_accvgpr_write_b32 a77, v21
    v_accvgpr_read_b32 v21, a78
    v_mul_f32 v21, v21, v17
    v_accvgpr_write_b32 a78, v21
    v_accvgpr_read_b32 v21, a79
    v_mul_f32 v21, v21, v17
    v_accvgpr_write_b32 a79, v21
    v_accvgpr_read_b32 v21, a80
    v_mul_f32 v21, v21, v17
    v_accvgpr_write_b32 a80, v21
    v_accvgpr_read_b32 v21, a81
    v_mul_f32 v21, v21, v17
    v_accvgpr_write_b32 a81, v21
    v_accvgpr_read_b32 v21, a82
    v_mul_f32 v21, v21, v17
    v_accvgpr_write_b32 a82, v21
    v_accvgpr_read_b32 v21, a83
    v_mul_f32 v21, v21, v17
    v_accvgpr_write_b32 a83, v21
    v_accvgpr_read_b32 v21, a84
    v_mul_f32 v21, v21, v17
    v_accvgpr_write_b32 a84, v21
    v_accvgpr_read_b32 v21, a85
    v_mul_f32 v21, v21, v17
    v_accvgpr_write_b32 a85, v21
    v_accvgpr_read_b32 v21, a86
    v_mul_f32 v21, v21, v17
    v_accvgpr_write_b32 a86, v21
    v_accvgpr_read_b32 v21, a87
    v_mul_f32 v21, v21, v17
    v_accvgpr_write_b32 a87, v21
    v_accvgpr_read_b32 v21, a88
    v_mul_f32 v21, v21, v17
    v_accvgpr_write_b32 a88, v21
    v_accvgpr_read_b32 v21, a89
    v_mul_f32 v21, v21, v17
    v_accvgpr_write_b32 a89, v21
    v_accvgpr_read_b32 v21, a90
    v_mul_f32 v21, v21, v17
    v_accvgpr_write_b32 a90, v21
    v_accvgpr_read_b32 v21, a91
    v_mul_f32 v21, v21, v17
    v_accvgpr_write_b32 a91, v21
    v_accvgpr_read_b32 v21, a92
    v_mul_f32 v21, v21, v17
    v_accvgpr_write_b32 a92, v21
    v_accvgpr_read_b32 v21, a93
    v_mul_f32 v21, v21, v17
    v_accvgpr_write_b32 a93, v21
    v_accvgpr_read_b32 v21, a94
    v_mul_f32 v21, v21, v17
    v_accvgpr_write_b32 a94, v21
    v_accvgpr_read_b32 v21, a95
    v_mul_f32 v21, v21, v17
    v_accvgpr_write_b32 a95, v21
    v_mov_b32 v20, v17
    v_mov_b32 v21, v17
    s_nop 1
    v_permlane16_swap_b32 v20, v21
    s_nop 1
    v_mul_f32 v148, v148, v20
    v_mul_f32 v149, v149, v21
    v_mul_f32 v150, v150, v20
    v_mul_f32 v151, v151, v21
    s_mov_b32 s35, 0
    s_nop 1
    s_branch LbackB_38
LrareA_43:
    v_max_f32 v141, v141, v143
    v_mov_b32 v20, v141
    v_mov_b32 v21, v141
    s_nop 1
    v_permlane32_swap_b32 v20, v21
    s_nop 1
    v_max_f32 v141, v20, v21
    v_sub_f32 v20, v143, v141
    v_mul_f32 v20, s44, v20
    v_exp_f32 v17, v20
    v_mov_b32 v143, v141
    v_mul_f32 v16, s44, v141
    v_sub_f32 v16, 0, v16
    v_add_f32 v15, 0x40b00000, v141
    v_mul_f32 v18, v18, v17
    v_mul_f32 v19, v19, v17
    s_mov_b32 s35, 1
    s_branch LbackA_44
LrareB_45:
    s_nop 15
    v_accvgpr_read_b32 v21, a32
    v_mul_f32 v21, v21, v17
    v_accvgpr_write_b32 a32, v21
    v_accvgpr_read_b32 v21, a33
    v_mul_f32 v21, v21, v17
    v_accvgpr_write_b32 a33, v21
    v_accvgpr_read_b32 v21, a34
    v_mul_f32 v21, v21, v17
    v_accvgpr_write_b32 a34, v21
    v_accvgpr_read_b32 v21, a35
    v_mul_f32 v21, v21, v17
    v_accvgpr_write_b32 a35, v21
    v_accvgpr_read_b32 v21, a36
    v_mul_f32 v21, v21, v17
    v_accvgpr_write_b32 a36, v21
    v_accvgpr_read_b32 v21, a37
    v_mul_f32 v21, v21, v17
    v_accvgpr_write_b32 a37, v21
    v_accvgpr_read_b32 v21, a38
    v_mul_f32 v21, v21, v17
    v_accvgpr_write_b32 a38, v21
    v_accvgpr_read_b32 v21, a39
    v_mul_f32 v21, v21, v17
    v_accvgpr_write_b32 a39, v21
    v_accvgpr_read_b32 v21, a40
    v_mul_f32 v21, v21, v17
    v_accvgpr_write_b32 a40, v21
    v_accvgpr_read_b32 v21, a41
    v_mul_f32 v21, v21, v17
    v_accvgpr_write_b32 a41, v21
    v_accvgpr_read_b32 v21, a42
    v_mul_f32 v21, v21, v17
    v_accvgpr_write_b32 a42, v21
    v_accvgpr_read_b32 v21, a43
    v_mul_f32 v21, v21, v17
    v_accvgpr_write_b32 a43, v21
    v_accvgpr_read_b32 v21, a44
    v_mul_f32 v21, v21, v17
    v_accvgpr_write_b32 a44, v21
    v_accvgpr_read_b32 v21, a45
    v_mul_f32 v21, v21, v17
    v_accvgpr_write_b32 a45, v21
    v_accvgpr_read_b32 v21, a46
    v_mul_f32 v21, v21, v17
    v_accvgpr_write_b32 a46, v21
    v_accvgpr_read_b32 v21, a47
    v_mul_f32 v21, v21, v17
    v_accvgpr_write_b32 a47, v21
    v_accvgpr_read_b32 v21, a48
    v_mul_f32 v21, v21, v17
    v_accvgpr_write_b32 a48, v21
    v_accvgpr_read_b32 v21, a49
    v_mul_f32 v21, v21, v17
    v_accvgpr_write_b32 a49, v21
    v_accvgpr_read_b32 v21, a50
    v_mul_f32 v21, v21, v17
    v_accvgpr_write_b32 a50, v21
    v_accvgpr_read_b32 v21, a51
    v_mul_f32 v21, v21, v17
    v_accvgpr_write_b32 a51, v21
    v_accvgpr_read_b32 v21, a52
    v_mul_f32 v21, v21, v17
    v_accvgpr_write_b32 a52, v21
    v_accvgpr_read_b32 v21, a53
    v_mul_f32 v21, v21, v17
    v_accvgpr_write_b32 a53, v21
    v_accvgpr_read_b32 v21, a54
    v_mul_f32 v21, v21, v17
    v_accvgpr_write_b32 a54, v21
    v_accvgpr_read_b32 v21, a55
    v_mul_f32 v21, v21, v17
    v_accvgpr_write_b32 a55, v21
    v_accvgpr_read_b32 v21, a56
    v_mul_f32 v21, v21, v17
    v_accvgpr_write_b32 a56, v21
    v_accvgpr_read_b32 v21, a57
    v_mul_f32 v21, v21, v17
    v_accvgpr_write_b32 a57, v21
    v_accvgpr_read_b32 v21, a58
    v_mul_f32 v21, v21, v17
    v_accvgpr_write_b32 a58, v21
    v_accvgpr_read_b32 v21, a59
    v_mul_f32 v21, v21, v17
    v_accvgpr_write_b32 a59, v21
    v_accvgpr_read_b32 v21, a60
    v_mul_f32 v21, v21, v17
    v_accvgpr_write_b32 a60, v21
    v_accvgpr_read_b32 v21, a61
    v_mul_f32 v21, v21, v17
    v_accvgpr_write_b32 a61, v21
    v_accvgpr_read_b32 v21, a62
    v_mul_f32 v21, v21, v17
    v_accvgpr_write_b32 a62, v21
    v_accvgpr_read_b32 v21, a63
    v_mul_f32 v21, v21, v17
    v_accvgpr_write_b32 a63, v21
    v_accvgpr_read_b32 v21, a64
    v_mul_f32 v21, v21, v17
    v_accvgpr_write_b32 a64, v21
    v_accvgpr_read_b32 v21, a65
    v_mul_f32 v21, v21, v17
    v_accvgpr_write_b32 a65, v21
    v_accvgpr_read_b32 v21, a66
    v_mul_f32 v21, v21, v17
    v_accvgpr_write_b32 a66, v21
    v_accvgpr_read_b32 v21, a67
    v_mul_f32 v21, v21, v17
    v_accvgpr_write_b32 a67, v21
    v_accvgpr_read_b32 v21, a68
    v_mul_f32 v21, v21, v17
    v_accvgpr_write_b32 a68, v21
    v_accvgpr_read_b32 v21, a69
    v_mul_f32 v21, v21, v17
    v_accvgpr_write_b32 a69, v21
    v_accvgpr_read_b32 v21, a70
    v_mul_f32 v21, v21, v17
    v_accvgpr_write_b32 a70, v21
    v_accvgpr_read_b32 v21, a71
    v_mul_f32 v21, v21, v17
    v_accvgpr_write_b32 a71, v21
    v_accvgpr_read_b32 v21, a72
    v_mul_f32 v21, v21, v17
    v_accvgpr_write_b32 a72, v21
    v_accvgpr_read_b32 v21, a73
    v_mul_f32 v21, v21, v17
    v_accvgpr_write_b32 a73, v21
    v_accvgpr_read_b32 v21, a74
    v_mul_f32 v21, v21, v17
    v_accvgpr_write_b32 a74, v21
    v_accvgpr_read_b32 v21, a75
    v_mul_f32 v21, v21, v17
    v_accvgpr_write_b32 a75, v21
    v_accvgpr_read_b32 v21, a76
    v_mul_f32 v21, v21, v17
    v_accvgpr_write_b32 a76, v21
    v_accvgpr_read_b32 v21, a77
    v_mul_f32 v21, v21, v17
    v_accvgpr_write_b32 a77, v21
    v_accvgpr_read_b32 v21, a78
    v_mul_f32 v21, v21, v17
    v_accvgpr_write_b32 a78, v21
    v_accvgpr_read_b32 v21, a79
    v_mul_f32 v21, v21, v17
    v_accvgpr_write_b32 a79, v21
    v_accvgpr_read_b32 v21, a80
    v_mul_f32 v21, v21, v17
    v_accvgpr_write_b32 a80, v21
    v_accvgpr_read_b32 v21, a81
    v_mul_f32 v21, v21, v17
    v_accvgpr_write_b32 a81, v21
    v_accvgpr_read_b32 v21, a82
    v_mul_f32 v21, v21, v17
    v_accvgpr_write_b32 a82, v21
    v_accvgpr_read_b32 v21, a83
    v_mul_f32 v21, v21, v17
    v_accvgpr_write_b32 a83, v21
    v_accvgpr_read_b32 v21, a84
    v_mul_f32 v21, v21, v17
    v_accvgpr_write_b32 a84, v21
    v_accvgpr_read_b32 v21, a85
    v_mul_f32 v21, v21, v17
    v_accvgpr_write_b32 a85, v21
    v_accvgpr_read_b32 v21, a86
    v_mul_f32 v21, v21, v17
    v_accvgpr_write_b32 a86, v21
    v_accvgpr_read_b32 v21, a87
    v_mul_f32 v21, v21, v17
    v_accvgpr_write_b32 a87, v21
    v_accvgpr_read_b32 v21, a88
    v_mul_f32 v21, v21, v17
    v_accvgpr_write_b32 a88, v21
    v_accvgpr_read_b32 v21, a89
    v_mul_f32 v21, v21, v17
    v_accvgpr_write_b32 a89, v21
    v_accvgpr_read_b32 v21, a90
    v_mul_f32 v21, v21, v17
    v_accvgpr_write_b32 a90, v21
    v_accvgpr_read_b32 v21, a91
    v_mul_f32 v21, v21, v17
    v_accvgpr_write_b32 a91, v21
    v_accvgpr_read_b32 v21, a92
    v_mul_f32 v21, v21, v17
    v_accvgpr_write_b32 a92, v21
    v_accvgpr_read_b32 v21, a93
    v_mul_f32 v21, v21, v17
    v_accvgpr_write_b32 a93, v21
    v_accvgpr_read_b32 v21, a94
    v_mul_f32 v21, v21, v17
    v_accvgpr_write_b32 a94, v21
    v_accvgpr_read_b32 v21, a95
    v_mul_f32 v21, v21, v17
    v_accvgpr_write_b32 a95, v21
    v_mov_b32 v20, v17
    v_mov_b32 v21, v17
    s_nop 1
    v_permlane16_swap_b32 v20, v21
    s_nop 1
    v_mul_f32 v148, v148, v20
    v_mul_f32 v149, v149, v21
    v_mul_f32 v150, v150, v20
    v_mul_f32 v151, v151, v21
    s_mov_b32 s35, 0
    s_nop 1
    s_branch LbackB_46
LrareA_51:
    v_max_f32 v141, v141, v143
    v_mov_b32 v20, v141
    v_mov_b32 v21, v141
    s_nop 1
    v_permlane32_swap_b32 v20, v21
    s_nop 1
    v_max_f32 v141, v20, v21
    v_sub_f32 v20, v143, v141
    v_mul_f32 v20, s44, v20
    v_exp_f32 v17, v20
    v_mov_b32 v143, v141
    v_mul_f32 v16, s44, v141
    v_sub_f32 v16, 0, v16
    v_add_f32 v15, 0x40b00000, v141
    v_mul_f32 v18, v18, v17
    v_mul_f32 v19, v19, v17
    s_mov_b32 s35, 1
    s_branch LbackA_52
LrareB_53:
    s_nop 15
    v_accvgpr_read_b32 v21, a32
    v_mul_f32 v21, v21, v17
    v_accvgpr_write_b32 a32, v21
    v_accvgpr_read_b32 v21, a33
    v_mul_f32 v21, v21, v17
    v_accvgpr_write_b32 a33, v21
    v_accvgpr_read_b32 v21, a34
    v_mul_f32 v21, v21, v17
    v_accvgpr_write_b32 a34, v21
    v_accvgpr_read_b32 v21, a35
    v_mul_f32 v21, v21, v17
    v_accvgpr_write_b32 a35, v21
    v_accvgpr_read_b32 v21, a36
    v_mul_f32 v21, v21, v17
    v_accvgpr_write_b32 a36, v21
    v_accvgpr_read_b32 v21, a37
    v_mul_f32 v21, v21, v17
    v_accvgpr_write_b32 a37, v21
    v_accvgpr_read_b32 v21, a38
    v_mul_f32 v21, v21, v17
    v_accvgpr_write_b32 a38, v21
    v_accvgpr_read_b32 v21, a39
    v_mul_f32 v21, v21, v17
    v_accvgpr_write_b32 a39, v21
    v_accvgpr_read_b32 v21, a40
    v_mul_f32 v21, v21, v17
    v_accvgpr_write_b32 a40, v21
    v_accvgpr_read_b32 v21, a41
    v_mul_f32 v21, v21, v17
    v_accvgpr_write_b32 a41, v21
    v_accvgpr_read_b32 v21, a42
    v_mul_f32 v21, v21, v17
    v_accvgpr_write_b32 a42, v21
    v_accvgpr_read_b32 v21, a43
    v_mul_f32 v21, v21, v17
    v_accvgpr_write_b32 a43, v21
    v_accvgpr_read_b32 v21, a44
    v_mul_f32 v21, v21, v17
    v_accvgpr_write_b32 a44, v21
    v_accvgpr_read_b32 v21, a45
    v_mul_f32 v21, v21, v17
    v_accvgpr_write_b32 a45, v21
    v_accvgpr_read_b32 v21, a46
    v_mul_f32 v21, v21, v17
    v_accvgpr_write_b32 a46, v21
    v_accvgpr_read_b32 v21, a47
    v_mul_f32 v21, v21, v17
    v_accvgpr_write_b32 a47, v21
    v_accvgpr_read_b32 v21, a48
    v_mul_f32 v21, v21, v17
    v_accvgpr_write_b32 a48, v21
    v_accvgpr_read_b32 v21, a49
    v_mul_f32 v21, v21, v17
    v_accvgpr_write_b32 a49, v21
    v_accvgpr_read_b32 v21, a50
    v_mul_f32 v21, v21, v17
    v_accvgpr_write_b32 a50, v21
    v_accvgpr_read_b32 v21, a51
    v_mul_f32 v21, v21, v17
    v_accvgpr_write_b32 a51, v21
    v_accvgpr_read_b32 v21, a52
    v_mul_f32 v21, v21, v17
    v_accvgpr_write_b32 a52, v21
    v_accvgpr_read_b32 v21, a53
    v_mul_f32 v21, v21, v17
    v_accvgpr_write_b32 a53, v21
    v_accvgpr_read_b32 v21, a54
    v_mul_f32 v21, v21, v17
    v_accvgpr_write_b32 a54, v21
    v_accvgpr_read_b32 v21, a55
    v_mul_f32 v21, v21, v17
    v_accvgpr_write_b32 a55, v21
    v_accvgpr_read_b32 v21, a56
    v_mul_f32 v21, v21, v17
    v_accvgpr_write_b32 a56, v21
    v_accvgpr_read_b32 v21, a57
    v_mul_f32 v21, v21, v17
    v_accvgpr_write_b32 a57, v21
    v_accvgpr_read_b32 v21, a58
    v_mul_f32 v21, v21, v17
    v_accvgpr_write_b32 a58, v21
    v_accvgpr_read_b32 v21, a59
    v_mul_f32 v21, v21, v17
    v_accvgpr_write_b32 a59, v21
    v_accvgpr_read_b32 v21, a60
    v_mul_f32 v21, v21, v17
    v_accvgpr_write_b32 a60, v21
    v_accvgpr_read_b32 v21, a61
    v_mul_f32 v21, v21, v17
    v_accvgpr_write_b32 a61, v21
    v_accvgpr_read_b32 v21, a62
    v_mul_f32 v21, v21, v17
    v_accvgpr_write_b32 a62, v21
    v_accvgpr_read_b32 v21, a63
    v_mul_f32 v21, v21, v17
    v_accvgpr_write_b32 a63, v21
    v_accvgpr_read_b32 v21, a64
    v_mul_f32 v21, v21, v17
    v_accvgpr_write_b32 a64, v21
    v_accvgpr_read_b32 v21, a65
    v_mul_f32 v21, v21, v17
    v_accvgpr_write_b32 a65, v21
    v_accvgpr_read_b32 v21, a66
    v_mul_f32 v21, v21, v17
    v_accvgpr_write_b32 a66, v21
    v_accvgpr_read_b32 v21, a67
    v_mul_f32 v21, v21, v17
    v_accvgpr_write_b32 a67, v21
    v_accvgpr_read_b32 v21, a68
    v_mul_f32 v21, v21, v17
    v_accvgpr_write_b32 a68, v21
    v_accvgpr_read_b32 v21, a69
    v_mul_f32 v21, v21, v17
    v_accvgpr_write_b32 a69, v21
    v_accvgpr_read_b32 v21, a70
    v_mul_f32 v21, v21, v17
    v_accvgpr_write_b32 a70, v21
    v_accvgpr_read_b32 v21, a71
    v_mul_f32 v21, v21, v17
    v_accvgpr_write_b32 a71, v21
    v_accvgpr_read_b32 v21, a72
    v_mul_f32 v21, v21, v17
    v_accvgpr_write_b32 a72, v21
    v_accvgpr_read_b32 v21, a73
    v_mul_f32 v21, v21, v17
    v_accvgpr_write_b32 a73, v21
    v_accvgpr_read_b32 v21, a74
    v_mul_f32 v21, v21, v17
    v_accvgpr_write_b32 a74, v21
    v_accvgpr_read_b32 v21, a75
    v_mul_f32 v21, v21, v17
    v_accvgpr_write_b32 a75, v21
    v_accvgpr_read_b32 v21, a76
    v_mul_f32 v21, v21, v17
    v_accvgpr_write_b32 a76, v21
    v_accvgpr_read_b32 v21, a77
    v_mul_f32 v21, v21, v17
    v_accvgpr_write_b32 a77, v21
    v_accvgpr_read_b32 v21, a78
    v_mul_f32 v21, v21, v17
    v_accvgpr_write_b32 a78, v21
    v_accvgpr_read_b32 v21, a79
    v_mul_f32 v21, v21, v17
    v_accvgpr_write_b32 a79, v21
    v_accvgpr_read_b32 v21, a80
    v_mul_f32 v21, v21, v17
    v_accvgpr_write_b32 a80, v21
    v_accvgpr_read_b32 v21, a81
    v_mul_f32 v21, v21, v17
    v_accvgpr_write_b32 a81, v21
    v_accvgpr_read_b32 v21, a82
    v_mul_f32 v21, v21, v17
    v_accvgpr_write_b32 a82, v21
    v_accvgpr_read_b32 v21, a83
    v_mul_f32 v21, v21, v17
    v_accvgpr_write_b32 a83, v21
    v_accvgpr_read_b32 v21, a84
    v_mul_f32 v21, v21, v17
    v_accvgpr_write_b32 a84, v21
    v_accvgpr_read_b32 v21, a85
    v_mul_f32 v21, v21, v17
    v_accvgpr_write_b32 a85, v21
    v_accvgpr_read_b32 v21, a86
    v_mul_f32 v21, v21, v17
    v_accvgpr_write_b32 a86, v21
    v_accvgpr_read_b32 v21, a87
    v_mul_f32 v21, v21, v17
    v_accvgpr_write_b32 a87, v21
    v_accvgpr_read_b32 v21, a88
    v_mul_f32 v21, v21, v17
    v_accvgpr_write_b32 a88, v21
    v_accvgpr_read_b32 v21, a89
    v_mul_f32 v21, v21, v17
    v_accvgpr_write_b32 a89, v21
    v_accvgpr_read_b32 v21, a90
    v_mul_f32 v21, v21, v17
    v_accvgpr_write_b32 a90, v21
    v_accvgpr_read_b32 v21, a91
    v_mul_f32 v21, v21, v17
    v_accvgpr_write_b32 a91, v21
    v_accvgpr_read_b32 v21, a92
    v_mul_f32 v21, v21, v17
    v_accvgpr_write_b32 a92, v21
    v_accvgpr_read_b32 v21, a93
    v_mul_f32 v21, v21, v17
    v_accvgpr_write_b32 a93, v21
    v_accvgpr_read_b32 v21, a94
    v_mul_f32 v21, v21, v17
    v_accvgpr_write_b32 a94, v21
    v_accvgpr_read_b32 v21, a95
    v_mul_f32 v21, v21, v17
    v_accvgpr_write_b32 a95, v21
    v_mov_b32 v20, v17
    v_mov_b32 v21, v17
    s_nop 1
    v_permlane16_swap_b32 v20, v21
    s_nop 1
    v_mul_f32 v148, v148, v20
    v_mul_f32 v149, v149, v21
    v_mul_f32 v150, v150, v20
    v_mul_f32 v151, v151, v21
    s_mov_b32 s35, 0
    s_nop 1
    s_branch LbackB_54
.globl oproj_kernel
.p2align 8
.type oproj_kernel,@function
oproj_kernel:
    s_cmp_ge_u32 s2, 256
    s_cbranch_scc1 Lk3_end
    s_load_dwordx2 s[36:37], s[0:1], 32
    s_load_dwordx2 s[42:43], s[0:1], 112
    s_and_b32 s7, s2, 7
    s_and_b32 s6, s7, 1
    s_lshr_b32 s7, s7, 1
    s_lshl_b32 s4, s7, 2
    s_lshr_b32 s7, s2, 3
    s_and_b32 s5, s7, 7
    s_lshr_b32 s7, s7, 3
    s_add_u32 s4, s4, s7
    v_lshrrev_b32 v1, 6, v0
    s_nop 0
    v_readfirstlane_b32 s3, v1
    v_and_b32 v0, 63, v0
    s_lshl_b32 s23, s3, 10
    s_lshl_b32 s24, s3, 12
    v_lshlrev_b32 v2, 4, v0
    v_lshrrev_b32 v20, 3, v0
    v_and_b32 v21, 7, v0
    v_lshrrev_b32 v22, 1, v20
    v_and_b32 v22, 1, v22
    v_lshlrev_b32 v22, 2, v22
    v_xor_b32 v22, v22, v21
    v_lshlrev_b32 v22, 4, v22
    v_lshlrev_b32 v23, 10, v20
    v_add_u32 v1, v22, v23
    v_and_b32 v21, 15, v0
    v_lshrrev_b32 v20, 2, v21
    v_lshrrev_b32 v22, 5, v0
    v_lshlrev_b32 v22, 2, v22
    v_add_u32 v22, v22, v20
    v_lshlrev_b32 v22, 7, v22
    v_lshrrev_b32 v23, 4, v0
    v_and_b32 v23, 1, v23
    v_lshlrev_b32 v23, 5, v23
    v_add_u32 v22, v22, v23
    v_and_b32 v23, 3, v0
    v_lshlrev_b32 v23, 3, v23
    v_add_u32 v22, v22, v23
    v_lshrrev_b32 v23, 1, v20
    s_and_b32 s7, s3, 1
    v_xor_b32 v23, s7, v23
    v_lshlrev_b32 v23, 6, v23
    v_add_u32 v4, v22, v23
    v_add_u32 v5, 0x10000, v4
    s_lshr_b32 s7, s3, 1
    s_lshl_b32 s7, s7, 13
    s_add_u32 s7, s7, 8192
    v_add_u32 v6, s7, v2
    v_add_u32 v3, 0x10000, v6
    s_waitcnt lgkmcnt(0)

    s_mov_b32 s8, s36
    s_mov_b32 s9, s37
    s_mov_b32 s10, 0x400000
    s_mov_b32 s11, 0x00020000
    s_add_u32 s12, s42, 0x400000
    s_addc_u32 s13, s43, 0
    s_mov_b32 s14, 0x1000000
    s_mov_b32 s15, 0x00020000
    s_add_u32 s16, s42, 0x2000000
    s_addc_u32 s17, s43, 0
    s_mov_b32 s18, 0x800000
    s_mov_b32 s19, 0x00020000
    s_cmp_lt_u32 s3, 4
    s_cbranch_scc1 Lk3_main
    s_cmp_ge_u32 s2, 16
    s_cbranch_scc1 Lk3_noz
    s_add_u32 s44, s42, 76611584
    s_addc_u32 s45, s43, 0
    s_mov_b32 s46, 16384
    s_mov_b32 s47, 0x00020000
    v_mov_b32 v60, 0
    v_mov_b32 v61, 0
    v_mov_b32 v62, 0
    v_mov_b32 v63, 0
    s_lshl_b32 s7, s2, 10
    buffer_store_dwordx4 v[60:63], v2, s[44:47], s7 offen
Lk3_noz:
    v_lshrrev_b32 v20, 4, v0
    v_and_b32 v21, 15, v0
    v_lshlrev_b32 v22, 12, v20
    v_lshlrev_b32 v23, 7, v21
    v_add_u32 v22, v22, v23
    v_lshlrev_b32 v24, 16, v20
    v_lshlrev_b32 v23, 10, v21
    v_add_u32 v24, v24, v23
    s_lshl_b32 s7, s4, 2
    s_lshr_b32 s22, s5, 1
    s_add_u32 s7, s7, s22
    s_lshl_b32 s7, s7, 18
    s_lshl_b32 s22, s6, 17
    s_add_u32 s7, s7, s22
    s_and_b32 s22, s5, 1
    s_lshl_b32 s22, s22, 11
    s_add_u32 s7, s7, s22
    s_lshl_b32 s20, s6, 21
    s_and_b32 s22, s4, 3
    s_lshl_b32 s22, s22, 14
    s_add_u32 s20, s20, s22
    s_lshl_b32 s22, s5, 7
    s_add_u32 s20, s20, s22

    s_add_u32 s20, s20, 262144
    s_add_u32 s7, s7, 16384
    buffer_load_dword v30, v24, s[8:11], s20 offen
    buffer_load_dword v31, v22, s[12:15], s7 offen
    s_add_u32 s20, s20, 262144
    s_add_u32 s7, s7, 16384
    s_barrier
    s_barrier
    s_barrier
    s_barrier
    buffer_load_dword v32, v24, s[8:11], s20 offen
    buffer_load_dword v33, v22, s[12:15], s7 offen
    s_add_u32 s20, s20, 262144
    s_add_u32 s7, s7, 16384
    s_barrier
    s_barrier
    s_barrier
    s_barrier
    buffer_load_dword v34, v24, s[8:11], s20 offen
    buffer_load_dword v35, v22, s[12:15], s7 offen
    s_add_u32 s20, s20, 262144
    s_add_u32 s7, s7, 16384
    s_barrier
    s_barrier
    s_barrier
    s_barrier
    buffer_load_dword v36, v24, s[8:11], s20 offen
    buffer_load_dword v37, v22, s[12:15], s7 offen
    s_add_u32 s20, s20, 262144
    s_add_u32 s7, s7, 16384
    s_barrier
    s_barrier
    s_barrier
    s_barrier
    buffer_load_dword v38, v24, s[8:11], s20 offen
    buffer_load_dword v39, v22, s[12:15], s7 offen
    s_add_u32 s20, s20, 262144
    s_add_u32 s7, s7, 16384
    s_barrier
    s_barrier
    s_barrier
    s_barrier
    buffer_load_dword v40, v24, s[8:11], s20 offen
    buffer_load_dword v41, v22, s[12:15], s7 offen
    s_add_u32 s20, s20, 262144
    s_add_u32 s7, s7, 16384
    s_barrier
    s_barrier
    s_barrier
    s_barrier
    buffer_load_dword v42, v24, s[8:11], s20 offen
    buffer_load_dword v43, v22, s[12:15], s7 offen
    s_add_u32 s20, s20, 262144
    s_add_u32 s7, s7, 16384
    s_barrier
    s_barrier
    s_barrier
    s_barrier
    s_barrier
    s_barrier
    s_barrier
    s_barrier
    s_endpgm
Lk3_main:
    s_lshl_b32 s20, s6, 21
    s_lshl_b32 s7, s5, 7
    s_add_u32 s20, s20, s7
    s_lshl_b32 s7, s3, 13
    s_add_u32 s20, s20, s7
    s_lshl_b32 s21, s4, 2
    s_add_u32 s21, s21, s3
    s_lshl_b32 s21, s21, 18
    s_lshl_b32 s7, s6, 17
    s_add_u32 s21, s21, s7

    s_add_u32 m0, s23, 0
    s_add_u32 s22, s20, 0
    buffer_load_dwordx4 v1, s[8:11], s22 offen lds
    s_add_u32 m0, s23, 4096
    s_add_u32 s22, s20, 32768
    buffer_load_dwordx4 v1, s[8:11], s22 offen lds
    s_add_u32 m0, s24, 8192
    s_add_u32 s20, s20, 65536
    buffer_load_dwordx4 v2, s[12:15], s21 offen offset:0 lds
    buffer_load_dwordx4 v2, s[12:15], s21 offen offset:1024 lds
    buffer_load_dwordx4 v2, s[12:15], s21 offen offset:2048 lds
    buffer_load_dwordx4 v2, s[12:15], s21 offen offset:3072 lds
    s_add_u32 s21, s21, 4096
    s_add_u32 m0, s23, 24576
    s_add_u32 s22, s20, 0
    buffer_load_dwordx4 v1, s[8:11], s22 offen lds
    s_add_u32 m0, s23, 28672
    s_add_u32 s22, s20, 32768
    buffer_load_dwordx4 v1, s[8:11], s22 offen lds
    s_add_u32 m0, s24, 32768
    s_add_u32 s20, s20, 65536
    buffer_load_dwordx4 v2, s[12:15], s21 offen offset:0 lds
    buffer_load_dwordx4 v2, s[12:15], s21 offen offset:1024 lds
    buffer_load_dwordx4 v2, s[12:15], s21 offen offset:2048 lds
    buffer_load_dwordx4 v2, s[12:15], s21 offen offset:3072 lds
    s_add_u32 s21, s21, 4096
    s_add_u32 m0, s23, 49152
    s_add_u32 s22, s20, 0
    buffer_load_dwordx4 v1, s[8:11], s22 offen lds
    s_add_u32 m0, s23, 53248
    s_add_u32 s22, s20, 32768
    buffer_load_dwordx4 v1, s[8:11], s22 offen lds
    s_add_u32 m0, s24, 57344
    s_add_u32 s20, s20, 65536
    buffer_load_dwordx4 v2, s[12:15], s21 offen offset:0 lds
    buffer_load_dwordx4 v2, s[12:15], s21 offen offset:1024 lds
    buffer_load_dwordx4 v2, s[12:15], s21 offen offset:2048 lds
    buffer_load_dwordx4 v2, s[12:15], s21 offen offset:3072 lds
    s_add_u32 s21, s21, 4096
    s_add_u32 m0, s23, 73728
    s_add_u32 s22, s20, 0
    buffer_load_dwordx4 v1, s[8:11], s22 offen lds
    s_add_u32 m0, s23, 77824
    s_add_u32 s22, s20, 32768
    buffer_load_dwordx4 v1, s[8:11], s22 offen lds
    s_add_u32 m0, s24, 81920
    s_add_u32 s20, s20, 65536
    buffer_load_dwordx4 v2, s[12:15], s21 offen offset:0 lds
    buffer_load_dwordx4 v2, s[12:15], s21 offen offset:1024 lds
    buffer_load_dwordx4 v2, s[12:15], s21 offen offset:2048 lds
    buffer_load_dwordx4 v2, s[12:15], s21 offen offset:3072 lds
    s_add_u32 s21, s21, 4096
    s_waitcnt vmcnt(12)
    s_barrier
    ds_read_b64_tr_b16 v[8:9], v4 offset:0
    ds_read_b64_tr_b16 v[10:11], v4 offset:1024
    ds_read_b128 v[12:15], v6 offset:0
    ds_read_b128 v[16:19], v6 offset:4096
    ds_read_b64_tr_b16 v[20:21], v4 offset:2048
    ds_read_b64_tr_b16 v[22:23], v4 offset:3072
    ds_read_b128 v[24:27], v6 offset:1024
    ds_read_b128 v[28:31], v6 offset:5120
    s_waitcnt lgkmcnt(4)
    v_mfma_f32_32x32x16_bf16 v[48:63], v[12:15], v[8:11], 0
    ds_read_b64_tr_b16 v[32:33], v4 offset:4096
    ds_read_b64_tr_b16 v[34:35], v4 offset:5120
    s_add_u32 m0, s23, 98304
    s_add_u32 s22, s20, 0
    buffer_load_dwordx4 v1, s[8:11], s22 offen lds
    v_mfma_f32_32x32x16_bf16 v[64:79], v[16:19], v[8:11], 0
    ds_read_b128 v[36:39], v6 offset:2048
    ds_read_b128 v[40:43], v6 offset:6144
    s_add_u32 m0, s23, 102400
    s_add_u32 s22, s20, 32768
    buffer_load_dwordx4 v1, s[8:11], s22 offen lds
    s_waitcnt lgkmcnt(4)
    v_mfma_f32_32x32x16_bf16 v[48:63], v[24:27], v[20:23], v[48:63]
    ds_read_b64_tr_b16 v[8:9], v4 offset:6144
    ds_read_b64_tr_b16 v[10:11], v4 offset:7168
    s_add_u32 m0, s24, 106496
    s_add_u32 s20, s20, 65536
    buffer_load_dwordx4 v2, s[12:15], s21 offen offset:0 lds
    v_mfma_f32_32x32x16_bf16 v[64:79], v[28:31], v[20:23], v[64:79]
    ds_read_b128 v[12:15], v6 offset:3072
    ds_read_b128 v[16:19], v6 offset:7168
    buffer_load_dwordx4 v2, s[12:15], s21 offen offset:1024 lds
    s_waitcnt lgkmcnt(4)
    v_mfma_f32_32x32x16_bf16 v[48:63], v[36:39], v[32:35], v[48:63]
    ds_read_b64_tr_b16 v[20:21], v4 offset:24576
    ds_read_b64_tr_b16 v[22:23], v4 offset:25600
    buffer_load_dwordx4 v2, s[12:15], s21 offen offset:2048 lds
    v_mfma_f32_32x32x16_bf16 v[64:79], v[40:43], v[32:35], v[64:79]
    ds_read_b128 v[24:27], v6 offset:24576
    ds_read_b128 v[28:31], v6 offset:28672
    buffer_load_dwordx4 v2, s[12:15], s21 offen offset:3072 lds
    s_add_u32 s21, s21, 4096
    s_waitcnt lgkmcnt(4)
    v_mfma_f32_32x32x16_bf16 v[48:63], v[12:15], v[8:11], v[48:63]
    ds_read_b64_tr_b16 v[32:33], v4 offset:26624
    ds_read_b64_tr_b16 v[34:35], v4 offset:27648
    v_mfma_f32_32x32x16_bf16 v[64:79], v[16:19], v[8:11], v[64:79]
    ds_read_b128 v[36:39], v6 offset:25600
    ds_read_b128 v[40:43], v6 offset:29696
    s_waitcnt vmcnt(12)
    s_barrier
    s_waitcnt lgkmcnt(4)
    v_mfma_f32_32x32x16_bf16 v[48:63], v[24:27], v[20:23], v[48:63]
    ds_read_b64_tr_b16 v[8:9], v4 offset:28672
    ds_read_b64_tr_b16 v[10:11], v4 offset:29696
    s_add_u32 m0, s23, 0
    s_add_u32 s22, s20, 0
    buffer_load_dwordx4 v1, s[8:11], s22 offen lds
    v_mfma_f32_32x32x16_bf16 v[64:79], v[28:31], v[20:23], v[64:79]
    ds_read_b128 v[12:15], v6 offset:26624
    ds_read_b128 v[16:19], v6 offset:30720
    s_add_u32 m0, s23, 4096
    s_add_u32 s22, s20, 32768
    buffer_load_dwordx4 v1, s[8:11], s22 offen lds
    s_waitcnt lgkmcnt(4)
    v_mfma_f32_32x32x16_bf16 v[48:63], v[36:39], v[32:35], v[48:63]
    ds_read_b64_tr_b16 v[20:21], v4 offset:30720
    ds_read_b64_tr_b16 v[22:23], v4 offset:31744
    s_add_u32 m0, s24, 8192
    s_add_u32 s20, s20, 65536
    buffer_load_dwordx4 v2, s[12:15], s21 offen offset:0 lds
    v_mfma_f32_32x32x16_bf16 v[64:79], v[40:43], v[32:35], v[64:79]
    ds_read_b128 v[24:27], v6 offset:27648
    ds_read_b128 v[28:31], v6 offset:31744
    buffer_load_dwordx4 v2, s[12:15], s21 offen offset:1024 lds
    s_waitcnt lgkmcnt(4)
    v_mfma_f32_32x32x16_bf16 v[48:63], v[12:15], v[8:11], v[48:63]
    ds_read_b64_tr_b16 v[32:33], v4 offset:49152
    ds_read_b64_tr_b16 v[34:35], v4 offset:50176
    buffer_load_dwordx4 v2, s[12:15], s21 offen offset:2048 lds
    v_mfma_f32_32x32x16_bf16 v[64:79], v[16:19], v[8:11], v[64:79]
    ds_read_b128 v[36:39], v6 offset:49152
    ds_read_b128 v[40:43], v6 offset:53248
    buffer_load_dwordx4 v2, s[12:15], s21 offen offset:3072 lds
    s_add_u32 s21, s21, 4096
    s_waitcnt lgkmcnt(4)
    v_mfma_f32_32x32x16_bf16 v[48:63], v[24:27], v[20:23], v[48:63]
    ds_read_b64_tr_b16 v[8:9], v4 offset:51200
    ds_read_b64_tr_b16 v[10:11], v4 offset:52224
    v_mfma_f32_32x32x16_bf16 v[64:79], v[28:31], v[20:23], v[64:79]
    ds_read_b128 v[12:15], v6 offset:50176
    ds_read_b128 v[16:19], v6 offset:54272
    s_waitcnt vmcnt(12)
    s_barrier
    s_waitcnt lgkmcnt(4)
    v_mfma_f32_32x32x16_bf16 v[48:63], v[36:39], v[32:35], v[48:63]
    ds_read_b64_tr_b16 v[20:21], v4 offset:53248
    ds_read_b64_tr_b16 v[22:23], v4 offset:54272
    s_add_u32 m0, s23, 24576
    s_add_u32 s22, s20, 0
    buffer_load_dwordx4 v1, s[8:11], s22 offen lds
    v_mfma_f32_32x32x16_bf16 v[64:79], v[40:43], v[32:35], v[64:79]
    ds_read_b128 v[24:27], v6 offset:51200
    ds_read_b128 v[28:31], v6 offset:55296
    s_add_u32 m0, s23, 28672
    s_add_u32 s22, s20, 32768
    buffer_load_dwordx4 v1, s[8:11], s22 offen lds
    s_waitcnt lgkmcnt(4)
    v_mfma_f32_32x32x16_bf16 v[48:63], v[12:15], v[8:11], v[48:63]
    ds_read_b64_tr_b16 v[32:33], v4 offset:55296
    ds_read_b64_tr_b16 v[34:35], v4 offset:56320
    s_add_u32 m0, s24, 32768
    s_add_u32 s20, s20, 65536
    buffer_load_dwordx4 v2, s[12:15], s21 offen offset:0 lds
    v_mfma_f32_32x32x16_bf16 v[64:79], v[16:19], v[8:11], v[64:79]
    ds_read_b128 v[36:39], v6 offset:52224
    ds_read_b128 v[40:43], v6 offset:56320
    buffer_load_dwordx4 v2, s[12:15], s21 offen offset:1024 lds
    s_waitcnt lgkmcnt(4)
    v_mfma_f32_32x32x16_bf16 v[48:63], v[24:27], v[20:23], v[48:63]
    ds_read_b64_tr_b16 v[8:9], v5 offset:8192
    ds_read_b64_tr_b16 v[10:11], v5 offset:9216
    buffer_load_dwordx4 v2, s[12:15], s21 offen offset:2048 lds
    v_mfma_f32_32x32x16_bf16 v[64:79], v[28:31], v[20:23], v[64:79]
    ds_read_b128 v[12:15], v3 offset:8192
    ds_read_b128 v[16:19], v3 offset:12288
    buffer_load_dwordx4 v2, s[12:15], s21 offen offset:3072 lds
    s_add_u32 s21, s21, 4096
    s_waitcnt lgkmcnt(4)
    v_mfma_f32_32x32x16_bf16 v[48:63], v[36:39], v[32:35], v[48:63]
    ds_read_b64_tr_b16 v[20:21], v5 offset:10240
    ds_read_b64_tr_b16 v[22:23], v5 offset:11264
    v_mfma_f32_32x32x16_bf16 v[64:79], v[40:43], v[32:35], v[64:79]
    ds_read_b128 v[24:27], v3 offset:9216
    ds_read_b128 v[28:31], v3 offset:13312
    s_waitcnt vmcnt(12)
    s_barrier
    s_waitcnt lgkmcnt(4)
    v_mfma_f32_32x32x16_bf16 v[48:63], v[12:15], v[8:11], v[48:63]
    ds_read_b64_tr_b16 v[32:33], v5 offset:12288
    ds_read_b64_tr_b16 v[34:35], v5 offset:13312
    s_add_u32 m0, s23, 49152
    s_add_u32 s22, s20, 0
    buffer_load_dwordx4 v1, s[8:11], s22 offen lds
    v_mfma_f32_32x32x16_bf16 v[64:79], v[16:19], v[8:11], v[64:79]
    ds_read_b128 v[36:39], v3 offset:10240
    ds_read_b128 v[40:43], v3 offset:14336
    s_add_u32 m0, s23, 53248
    s_add_u32 s22, s20, 32768
    buffer_load_dwordx4 v1, s[8:11], s22 offen lds
    s_waitcnt lgkmcnt(4)
    v_mfma_f32_32x32x16_bf16 v[48:63], v[24:27], v[20:23], v[48:63]
    ds_read_b64_tr_b16 v[8:9], v5 offset:14336
    ds_read_b64_tr_b16 v[10:11], v5 offset:15360
    s_add_u32 m0, s24, 57344
    s_add_u32 s20, s20, 65536
    buffer_load_dwordx4 v2, s[12:15], s21 offen offset:0 lds
    v_mfma_f32_32x32x16_bf16 v[64:79], v[28:31], v[20:23], v[64:79]
    ds_read_b128 v[12:15], v3 offset:11264
    ds_read_b128 v[16:19], v3 offset:15360
    buffer_load_dwordx4 v2, s[12:15], s21 offen offset:1024 lds
    s_waitcnt lgkmcnt(4)
    v_mfma_f32_32x32x16_bf16 v[48:63], v[36:39], v[32:35], v[48:63]
    ds_read_b64_tr_b16 v[20:21], v5 offset:32768
    ds_read_b64_tr_b16 v[22:23], v5 offset:33792
    buffer_load_dwordx4 v2, s[12:15], s21 offen offset:2048 lds
    v_mfma_f32_32x32x16_bf16 v[64:79], v[40:43], v[32:35], v[64:79]
    ds_read_b128 v[24:27], v3 offset:32768
    ds_read_b128 v[28:31], v3 offset:36864
    buffer_load_dwordx4 v2, s[12:15], s21 offen offset:3072 lds
    s_add_u32 s21, s21, 4096
    s_waitcnt lgkmcnt(4)
    v_mfma_f32_32x32x16_bf16 v[48:63], v[12:15], v[8:11], v[48:63]
    ds_read_b64_tr_b16 v[32:33], v5 offset:34816
    ds_read_b64_tr_b16 v[34:35], v5 offset:35840
    v_mfma_f32_32x32x16_bf16 v[64:79], v[16:19], v[8:11], v[64:79]
    ds_read_b128 v[36:39], v3 offset:33792
    ds_read_b128 v[40:43], v3 offset:37888
    s_waitcnt vmcnt(12)
    s_barrier
    s_waitcnt lgkmcnt(4)
    v_mfma_f32_32x32x16_bf16 v[48:63], v[24:27], v[20:23], v[48:63]
    ds_read_b64_tr_b16 v[8:9], v5 offset:36864
    ds_read_b64_tr_b16 v[10:11], v5 offset:37888
    s_add_u32 m0, s23, 73728
    s_add_u32 s22, s20, 0
    buffer_load_dwordx4 v1, s[8:11], s22 offen lds
    v_mfma_f32_32x32x16_bf16 v[64:79], v[28:31], v[20:23], v[64:79]
    ds_read_b128 v[12:15], v3 offset:34816
    ds_read_b128 v[16:19], v3 offset:38912
    s_add_u32 m0, s23, 77824
    s_add_u32 s22, s20, 32768
    buffer_load_dwordx4 v1, s[8:11], s22 offen lds
    s_waitcnt lgkmcnt(4)
    v_mfma_f32_32x32x16_bf16 v[48:63], v[36:39], v[32:35], v[48:63]
    ds_read_b64_tr_b16 v[20:21], v5 offset:38912
    ds_read_b64_tr_b16 v[22:23], v5 offset:39936
    s_add_u32 m0, s24, 81920
    s_add_u32 s20, s20, 65536
    buffer_load_dwordx4 v2, s[12:15], s21 offen offset:0 lds
    v_mfma_f32_32x32x16_bf16 v[64:79], v[40:43], v[32:35], v[64:79]
    ds_read_b128 v[24:27], v3 offset:35840
    ds_read_b128 v[28:31], v3 offset:39936
    buffer_load_dwordx4 v2, s[12:15], s21 offen offset:1024 lds
    s_waitcnt lgkmcnt(4)
    v_mfma_f32_32x32x16_bf16 v[48:63], v[12:15], v[8:11], v[48:63]
    ds_read_b64_tr_b16 v[32:33], v4 offset:0
    ds_read_b64_tr_b16 v[34:35], v4 offset:1024
    buffer_load_dwordx4 v2, s[12:15], s21 offen offset:2048 lds
    v_mfma_f32_32x32x16_bf16 v[64:79], v[16:19], v[8:11], v[64:79]
    ds_read_b128 v[36:39], v6 offset:0
    ds_read_b128 v[40:43], v6 offset:4096
    buffer_load_dwordx4 v2, s[12:15], s21 offen offset:3072 lds
    s_add_u32 s21, s21, 4096
    s_waitcnt lgkmcnt(4)
    v_mfma_f32_32x32x16_bf16 v[48:63], v[24:27], v[20:23], v[48:63]
    ds_read_b64_tr_b16 v[8:9], v4 offset:2048
    ds_read_b64_tr_b16 v[10:11], v4 offset:3072
    v_mfma_f32_32x32x16_bf16 v[64:79], v[28:31], v[20:23], v[64:79]
    ds_read_b128 v[12:15], v6 offset:1024
    ds_read_b128 v[16:19], v6 offset:5120
    s_waitcnt vmcnt(12)
    s_barrier
    s_waitcnt lgkmcnt(4)
    v_mfma_f32_32x32x16_bf16 v[48:63], v[36:39], v[32:35], v[48:63]
    ds_read_b64_tr_b16 v[20:21], v4 offset:4096
    ds_read_b64_tr_b16 v[22:23], v4 offset:5120
    s_add_u32 m0, s23, 98304
    s_add_u32 s22, s20, 0
    buffer_load_dwordx4 v1, s[8:11], s22 offen lds
    v_mfma_f32_32x32x16_bf16 v[64:79], v[40:43], v[32:35], v[64:79]
    ds_read_b128 v[24:27], v6 offset:2048
    ds_read_b128 v[28:31], v6 offset:6144
    s_add_u32 m0, s23, 102400
    s_add_u32 s22, s20, 32768
    buffer_load_dwordx4 v1, s[8:11], s22 offen lds
    s_waitcnt lgkmcnt(4)
    v_mfma_f32_32x32x16_bf16 v[48:63], v[12:15], v[8:11], v[48:63]
    ds_read_b64_tr_b16 v[32:33], v4 offset:6144
    ds_read_b64_tr_b16 v[34:35], v4 offset:7168
    s_add_u32 m0, s24, 106496
    s_add_u32 s20, s20, 65536
    buffer_load_dwordx4 v2, s[12:15], s21 offen offset:0 lds
    v_mfma_f32_32x32x16_bf16 v[64:79], v[16:19], v[8:11], v[64:79]
    ds_read_b128 v[36:39], v6 offset:3072
    ds_read_b128 v[40:43], v6 offset:7168
    buffer_load_dwordx4 v2, s[12:15], s21 offen offset:1024 lds
    s_waitcnt lgkmcnt(4)
    v_mfma_f32_32x32x16_bf16 v[48:63], v[24:27], v[20:23], v[48:63]
    ds_read_b64_tr_b16 v[8:9], v4 offset:24576
    ds_read_b64_tr_b16 v[10:11], v4 offset:25600
    buffer_load_dwordx4 v2, s[12:15], s21 offen offset:2048 lds
    v_mfma_f32_32x32x16_bf16 v[64:79], v[28:31], v[20:23], v[64:79]
    ds_read_b128 v[12:15], v6 offset:24576
    ds_read_b128 v[16:19], v6 offset:28672
    buffer_load_dwordx4 v2, s[12:15], s21 offen offset:3072 lds
    s_add_u32 s21, s21, 4096
    s_waitcnt lgkmcnt(4)
    v_mfma_f32_32x32x16_bf16 v[48:63], v[36:39], v[32:35], v[48:63]
    ds_read_b64_tr_b16 v[20:21], v4 offset:26624
    ds_read_b64_tr_b16 v[22:23], v4 offset:27648
    v_mfma_f32_32x32x16_bf16 v[64:79], v[40:43], v[32:35], v[64:79]
    ds_read_b128 v[24:27], v6 offset:25600
    ds_read_b128 v[28:31], v6 offset:29696
    s_waitcnt vmcnt(12)
    s_barrier
    s_waitcnt lgkmcnt(4)
    v_mfma_f32_32x32x16_bf16 v[48:63], v[12:15], v[8:11], v[48:63]
    ds_read_b64_tr_b16 v[32:33], v4 offset:28672
    ds_read_b64_tr_b16 v[34:35], v4 offset:29696
    s_add_u32 m0, s23, 0
    s_add_u32 s22, s20, 0
    buffer_load_dwordx4 v1, s[8:11], s22 offen lds
    v_mfma_f32_32x32x16_bf16 v[64:79], v[16:19], v[8:11], v[64:79]
    ds_read_b128 v[36:39], v6 offset:26624
    ds_read_b128 v[40:43], v6 offset:30720
    s_add_u32 m0, s23, 4096
    s_add_u32 s22, s20, 32768
    buffer_load_dwordx4 v1, s[8:11], s22 offen lds
    s_waitcnt lgkmcnt(4)
    v_mfma_f32_32x32x16_bf16 v[48:63], v[24:27], v[20:23], v[48:63]
    ds_read_b64_tr_b16 v[8:9], v4 offset:30720
    ds_read_b64_tr_b16 v[10:11], v4 offset:31744
    s_add_u32 m0, s24, 8192
    s_add_u32 s20, s20, 65536
    buffer_load_dwordx4 v2, s[12:15], s21 offen offset:0 lds
    v_mfma_f32_32x32x16_bf16 v[64:79], v[28:31], v[20:23], v[64:79]
    ds_read_b128 v[12:15], v6 offset:27648
    ds_read_b128 v[16:19], v6 offset:31744
    buffer_load_dwordx4 v2, s[12:15], s21 offen offset:1024 lds
    s_waitcnt lgkmcnt(4)
    v_mfma_f32_32x32x16_bf16 v[48:63], v[36:39], v[32:35], v[48:63]
    ds_read_b64_tr_b16 v[20:21], v4 offset:49152
    ds_read_b64_tr_b16 v[22:23], v4 offset:50176
    buffer_load_dwordx4 v2, s[12:15], s21 offen offset:2048 lds
    v_mfma_f32_32x32x16_bf16 v[64:79], v[40:43], v[32:35], v[64:79]
    ds_read_b128 v[24:27], v6 offset:49152
    ds_read_b128 v[28:31], v6 offset:53248
    buffer_load_dwordx4 v2, s[12:15], s21 offen offset:3072 lds
    s_add_u32 s21, s21, 4096
    s_waitcnt lgkmcnt(4)
    v_mfma_f32_32x32x16_bf16 v[48:63], v[12:15], v[8:11], v[48:63]
    ds_read_b64_tr_b16 v[32:33], v4 offset:51200
    ds_read_b64_tr_b16 v[34:35], v4 offset:52224
    v_mfma_f32_32x32x16_bf16 v[64:79], v[16:19], v[8:11], v[64:79]
    ds_read_b128 v[36:39], v6 offset:50176
    ds_read_b128 v[40:43], v6 offset:54272
    s_waitcnt vmcnt(12)
    s_barrier
    s_waitcnt lgkmcnt(4)
    v_mfma_f32_32x32x16_bf16 v[48:63], v[24:27], v[20:23], v[48:63]
    ds_read_b64_tr_b16 v[8:9], v4 offset:53248
    ds_read_b64_tr_b16 v[10:11], v4 offset:54272
    s_add_u32 m0, s23, 24576
    s_add_u32 s22, s20, 0
    buffer_load_dwordx4 v1, s[8:11], s22 offen lds
    v_mfma_f32_32x32x16_bf16 v[64:79], v[28:31], v[20:23], v[64:79]
    ds_read_b128 v[12:15], v6 offset:51200
    ds_read_b128 v[16:19], v6 offset:55296
    s_add_u32 m0, s23, 28672
    s_add_u32 s22, s20, 32768
    buffer_load_dwordx4 v1, s[8:11], s22 offen lds
    s_waitcnt lgkmcnt(4)
    v_mfma_f32_32x32x16_bf16 v[48:63], v[36:39], v[32:35], v[48:63]
    ds_read_b64_tr_b16 v[20:21], v4 offset:55296
    ds_read_b64_tr_b16 v[22:23], v4 offset:56320
    s_add_u32 m0, s24, 32768
    s_add_u32 s20, s20, 65536
    buffer_load_dwordx4 v2, s[12:15], s21 offen offset:0 lds
    v_mfma_f32_32x32x16_bf16 v[64:79], v[40:43], v[32:35], v[64:79]
    ds_read_b128 v[24:27], v6 offset:52224
    ds_read_b128 v[28:31], v6 offset:56320
    buffer_load_dwordx4 v2, s[12:15], s21 offen offset:1024 lds
    s_waitcnt lgkmcnt(4)
    v_mfma_f32_32x32x16_bf16 v[48:63], v[12:15], v[8:11], v[48:63]
    ds_read_b64_tr_b16 v[32:33], v5 offset:8192
    ds_read_b64_tr_b16 v[34:35], v5 offset:9216
    buffer_load_dwordx4 v2, s[12:15], s21 offen offset:2048 lds
    v_mfma_f32_32x32x16_bf16 v[64:79], v[16:19], v[8:11], v[64:79]
    ds_read_b128 v[36:39], v3 offset:8192
    ds_read_b128 v[40:43], v3 offset:12288
    buffer_load_dwordx4 v2, s[12:15], s21 offen offset:3072 lds
    s_add_u32 s21, s21, 4096
    s_waitcnt lgkmcnt(4)
    v_mfma_f32_32x32x16_bf16 v[48:63], v[24:27], v[20:23], v[48:63]
    ds_read_b64_tr_b16 v[8:9], v5 offset:10240
    ds_read_b64_tr_b16 v[10:11], v5 offset:11264
    v_mfma_f32_32x32x16_bf16 v[64:79], v[28:31], v[20:23], v[64:79]
    ds_read_b128 v[12:15], v3 offset:9216
    ds_read_b128 v[16:19], v3 offset:13312
    s_waitcnt vmcnt(12)
    s_barrier
    s_waitcnt lgkmcnt(4)
    v_mfma_f32_32x32x16_bf16 v[48:63], v[36:39], v[32:35], v[48:63]
    ds_read_b64_tr_b16 v[20:21], v5 offset:12288
    ds_read_b64_tr_b16 v[22:23], v5 offset:13312
    s_add_u32 m0, s23, 49152
    s_add_u32 s22, s20, 0
    buffer_load_dwordx4 v1, s[8:11], s22 offen lds
    v_mfma_f32_32x32x16_bf16 v[64:79], v[40:43], v[32:35], v[64:79]
    ds_read_b128 v[24:27], v3 offset:10240
    ds_read_b128 v[28:31], v3 offset:14336
    s_add_u32 m0, s23, 53248
    s_add_u32 s22, s20, 32768
    buffer_load_dwordx4 v1, s[8:11], s22 offen lds
    s_waitcnt lgkmcnt(4)
    v_mfma_f32_32x32x16_bf16 v[48:63], v[12:15], v[8:11], v[48:63]
    ds_read_b64_tr_b16 v[32:33], v5 offset:14336
    ds_read_b64_tr_b16 v[34:35], v5 offset:15360
    s_add_u32 m0, s24, 57344
    s_add_u32 s20, s20, 65536
    buffer_load_dwordx4 v2, s[12:15], s21 offen offset:0 lds
    v_mfma_f32_32x32x16_bf16 v[64:79], v[16:19], v[8:11], v[64:79]
    ds_read_b128 v[36:39], v3 offset:11264
    ds_read_b128 v[40:43], v3 offset:15360
    buffer_load_dwordx4 v2, s[12:15], s21 offen offset:1024 lds
    s_waitcnt lgkmcnt(4)
    v_mfma_f32_32x32x16_bf16 v[48:63], v[24:27], v[20:23], v[48:63]
    ds_read_b64_tr_b16 v[8:9], v5 offset:32768
    ds_read_b64_tr_b16 v[10:11], v5 offset:33792
    buffer_load_dwordx4 v2, s[12:15], s21 offen offset:2048 lds
    v_mfma_f32_32x32x16_bf16 v[64:79], v[28:31], v[20:23], v[64:79]
    ds_read_b128 v[12:15], v3 offset:32768
    ds_read_b128 v[16:19], v3 offset:36864
    buffer_load_dwordx4 v2, s[12:15], s21 offen offset:3072 lds
    s_add_u32 s21, s21, 4096
    s_waitcnt lgkmcnt(4)
    v_mfma_f32_32x32x16_bf16 v[48:63], v[36:39], v[32:35], v[48:63]
    ds_read_b64_tr_b16 v[20:21], v5 offset:34816
    ds_read_b64_tr_b16 v[22:23], v5 offset:35840
    v_mfma_f32_32x32x16_bf16 v[64:79], v[40:43], v[32:35], v[64:79]
    ds_read_b128 v[24:27], v3 offset:33792
    ds_read_b128 v[28:31], v3 offset:37888
    s_waitcnt vmcnt(12)
    s_barrier
    s_waitcnt lgkmcnt(4)
    v_mfma_f32_32x32x16_bf16 v[48:63], v[12:15], v[8:11], v[48:63]
    ds_read_b64_tr_b16 v[32:33], v5 offset:36864
    ds_read_b64_tr_b16 v[34:35], v5 offset:37888
    s_add_u32 m0, s23, 73728
    s_add_u32 s22, s20, 0
    buffer_load_dwordx4 v1, s[8:11], s22 offen lds
    v_mfma_f32_32x32x16_bf16 v[64:79], v[16:19], v[8:11], v[64:79]
    ds_read_b128 v[36:39], v3 offset:34816
    ds_read_b128 v[40:43], v3 offset:38912
    s_add_u32 m0, s23, 77824
    s_add_u32 s22, s20, 32768
    buffer_load_dwordx4 v1, s[8:11], s22 offen lds
    s_waitcnt lgkmcnt(4)
    v_mfma_f32_32x32x16_bf16 v[48:63], v[24:27], v[20:23], v[48:63]
    ds_read_b64_tr_b16 v[8:9], v5 offset:38912
    ds_read_b64_tr_b16 v[10:11], v5 offset:39936
    s_add_u32 m0, s24, 81920
    s_add_u32 s20, s20, 65536
    buffer_load_dwordx4 v2, s[12:15], s21 offen offset:0 lds
    v_mfma_f32_32x32x16_bf16 v[64:79], v[28:31], v[20:23], v[64:79]
    ds_read_b128 v[12:15], v3 offset:35840
    ds_read_b128 v[16:19], v3 offset:39936
    buffer_load_dwordx4 v2, s[12:15], s21 offen offset:1024 lds
    s_waitcnt lgkmcnt(4)
    v_mfma_f32_32x32x16_bf16 v[48:63], v[36:39], v[32:35], v[48:63]
    ds_read_b64_tr_b16 v[20:21], v4 offset:0
    ds_read_b64_tr_b16 v[22:23], v4 offset:1024
    buffer_load_dwordx4 v2, s[12:15], s21 offen offset:2048 lds
    v_mfma_f32_32x32x16_bf16 v[64:79], v[40:43], v[32:35], v[64:79]
    ds_read_b128 v[24:27], v6 offset:0
    ds_read_b128 v[28:31], v6 offset:4096
    buffer_load_dwordx4 v2, s[12:15], s21 offen offset:3072 lds
    s_add_u32 s21, s21, 4096
    s_waitcnt lgkmcnt(4)
    v_mfma_f32_32x32x16_bf16 v[48:63], v[12:15], v[8:11], v[48:63]
    ds_read_b64_tr_b16 v[32:33], v4 offset:2048
    ds_read_b64_tr_b16 v[34:35], v4 offset:3072
    v_mfma_f32_32x32x16_bf16 v[64:79], v[16:19], v[8:11], v[64:79]
    ds_read_b128 v[36:39], v6 offset:1024
    ds_read_b128 v[40:43], v6 offset:5120
    s_waitcnt vmcnt(12)
    s_barrier
    s_waitcnt lgkmcnt(4)
    v_mfma_f32_32x32x16_bf16 v[48:63], v[24:27], v[20:23], v[48:63]
    ds_read_b64_tr_b16 v[8:9], v4 offset:4096
    ds_read_b64_tr_b16 v[10:11], v4 offset:5120
    s_add_u32 m0, s23, 98304
    s_add_u32 s22, s20, 0
    buffer_load_dwordx4 v1, s[8:11], s22 offen lds
    v_mfma_f32_32x32x16_bf16 v[64:79], v[28:31], v[20:23], v[64:79]
    ds_read_b128 v[12:15], v6 offset:2048
    ds_read_b128 v[16:19], v6 offset:6144
    s_add_u32 m0, s23, 102400
    s_add_u32 s22, s20, 32768
    buffer_load_dwordx4 v1, s[8:11], s22 offen lds
    s_waitcnt lgkmcnt(4)
    v_mfma_f32_32x32x16_bf16 v[48:63], v[36:39], v[32:35], v[48:63]
    ds_read_b64_tr_b16 v[20:21], v4 offset:6144
    ds_read_b64_tr_b16 v[22:23], v4 offset:7168
    s_add_u32 m0, s24, 106496
    s_add_u32 s20, s20, 65536
    buffer_load_dwordx4 v2, s[12:15], s21 offen offset:0 lds
    v_mfma_f32_32x32x16_bf16 v[64:79], v[40:43], v[32:35], v[64:79]
    ds_read_b128 v[24:27], v6 offset:3072
    ds_read_b128 v[28:31], v6 offset:7168
    buffer_load_dwordx4 v2, s[12:15], s21 offen offset:1024 lds
    s_waitcnt lgkmcnt(4)
    v_mfma_f32_32x32x16_bf16 v[48:63], v[12:15], v[8:11], v[48:63]
    ds_read_b64_tr_b16 v[32:33], v4 offset:24576
    ds_read_b64_tr_b16 v[34:35], v4 offset:25600
    buffer_load_dwordx4 v2, s[12:15], s21 offen offset:2048 lds
    v_mfma_f32_32x32x16_bf16 v[64:79], v[16:19], v[8:11], v[64:79]
    ds_read_b128 v[36:39], v6 offset:24576
    ds_read_b128 v[40:43], v6 offset:28672
    buffer_load_dwordx4 v2, s[12:15], s21 offen offset:3072 lds
    s_add_u32 s21, s21, 4096
    s_waitcnt lgkmcnt(4)
    v_mfma_f32_32x32x16_bf16 v[48:63], v[24:27], v[20:23], v[48:63]
    ds_read_b64_tr_b16 v[8:9], v4 offset:26624
    ds_read_b64_tr_b16 v[10:11], v4 offset:27648
    v_mfma_f32_32x32x16_bf16 v[64:79], v[28:31], v[20:23], v[64:79]
    ds_read_b128 v[12:15], v6 offset:25600
    ds_read_b128 v[16:19], v6 offset:29696
    s_waitcnt vmcnt(12)
    s_barrier
    s_waitcnt lgkmcnt(4)
    v_mfma_f32_32x32x16_bf16 v[48:63], v[36:39], v[32:35], v[48:63]
    ds_read_b64_tr_b16 v[20:21], v4 offset:28672
    ds_read_b64_tr_b16 v[22:23], v4 offset:29696
    s_add_u32 m0, s23, 0
    s_add_u32 s22, s20, 0
    buffer_load_dwordx4 v1, s[8:11], s22 offen lds
    v_mfma_f32_32x32x16_bf16 v[64:79], v[40:43], v[32:35], v[64:79]
    ds_read_b128 v[24:27], v6 offset:26624
    ds_read_b128 v[28:31], v6 offset:30720
    s_add_u32 m0, s23, 4096
    s_add_u32 s22, s20, 32768
    buffer_load_dwordx4 v1, s[8:11], s22 offen lds
    s_waitcnt lgkmcnt(4)
    v_mfma_f32_32x32x16_bf16 v[48:63], v[12:15], v[8:11], v[48:63]
    ds_read_b64_tr_b16 v[32:33], v4 offset:30720
    ds_read_b64_tr_b16 v[34:35], v4 offset:31744
    s_add_u32 m0, s24, 8192
    s_add_u32 s20, s20, 65536
    buffer_load_dwordx4 v2, s[12:15], s21 offen offset:0 lds
    v_mfma_f32_32x32x16_bf16 v[64:79], v[16:19], v[8:11], v[64:79]
    ds_read_b128 v[36:39], v6 offset:27648
    ds_read_b128 v[40:43], v6 offset:31744
    buffer_load_dwordx4 v2, s[12:15], s21 offen offset:1024 lds
    s_waitcnt lgkmcnt(4)
    v_mfma_f32_32x32x16_bf16 v[48:63], v[24:27], v[20:23], v[48:63]
    ds_read_b64_tr_b16 v[8:9], v4 offset:49152
    ds_read_b64_tr_b16 v[10:11], v4 offset:50176
    buffer_load_dwordx4 v2, s[12:15], s21 offen offset:2048 lds
    v_mfma_f32_32x32x16_bf16 v[64:79], v[28:31], v[20:23], v[64:79]
    ds_read_b128 v[12:15], v6 offset:49152
    ds_read_b128 v[16:19], v6 offset:53248
    buffer_load_dwordx4 v2, s[12:15], s21 offen offset:3072 lds
    s_add_u32 s21, s21, 4096
    s_waitcnt lgkmcnt(4)
    v_mfma_f32_32x32x16_bf16 v[48:63], v[36:39], v[32:35], v[48:63]
    ds_read_b64_tr_b16 v[20:21], v4 offset:51200
    ds_read_b64_tr_b16 v[22:23], v4 offset:52224
    v_mfma_f32_32x32x16_bf16 v[64:79], v[40:43], v[32:35], v[64:79]
    ds_read_b128 v[24:27], v6 offset:50176
    ds_read_b128 v[28:31], v6 offset:54272
    s_waitcnt vmcnt(12)
    s_barrier
    s_waitcnt lgkmcnt(4)
    v_mfma_f32_32x32x16_bf16 v[48:63], v[12:15], v[8:11], v[48:63]
    ds_read_b64_tr_b16 v[32:33], v4 offset:53248
    ds_read_b64_tr_b16 v[34:35], v4 offset:54272
    s_add_u32 m0, s23, 24576
    s_add_u32 s22, s20, 0
    buffer_load_dwordx4 v1, s[8:11], s22 offen lds
    v_mfma_f32_32x32x16_bf16 v[64:79], v[16:19], v[8:11], v[64:79]
    ds_read_b128 v[36:39], v6 offset:51200
    ds_read_b128 v[40:43], v6 offset:55296
    s_add_u32 m0, s23, 28672
    s_add_u32 s22, s20, 32768
    buffer_load_dwordx4 v1, s[8:11], s22 offen lds
    s_waitcnt lgkmcnt(4)
    v_mfma_f32_32x32x16_bf16 v[48:63], v[24:27], v[20:23], v[48:63]
    ds_read_b64_tr_b16 v[8:9], v4 offset:55296
    ds_read_b64_tr_b16 v[10:11], v4 offset:56320
    s_add_u32 m0, s24, 32768
    s_add_u32 s20, s20, 65536
    buffer_load_dwordx4 v2, s[12:15], s21 offen offset:0 lds
    v_mfma_f32_32x32x16_bf16 v[64:79], v[28:31], v[20:23], v[64:79]
    ds_read_b128 v[12:15], v6 offset:52224
    ds_read_b128 v[16:19], v6 offset:56320
    buffer_load_dwordx4 v2, s[12:15], s21 offen offset:1024 lds
    s_waitcnt lgkmcnt(4)
    v_mfma_f32_32x32x16_bf16 v[48:63], v[36:39], v[32:35], v[48:63]
    ds_read_b64_tr_b16 v[20:21], v5 offset:8192
    ds_read_b64_tr_b16 v[22:23], v5 offset:9216
    buffer_load_dwordx4 v2, s[12:15], s21 offen offset:2048 lds
    v_mfma_f32_32x32x16_bf16 v[64:79], v[40:43], v[32:35], v[64:79]
    ds_read_b128 v[24:27], v3 offset:8192
    ds_read_b128 v[28:31], v3 offset:12288
    buffer_load_dwordx4 v2, s[12:15], s21 offen offset:3072 lds
    s_add_u32 s21, s21, 4096
    s_waitcnt lgkmcnt(4)
    v_mfma_f32_32x32x16_bf16 v[48:63], v[12:15], v[8:11], v[48:63]
    ds_read_b64_tr_b16 v[32:33], v5 offset:10240
    ds_read_b64_tr_b16 v[34:35], v5 offset:11264
    v_mfma_f32_32x32x16_bf16 v[64:79], v[16:19], v[8:11], v[64:79]
    ds_read_b128 v[36:39], v3 offset:9216
    ds_read_b128 v[40:43], v3 offset:13312
    s_waitcnt vmcnt(12)
    s_barrier
    s_waitcnt lgkmcnt(4)
    v_mfma_f32_32x32x16_bf16 v[48:63], v[24:27], v[20:23], v[48:63]
    ds_read_b64_tr_b16 v[8:9], v5 offset:12288
    ds_read_b64_tr_b16 v[10:11], v5 offset:13312
    s_add_u32 m0, s23, 49152
    s_add_u32 s22, s20, 0
    buffer_load_dwordx4 v1, s[8:11], s22 offen lds
    v_mfma_f32_32x32x16_bf16 v[64:79], v[28:31], v[20:23], v[64:79]
    ds_read_b128 v[12:15], v3 offset:10240
    ds_read_b128 v[16:19], v3 offset:14336
    s_add_u32 m0, s23, 53248
    s_add_u32 s22, s20, 32768
    buffer_load_dwordx4 v1, s[8:11], s22 offen lds
    s_waitcnt lgkmcnt(4)
    v_mfma_f32_32x32x16_bf16 v[48:63], v[36:39], v[32:35], v[48:63]
    ds_read_b64_tr_b16 v[20:21], v5 offset:14336
    ds_read_b64_tr_b16 v[22:23], v5 offset:15360
    s_add_u32 m0, s24, 57344
    s_add_u32 s20, s20, 65536
    buffer_load_dwordx4 v2, s[12:15], s21 offen offset:0 lds
    v_mfma_f32_32x32x16_bf16 v[64:79], v[40:43], v[32:35], v[64:79]
    ds_read_b128 v[24:27], v3 offset:11264
    ds_read_b128 v[28:31], v3 offset:15360
    buffer_load_dwordx4 v2, s[12:15], s21 offen offset:1024 lds
    s_waitcnt lgkmcnt(4)
    v_mfma_f32_32x32x16_bf16 v[48:63], v[12:15], v[8:11], v[48:63]
    ds_read_b64_tr_b16 v[32:33], v5 offset:32768
    ds_read_b64_tr_b16 v[34:35], v5 offset:33792
    buffer_load_dwordx4 v2, s[12:15], s21 offen offset:2048 lds
    v_mfma_f32_32x32x16_bf16 v[64:79], v[16:19], v[8:11], v[64:79]
    ds_read_b128 v[36:39], v3 offset:32768
    ds_read_b128 v[40:43], v3 offset:36864
    buffer_load_dwordx4 v2, s[12:15], s21 offen offset:3072 lds
    s_add_u32 s21, s21, 4096
    s_waitcnt lgkmcnt(4)
    v_mfma_f32_32x32x16_bf16 v[48:63], v[24:27], v[20:23], v[48:63]
    ds_read_b64_tr_b16 v[8:9], v5 offset:34816
    ds_read_b64_tr_b16 v[10:11], v5 offset:35840
    v_mfma_f32_32x32x16_bf16 v[64:79], v[28:31], v[20:23], v[64:79]
    ds_read_b128 v[12:15], v3 offset:33792
    ds_read_b128 v[16:19], v3 offset:37888
    s_waitcnt vmcnt(12)
    s_barrier
    s_waitcnt lgkmcnt(4)
    v_mfma_f32_32x32x16_bf16 v[48:63], v[36:39], v[32:35], v[48:63]
    ds_read_b64_tr_b16 v[20:21], v5 offset:36864
    ds_read_b64_tr_b16 v[22:23], v5 offset:37888
    s_add_u32 m0, s23, 73728
    s_add_u32 s22, s20, 0
    buffer_load_dwordx4 v1, s[8:11], s22 offen lds
    v_mfma_f32_32x32x16_bf16 v[64:79], v[40:43], v[32:35], v[64:79]
    ds_read_b128 v[24:27], v3 offset:34816
    ds_read_b128 v[28:31], v3 offset:38912
    s_add_u32 m0, s23, 77824
    s_add_u32 s22, s20, 32768
    buffer_load_dwordx4 v1, s[8:11], s22 offen lds
    s_waitcnt lgkmcnt(4)
    v_mfma_f32_32x32x16_bf16 v[48:63], v[12:15], v[8:11], v[48:63]
    ds_read_b64_tr_b16 v[32:33], v5 offset:38912
    ds_read_b64_tr_b16 v[34:35], v5 offset:39936
    s_add_u32 m0, s24, 81920
    s_add_u32 s20, s20, 65536
    buffer_load_dwordx4 v2, s[12:15], s21 offen offset:0 lds
    v_mfma_f32_32x32x16_bf16 v[64:79], v[16:19], v[8:11], v[64:79]
    ds_read_b128 v[36:39], v3 offset:35840
    ds_read_b128 v[40:43], v3 offset:39936
    buffer_load_dwordx4 v2, s[12:15], s21 offen offset:1024 lds
    s_waitcnt lgkmcnt(4)
    v_mfma_f32_32x32x16_bf16 v[48:63], v[24:27], v[20:23], v[48:63]
    ds_read_b64_tr_b16 v[8:9], v4 offset:0
    ds_read_b64_tr_b16 v[10:11], v4 offset:1024
    buffer_load_dwordx4 v2, s[12:15], s21 offen offset:2048 lds
    v_mfma_f32_32x32x16_bf16 v[64:79], v[28:31], v[20:23], v[64:79]
    ds_read_b128 v[12:15], v6 offset:0
    ds_read_b128 v[16:19], v6 offset:4096
    buffer_load_dwordx4 v2, s[12:15], s21 offen offset:3072 lds
    s_add_u32 s21, s21, 4096
    s_waitcnt lgkmcnt(4)
    v_mfma_f32_32x32x16_bf16 v[48:63], v[36:39], v[32:35], v[48:63]
    ds_read_b64_tr_b16 v[20:21], v4 offset:2048
    ds_read_b64_tr_b16 v[22:23], v4 offset:3072
    v_mfma_f32_32x32x16_bf16 v[64:79], v[40:43], v[32:35], v[64:79]
    ds_read_b128 v[24:27], v6 offset:1024
    ds_read_b128 v[28:31], v6 offset:5120
    s_waitcnt vmcnt(12)
    s_barrier
    s_waitcnt lgkmcnt(4)
    v_mfma_f32_32x32x16_bf16 v[48:63], v[12:15], v[8:11], v[48:63]
    ds_read_b64_tr_b16 v[32:33], v4 offset:4096
    ds_read_b64_tr_b16 v[34:35], v4 offset:5120
    s_add_u32 m0, s23, 98304
    s_add_u32 s22, s20, 0
    buffer_load_dwordx4 v1, s[8:11], s22 offen lds
    v_mfma_f32_32x32x16_bf16 v[64:79], v[16:19], v[8:11], v[64:79]
    ds_read_b128 v[36:39], v6 offset:2048
    ds_read_b128 v[40:43], v6 offset:6144
    s_add_u32 m0, s23, 102400
    s_add_u32 s22, s20, 32768
    buffer_load_dwordx4 v1, s[8:11], s22 offen lds
    s_waitcnt lgkmcnt(4)
    v_mfma_f32_32x32x16_bf16 v[48:63], v[24:27], v[20:23], v[48:63]
    ds_read_b64_tr_b16 v[8:9], v4 offset:6144
    ds_read_b64_tr_b16 v[10:11], v4 offset:7168
    s_add_u32 m0, s24, 106496
    s_add_u32 s20, s20, 65536
    buffer_load_dwordx4 v2, s[12:15], s21 offen offset:0 lds
    v_mfma_f32_32x32x16_bf16 v[64:79], v[28:31], v[20:23], v[64:79]
    ds_read_b128 v[12:15], v6 offset:3072
    ds_read_b128 v[16:19], v6 offset:7168
    buffer_load_dwordx4 v2, s[12:15], s21 offen offset:1024 lds
    s_waitcnt lgkmcnt(4)
    v_mfma_f32_32x32x16_bf16 v[48:63], v[36:39], v[32:35], v[48:63]
    ds_read_b64_tr_b16 v[20:21], v4 offset:24576
    ds_read_b64_tr_b16 v[22:23], v4 offset:25600
    buffer_load_dwordx4 v2, s[12:15], s21 offen offset:2048 lds
    v_mfma_f32_32x32x16_bf16 v[64:79], v[40:43], v[32:35], v[64:79]
    ds_read_b128 v[24:27], v6 offset:24576
    ds_read_b128 v[28:31], v6 offset:28672
    buffer_load_dwordx4 v2, s[12:15], s21 offen offset:3072 lds
    s_add_u32 s21, s21, 4096
    s_waitcnt lgkmcnt(4)
    v_mfma_f32_32x32x16_bf16 v[48:63], v[12:15], v[8:11], v[48:63]
    ds_read_b64_tr_b16 v[32:33], v4 offset:26624
    ds_read_b64_tr_b16 v[34:35], v4 offset:27648
    v_mfma_f32_32x32x16_bf16 v[64:79], v[16:19], v[8:11], v[64:79]
    ds_read_b128 v[36:39], v6 offset:25600
    ds_read_b128 v[40:43], v6 offset:29696
    s_waitcnt vmcnt(12)
    s_barrier
    s_waitcnt lgkmcnt(4)
    v_mfma_f32_32x32x16_bf16 v[48:63], v[24:27], v[20:23], v[48:63]
    ds_read_b64_tr_b16 v[8:9], v4 offset:28672
    ds_read_b64_tr_b16 v[10:11], v4 offset:29696
    s_add_u32 m0, s23, 0
    s_add_u32 s22, s20, 0
    buffer_load_dwordx4 v1, s[8:11], s22 offen lds
    v_mfma_f32_32x32x16_bf16 v[64:79], v[28:31], v[20:23], v[64:79]
    ds_read_b128 v[12:15], v6 offset:26624
    ds_read_b128 v[16:19], v6 offset:30720
    s_add_u32 m0, s23, 4096
    s_add_u32 s22, s20, 32768
    buffer_load_dwordx4 v1, s[8:11], s22 offen lds
    s_waitcnt lgkmcnt(4)
    v_mfma_f32_32x32x16_bf16 v[48:63], v[36:39], v[32:35], v[48:63]
    ds_read_b64_tr_b16 v[20:21], v4 offset:30720
    ds_read_b64_tr_b16 v[22:23], v4 offset:31744
    s_add_u32 m0, s24, 8192
    s_add_u32 s20, s20, 65536
    buffer_load_dwordx4 v2, s[12:15], s21 offen offset:0 lds
    v_mfma_f32_32x32x16_bf16 v[64:79], v[40:43], v[32:35], v[64:79]
    ds_read_b128 v[24:27], v6 offset:27648
    ds_read_b128 v[28:31], v6 offset:31744
    buffer_load_dwordx4 v2, s[12:15], s21 offen offset:1024 lds
    s_waitcnt lgkmcnt(4)
    v_mfma_f32_32x32x16_bf16 v[48:63], v[12:15], v[8:11], v[48:63]
    ds_read_b64_tr_b16 v[32:33], v4 offset:49152
    ds_read_b64_tr_b16 v[34:35], v4 offset:50176
    buffer_load_dwordx4 v2, s[12:15], s21 offen offset:2048 lds
    v_mfma_f32_32x32x16_bf16 v[64:79], v[16:19], v[8:11], v[64:79]
    ds_read_b128 v[36:39], v6 offset:49152
    ds_read_b128 v[40:43], v6 offset:53248
    buffer_load_dwordx4 v2, s[12:15], s21 offen offset:3072 lds
    s_add_u32 s21, s21, 4096
    s_waitcnt lgkmcnt(4)
    v_mfma_f32_32x32x16_bf16 v[48:63], v[24:27], v[20:23], v[48:63]
    ds_read_b64_tr_b16 v[8:9], v4 offset:51200
    ds_read_b64_tr_b16 v[10:11], v4 offset:52224
    v_mfma_f32_32x32x16_bf16 v[64:79], v[28:31], v[20:23], v[64:79]
    ds_read_b128 v[12:15], v6 offset:50176
    ds_read_b128 v[16:19], v6 offset:54272
    s_waitcnt vmcnt(12)
    s_barrier
    s_waitcnt lgkmcnt(4)
    v_mfma_f32_32x32x16_bf16 v[48:63], v[36:39], v[32:35], v[48:63]
    ds_read_b64_tr_b16 v[20:21], v4 offset:53248
    ds_read_b64_tr_b16 v[22:23], v4 offset:54272
    s_add_u32 m0, s23, 24576
    s_add_u32 s22, s20, 0
    buffer_load_dwordx4 v1, s[8:11], s22 offen lds
    v_mfma_f32_32x32x16_bf16 v[64:79], v[40:43], v[32:35], v[64:79]
    ds_read_b128 v[24:27], v6 offset:51200
    ds_read_b128 v[28:31], v6 offset:55296
    s_add_u32 m0, s23, 28672
    s_add_u32 s22, s20, 32768
    buffer_load_dwordx4 v1, s[8:11], s22 offen lds
    s_waitcnt lgkmcnt(4)
    v_mfma_f32_32x32x16_bf16 v[48:63], v[12:15], v[8:11], v[48:63]
    ds_read_b64_tr_b16 v[32:33], v4 offset:55296
    ds_read_b64_tr_b16 v[34:35], v4 offset:56320
    s_add_u32 m0, s24, 32768
    s_add_u32 s20, s20, 65536
    buffer_load_dwordx4 v2, s[12:15], s21 offen offset:0 lds
    v_mfma_f32_32x32x16_bf16 v[64:79], v[16:19], v[8:11], v[64:79]
    ds_read_b128 v[36:39], v6 offset:52224
    ds_read_b128 v[40:43], v6 offset:56320
    buffer_load_dwordx4 v2, s[12:15], s21 offen offset:1024 lds
    s_waitcnt lgkmcnt(4)
    v_mfma_f32_32x32x16_bf16 v[48:63], v[24:27], v[20:23], v[48:63]
    ds_read_b64_tr_b16 v[8:9], v5 offset:8192
    ds_read_b64_tr_b16 v[10:11], v5 offset:9216
    buffer_load_dwordx4 v2, s[12:15], s21 offen offset:2048 lds
    v_mfma_f32_32x32x16_bf16 v[64:79], v[28:31], v[20:23], v[64:79]
    ds_read_b128 v[12:15], v3 offset:8192
    ds_read_b128 v[16:19], v3 offset:12288
    buffer_load_dwordx4 v2, s[12:15], s21 offen offset:3072 lds
    s_add_u32 s21, s21, 4096
    s_waitcnt lgkmcnt(4)
    v_mfma_f32_32x32x16_bf16 v[48:63], v[36:39], v[32:35], v[48:63]
    ds_read_b64_tr_b16 v[20:21], v5 offset:10240
    ds_read_b64_tr_b16 v[22:23], v5 offset:11264
    v_mfma_f32_32x32x16_bf16 v[64:79], v[40:43], v[32:35], v[64:79]
    ds_read_b128 v[24:27], v3 offset:9216
    ds_read_b128 v[28:31], v3 offset:13312
    s_waitcnt vmcnt(12)
    s_barrier
    s_waitcnt lgkmcnt(4)
    v_mfma_f32_32x32x16_bf16 v[48:63], v[12:15], v[8:11], v[48:63]
    ds_read_b64_tr_b16 v[32:33], v5 offset:12288
    ds_read_b64_tr_b16 v[34:35], v5 offset:13312
    s_add_u32 m0, s23, 49152
    s_add_u32 s22, s20, 0
    buffer_load_dwordx4 v1, s[8:11], s22 offen lds
    v_mfma_f32_32x32x16_bf16 v[64:79], v[16:19], v[8:11], v[64:79]
    ds_read_b128 v[36:39], v3 offset:10240
    ds_read_b128 v[40:43], v3 offset:14336
    s_add_u32 m0, s23, 53248
    s_add_u32 s22, s20, 32768
    buffer_load_dwordx4 v1, s[8:11], s22 offen lds
    s_waitcnt lgkmcnt(4)
    v_mfma_f32_32x32x16_bf16 v[48:63], v[24:27], v[20:23], v[48:63]
    ds_read_b64_tr_b16 v[8:9], v5 offset:14336
    ds_read_b64_tr_b16 v[10:11], v5 offset:15360
    s_add_u32 m0, s24, 57344
    s_add_u32 s20, s20, 65536
    buffer_load_dwordx4 v2, s[12:15], s21 offen offset:0 lds
    v_mfma_f32_32x32x16_bf16 v[64:79], v[28:31], v[20:23], v[64:79]
    ds_read_b128 v[12:15], v3 offset:11264
    ds_read_b128 v[16:19], v3 offset:15360
    buffer_load_dwordx4 v2, s[12:15], s21 offen offset:1024 lds
    s_waitcnt lgkmcnt(4)
    v_mfma_f32_32x32x16_bf16 v[48:63], v[36:39], v[32:35], v[48:63]
    ds_read_b64_tr_b16 v[20:21], v5 offset:32768
    ds_read_b64_tr_b16 v[22:23], v5 offset:33792
    buffer_load_dwordx4 v2, s[12:15], s21 offen offset:2048 lds
    v_mfma_f32_32x32x16_bf16 v[64:79], v[40:43], v[32:35], v[64:79]
    ds_read_b128 v[24:27], v3 offset:32768
    ds_read_b128 v[28:31], v3 offset:36864
    buffer_load_dwordx4 v2, s[12:15], s21 offen offset:3072 lds
    s_add_u32 s21, s21, 4096
    s_waitcnt lgkmcnt(4)
    v_mfma_f32_32x32x16_bf16 v[48:63], v[12:15], v[8:11], v[48:63]
    ds_read_b64_tr_b16 v[32:33], v5 offset:34816
    ds_read_b64_tr_b16 v[34:35], v5 offset:35840
    v_mfma_f32_32x32x16_bf16 v[64:79], v[16:19], v[8:11], v[64:79]
    ds_read_b128 v[36:39], v3 offset:33792
    ds_read_b128 v[40:43], v3 offset:37888
    s_waitcnt vmcnt(12)
    s_barrier
    s_waitcnt lgkmcnt(4)
    v_mfma_f32_32x32x16_bf16 v[48:63], v[24:27], v[20:23], v[48:63]
    ds_read_b64_tr_b16 v[8:9], v5 offset:36864
    ds_read_b64_tr_b16 v[10:11], v5 offset:37888
    s_add_u32 m0, s23, 73728
    s_add_u32 s22, s20, 0
    buffer_load_dwordx4 v1, s[8:11], s22 offen lds
    v_mfma_f32_32x32x16_bf16 v[64:79], v[28:31], v[20:23], v[64:79]
    ds_read_b128 v[12:15], v3 offset:34816
    ds_read_b128 v[16:19], v3 offset:38912
    s_add_u32 m0, s23, 77824
    s_add_u32 s22, s20, 32768
    buffer_load_dwordx4 v1, s[8:11], s22 offen lds
    s_waitcnt lgkmcnt(4)
    v_mfma_f32_32x32x16_bf16 v[48:63], v[36:39], v[32:35], v[48:63]
    ds_read_b64_tr_b16 v[20:21], v5 offset:38912
    ds_read_b64_tr_b16 v[22:23], v5 offset:39936
    s_add_u32 m0, s24, 81920
    s_add_u32 s20, s20, 65536
    buffer_load_dwordx4 v2, s[12:15], s21 offen offset:0 lds
    v_mfma_f32_32x32x16_bf16 v[64:79], v[40:43], v[32:35], v[64:79]
    ds_read_b128 v[24:27], v3 offset:35840
    ds_read_b128 v[28:31], v3 offset:39936
    buffer_load_dwordx4 v2, s[12:15], s21 offen offset:1024 lds
    s_waitcnt lgkmcnt(4)
    v_mfma_f32_32x32x16_bf16 v[48:63], v[12:15], v[8:11], v[48:63]
    ds_read_b64_tr_b16 v[32:33], v4 offset:0
    ds_read_b64_tr_b16 v[34:35], v4 offset:1024
    buffer_load_dwordx4 v2, s[12:15], s21 offen offset:2048 lds
    v_mfma_f32_32x32x16_bf16 v[64:79], v[16:19], v[8:11], v[64:79]
    ds_read_b128 v[36:39], v6 offset:0
    ds_read_b128 v[40:43], v6 offset:4096
    buffer_load_dwordx4 v2, s[12:15], s21 offen offset:3072 lds
    s_add_u32 s21, s21, 4096
    s_waitcnt lgkmcnt(4)
    v_mfma_f32_32x32x16_bf16 v[48:63], v[24:27], v[20:23], v[48:63]
    ds_read_b64_tr_b16 v[8:9], v4 offset:2048
    ds_read_b64_tr_b16 v[10:11], v4 offset:3072
    v_mfma_f32_32x32x16_bf16 v[64:79], v[28:31], v[20:23], v[64:79]
    ds_read_b128 v[12:15], v6 offset:1024
    ds_read_b128 v[16:19], v6 offset:5120
    s_waitcnt vmcnt(12)
    s_barrier
    s_waitcnt lgkmcnt(4)
    v_mfma_f32_32x32x16_bf16 v[48:63], v[36:39], v[32:35], v[48:63]
    ds_read_b64_tr_b16 v[20:21], v4 offset:4096
    ds_read_b64_tr_b16 v[22:23], v4 offset:5120
    s_add_u32 m0, s23, 98304
    s_add_u32 s22, s20, 0
    buffer_load_dwordx4 v1, s[8:11], s22 offen lds
    v_mfma_f32_32x32x16_bf16 v[64:79], v[40:43], v[32:35], v[64:79]
    ds_read_b128 v[24:27], v6 offset:2048
    ds_read_b128 v[28:31], v6 offset:6144
    s_add_u32 m0, s23, 102400
    s_add_u32 s22, s20, 32768
    buffer_load_dwordx4 v1, s[8:11], s22 offen lds
    s_waitcnt lgkmcnt(4)
    v_mfma_f32_32x32x16_bf16 v[48:63], v[12:15], v[8:11], v[48:63]
    ds_read_b64_tr_b16 v[32:33], v4 offset:6144
    ds_read_b64_tr_b16 v[34:35], v4 offset:7168
    s_add_u32 m0, s24, 106496
    s_add_u32 s20, s20, 65536
    buffer_load_dwordx4 v2, s[12:15], s21 offen offset:0 lds
    v_mfma_f32_32x32x16_bf16 v[64:79], v[16:19], v[8:11], v[64:79]
    ds_read_b128 v[36:39], v6 offset:3072
    ds_read_b128 v[40:43], v6 offset:7168
    buffer_load_dwordx4 v2, s[12:15], s21 offen offset:1024 lds
    s_waitcnt lgkmcnt(4)
    v_mfma_f32_32x32x16_bf16 v[48:63], v[24:27], v[20:23], v[48:63]
    ds_read_b64_tr_b16 v[8:9], v4 offset:24576
    ds_read_b64_tr_b16 v[10:11], v4 offset:25600
    buffer_load_dwordx4 v2, s[12:15], s21 offen offset:2048 lds
    v_mfma_f32_32x32x16_bf16 v[64:79], v[28:31], v[20:23], v[64:79]
    ds_read_b128 v[12:15], v6 offset:24576
    ds_read_b128 v[16:19], v6 offset:28672
    buffer_load_dwordx4 v2, s[12:15], s21 offen offset:3072 lds
    s_add_u32 s21, s21, 4096
    s_waitcnt lgkmcnt(4)
    v_mfma_f32_32x32x16_bf16 v[48:63], v[36:39], v[32:35], v[48:63]
    ds_read_b64_tr_b16 v[20:21], v4 offset:26624
    ds_read_b64_tr_b16 v[22:23], v4 offset:27648
    v_mfma_f32_32x32x16_bf16 v[64:79], v[40:43], v[32:35], v[64:79]
    ds_read_b128 v[24:27], v6 offset:25600
    ds_read_b128 v[28:31], v6 offset:29696
    s_waitcnt vmcnt(12)
    s_barrier
    s_waitcnt lgkmcnt(4)
    v_mfma_f32_32x32x16_bf16 v[48:63], v[12:15], v[8:11], v[48:63]
    ds_read_b64_tr_b16 v[32:33], v4 offset:28672
    ds_read_b64_tr_b16 v[34:35], v4 offset:29696
    s_add_u32 m0, s23, 0
    s_add_u32 s22, s20, 0
    buffer_load_dwordx4 v1, s[8:11], s22 offen lds
    v_mfma_f32_32x32x16_bf16 v[64:79], v[16:19], v[8:11], v[64:79]
    ds_read_b128 v[36:39], v6 offset:26624
    ds_read_b128 v[40:43], v6 offset:30720
    s_add_u32 m0, s23, 4096
    s_add_u32 s22, s20, 32768
    buffer_load_dwordx4 v1, s[8:11], s22 offen lds
    s_waitcnt lgkmcnt(4)
    v_mfma_f32_32x32x16_bf16 v[48:63], v[24:27], v[20:23], v[48:63]
    ds_read_b64_tr_b16 v[8:9], v4 offset:30720
    ds_read_b64_tr_b16 v[10:11], v4 offset:31744
    s_add_u32 m0, s24, 8192
    s_add_u32 s20, s20, 65536
    buffer_load_dwordx4 v2, s[12:15], s21 offen offset:0 lds
    v_mfma_f32_32x32x16_bf16 v[64:79], v[28:31], v[20:23], v[64:79]
    ds_read_b128 v[12:15], v6 offset:27648
    ds_read_b128 v[16:19], v6 offset:31744
    buffer_load_dwordx4 v2, s[12:15], s21 offen offset:1024 lds
    s_waitcnt lgkmcnt(4)
    v_mfma_f32_32x32x16_bf16 v[48:63], v[36:39], v[32:35], v[48:63]
    ds_read_b64_tr_b16 v[20:21], v4 offset:49152
    ds_read_b64_tr_b16 v[22:23], v4 offset:50176
    buffer_load_dwordx4 v2, s[12:15], s21 offen offset:2048 lds
    v_mfma_f32_32x32x16_bf16 v[64:79], v[40:43], v[32:35], v[64:79]
    ds_read_b128 v[24:27], v6 offset:49152
    ds_read_b128 v[28:31], v6 offset:53248
    buffer_load_dwordx4 v2, s[12:15], s21 offen offset:3072 lds
    s_add_u32 s21, s21, 4096
    s_waitcnt lgkmcnt(4)
    v_mfma_f32_32x32x16_bf16 v[48:63], v[12:15], v[8:11], v[48:63]
    ds_read_b64_tr_b16 v[32:33], v4 offset:51200
    ds_read_b64_tr_b16 v[34:35], v4 offset:52224
    v_mfma_f32_32x32x16_bf16 v[64:79], v[16:19], v[8:11], v[64:79]
    ds_read_b128 v[36:39], v6 offset:50176
    ds_read_b128 v[40:43], v6 offset:54272
    s_waitcnt vmcnt(12)
    s_barrier
    s_waitcnt lgkmcnt(4)
    v_mfma_f32_32x32x16_bf16 v[48:63], v[24:27], v[20:23], v[48:63]
    ds_read_b64_tr_b16 v[8:9], v4 offset:53248
    ds_read_b64_tr_b16 v[10:11], v4 offset:54272
    s_add_u32 m0, s23, 24576
    s_add_u32 s22, s20, 0
    buffer_load_dwordx4 v1, s[8:11], s22 offen lds
    v_mfma_f32_32x32x16_bf16 v[64:79], v[28:31], v[20:23], v[64:79]
    ds_read_b128 v[12:15], v6 offset:51200
    ds_read_b128 v[16:19], v6 offset:55296
    s_add_u32 m0, s23, 28672
    s_add_u32 s22, s20, 32768
    buffer_load_dwordx4 v1, s[8:11], s22 offen lds
    s_waitcnt lgkmcnt(4)
    v_mfma_f32_32x32x16_bf16 v[48:63], v[36:39], v[32:35], v[48:63]
    ds_read_b64_tr_b16 v[20:21], v4 offset:55296
    ds_read_b64_tr_b16 v[22:23], v4 offset:56320
    s_add_u32 m0, s24, 32768
    s_add_u32 s20, s20, 65536
    buffer_load_dwordx4 v2, s[12:15], s21 offen offset:0 lds
    v_mfma_f32_32x32x16_bf16 v[64:79], v[40:43], v[32:35], v[64:79]
    ds_read_b128 v[24:27], v6 offset:52224
    ds_read_b128 v[28:31], v6 offset:56320
    buffer_load_dwordx4 v2, s[12:15], s21 offen offset:1024 lds
    s_waitcnt lgkmcnt(4)
    v_mfma_f32_32x32x16_bf16 v[48:63], v[12:15], v[8:11], v[48:63]
    ds_read_b64_tr_b16 v[32:33], v5 offset:8192
    ds_read_b64_tr_b16 v[34:35], v5 offset:9216
    buffer_load_dwordx4 v2, s[12:15], s21 offen offset:2048 lds
    v_mfma_f32_32x32x16_bf16 v[64:79], v[16:19], v[8:11], v[64:79]
    ds_read_b128 v[36:39], v3 offset:8192
    ds_read_b128 v[40:43], v3 offset:12288
    buffer_load_dwordx4 v2, s[12:15], s21 offen offset:3072 lds
    s_add_u32 s21, s21, 4096
    s_waitcnt lgkmcnt(4)
    v_mfma_f32_32x32x16_bf16 v[48:63], v[24:27], v[20:23], v[48:63]
    ds_read_b64_tr_b16 v[8:9], v5 offset:10240
    ds_read_b64_tr_b16 v[10:11], v5 offset:11264
    v_mfma_f32_32x32x16_bf16 v[64:79], v[28:31], v[20:23], v[64:79]
    ds_read_b128 v[12:15], v3 offset:9216
    ds_read_b128 v[16:19], v3 offset:13312
    s_waitcnt vmcnt(12)
    s_barrier
    s_waitcnt lgkmcnt(4)
    v_mfma_f32_32x32x16_bf16 v[48:63], v[36:39], v[32:35], v[48:63]
    ds_read_b64_tr_b16 v[20:21], v5 offset:12288
    ds_read_b64_tr_b16 v[22:23], v5 offset:13312
    s_add_u32 m0, s23, 49152
    s_add_u32 s22, s20, 0
    buffer_load_dwordx4 v1, s[8:11], s22 offen lds
    v_mfma_f32_32x32x16_bf16 v[64:79], v[40:43], v[32:35], v[64:79]
    ds_read_b128 v[24:27], v3 offset:10240
    ds_read_b128 v[28:31], v3 offset:14336
    s_add_u32 m0, s23, 53248
    s_add_u32 s22, s20, 32768
    buffer_load_dwordx4 v1, s[8:11], s22 offen lds
    s_waitcnt lgkmcnt(4)
    v_mfma_f32_32x32x16_bf16 v[48:63], v[12:15], v[8:11], v[48:63]
    ds_read_b64_tr_b16 v[32:33], v5 offset:14336
    ds_read_b64_tr_b16 v[34:35], v5 offset:15360
    s_add_u32 m0, s24, 57344
    s_add_u32 s20, s20, 65536
    buffer_load_dwordx4 v2, s[12:15], s21 offen offset:0 lds
    v_mfma_f32_32x32x16_bf16 v[64:79], v[16:19], v[8:11], v[64:79]
    ds_read_b128 v[36:39], v3 offset:11264
    ds_read_b128 v[40:43], v3 offset:15360
    buffer_load_dwordx4 v2, s[12:15], s21 offen offset:1024 lds
    s_waitcnt lgkmcnt(4)
    v_mfma_f32_32x32x16_bf16 v[48:63], v[24:27], v[20:23], v[48:63]
    ds_read_b64_tr_b16 v[8:9], v5 offset:32768
    ds_read_b64_tr_b16 v[10:11], v5 offset:33792
    buffer_load_dwordx4 v2, s[12:15], s21 offen offset:2048 lds
    v_mfma_f32_32x32x16_bf16 v[64:79], v[28:31], v[20:23], v[64:79]
    ds_read_b128 v[12:15], v3 offset:32768
    ds_read_b128 v[16:19], v3 offset:36864
    buffer_load_dwordx4 v2, s[12:15], s21 offen offset:3072 lds
    s_add_u32 s21, s21, 4096
    s_waitcnt lgkmcnt(4)
    v_mfma_f32_32x32x16_bf16 v[48:63], v[36:39], v[32:35], v[48:63]
    ds_read_b64_tr_b16 v[20:21], v5 offset:34816
    ds_read_b64_tr_b16 v[22:23], v5 offset:35840
    v_mfma_f32_32x32x16_bf16 v[64:79], v[40:43], v[32:35], v[64:79]
    ds_read_b128 v[24:27], v3 offset:33792
    ds_read_b128 v[28:31], v3 offset:37888
    s_waitcnt vmcnt(12)
    s_barrier
    s_waitcnt lgkmcnt(4)
    v_mfma_f32_32x32x16_bf16 v[48:63], v[12:15], v[8:11], v[48:63]
    ds_read_b64_tr_b16 v[32:33], v5 offset:36864
    ds_read_b64_tr_b16 v[34:35], v5 offset:37888
    s_add_u32 m0, s23, 73728
    s_add_u32 s22, s20, 0
    buffer_load_dwordx4 v1, s[8:11], s22 offen lds
    v_mfma_f32_32x32x16_bf16 v[64:79], v[16:19], v[8:11], v[64:79]
    ds_read_b128 v[36:39], v3 offset:34816
    ds_read_b128 v[40:43], v3 offset:38912
    s_add_u32 m0, s23, 77824
    s_add_u32 s22, s20, 32768
    buffer_load_dwordx4 v1, s[8:11], s22 offen lds
    s_waitcnt lgkmcnt(4)
    v_mfma_f32_32x32x16_bf16 v[48:63], v[24:27], v[20:23], v[48:63]
    ds_read_b64_tr_b16 v[8:9], v5 offset:38912
    ds_read_b64_tr_b16 v[10:11], v5 offset:39936
    s_add_u32 m0, s24, 81920
    s_add_u32 s20, s20, 65536
    buffer_load_dwordx4 v2, s[12:15], s21 offen offset:0 lds
    v_mfma_f32_32x32x16_bf16 v[64:79], v[28:31], v[20:23], v[64:79]
    ds_read_b128 v[12:15], v3 offset:35840
    ds_read_b128 v[16:19], v3 offset:39936
    buffer_load_dwordx4 v2, s[12:15], s21 offen offset:1024 lds
    s_waitcnt lgkmcnt(4)
    v_mfma_f32_32x32x16_bf16 v[48:63], v[36:39], v[32:35], v[48:63]
    ds_read_b64_tr_b16 v[20:21], v4 offset:0
    ds_read_b64_tr_b16 v[22:23], v4 offset:1024
    buffer_load_dwordx4 v2, s[12:15], s21 offen offset:2048 lds
    v_mfma_f32_32x32x16_bf16 v[64:79], v[40:43], v[32:35], v[64:79]
    ds_read_b128 v[24:27], v6 offset:0
    ds_read_b128 v[28:31], v6 offset:4096
    buffer_load_dwordx4 v2, s[12:15], s21 offen offset:3072 lds
    s_add_u32 s21, s21, 4096
    s_waitcnt lgkmcnt(4)
    v_mfma_f32_32x32x16_bf16 v[48:63], v[12:15], v[8:11], v[48:63]
    ds_read_b64_tr_b16 v[32:33], v4 offset:2048
    ds_read_b64_tr_b16 v[34:35], v4 offset:3072
    v_mfma_f32_32x32x16_bf16 v[64:79], v[16:19], v[8:11], v[64:79]
    ds_read_b128 v[36:39], v6 offset:1024
    ds_read_b128 v[40:43], v6 offset:5120
    s_waitcnt vmcnt(12)
    s_barrier
    s_waitcnt lgkmcnt(4)
    v_mfma_f32_32x32x16_bf16 v[48:63], v[24:27], v[20:23], v[48:63]
    ds_read_b64_tr_b16 v[8:9], v4 offset:4096
    ds_read_b64_tr_b16 v[10:11], v4 offset:5120
    s_add_u32 m0, s23, 98304
    s_add_u32 s22, s20, 0
    buffer_load_dwordx4 v1, s[8:11], s22 offen lds
    v_mfma_f32_32x32x16_bf16 v[64:79], v[28:31], v[20:23], v[64:79]
    ds_read_b128 v[12:15], v6 offset:2048
    ds_read_b128 v[16:19], v6 offset:6144
    s_add_u32 m0, s23, 102400
    s_add_u32 s22, s20, 32768
    buffer_load_dwordx4 v1, s[8:11], s22 offen lds
    s_waitcnt lgkmcnt(4)
    v_mfma_f32_32x32x16_bf16 v[48:63], v[36:39], v[32:35], v[48:63]
    ds_read_b64_tr_b16 v[20:21], v4 offset:6144
    ds_read_b64_tr_b16 v[22:23], v4 offset:7168
    s_add_u32 m0, s24, 106496
    s_add_u32 s20, s20, 65536
    buffer_load_dwordx4 v2, s[12:15], s21 offen offset:0 lds
    v_mfma_f32_32x32x16_bf16 v[64:79], v[40:43], v[32:35], v[64:79]
    ds_read_b128 v[24:27], v6 offset:3072
    ds_read_b128 v[28:31], v6 offset:7168
    buffer_load_dwordx4 v2, s[12:15], s21 offen offset:1024 lds
    s_waitcnt lgkmcnt(4)
    v_mfma_f32_32x32x16_bf16 v[48:63], v[12:15], v[8:11], v[48:63]
    ds_read_b64_tr_b16 v[32:33], v4 offset:24576
    ds_read_b64_tr_b16 v[34:35], v4 offset:25600
    buffer_load_dwordx4 v2, s[12:15], s21 offen offset:2048 lds
    v_mfma_f32_32x32x16_bf16 v[64:79], v[16:19], v[8:11], v[64:79]
    ds_read_b128 v[36:39], v6 offset:24576
    ds_read_b128 v[40:43], v6 offset:28672
    buffer_load_dwordx4 v2, s[12:15], s21 offen offset:3072 lds
    s_add_u32 s21, s21, 4096
    s_waitcnt lgkmcnt(4)
    v_mfma_f32_32x32x16_bf16 v[48:63], v[24:27], v[20:23], v[48:63]
    ds_read_b64_tr_b16 v[8:9], v4 offset:26624
    ds_read_b64_tr_b16 v[10:11], v4 offset:27648
    v_mfma_f32_32x32x16_bf16 v[64:79], v[28:31], v[20:23], v[64:79]
    ds_read_b128 v[12:15], v6 offset:25600
    ds_read_b128 v[16:19], v6 offset:29696
    s_waitcnt vmcnt(12)
    s_barrier
    s_waitcnt lgkmcnt(4)
    v_mfma_f32_32x32x16_bf16 v[48:63], v[36:39], v[32:35], v[48:63]
    ds_read_b64_tr_b16 v[20:21], v4 offset:28672
    ds_read_b64_tr_b16 v[22:23], v4 offset:29696
    s_add_u32 m0, s23, 0
    s_add_u32 s22, s20, 0
    buffer_load_dwordx4 v1, s[8:11], s22 offen lds
    v_mfma_f32_32x32x16_bf16 v[64:79], v[40:43], v[32:35], v[64:79]
    ds_read_b128 v[24:27], v6 offset:26624
    ds_read_b128 v[28:31], v6 offset:30720
    s_add_u32 m0, s23, 4096
    s_add_u32 s22, s20, 32768
    buffer_load_dwordx4 v1, s[8:11], s22 offen lds
    s_waitcnt lgkmcnt(4)
    v_mfma_f32_32x32x16_bf16 v[48:63], v[12:15], v[8:11], v[48:63]
    ds_read_b64_tr_b16 v[32:33], v4 offset:30720
    ds_read_b64_tr_b16 v[34:35], v4 offset:31744
    s_add_u32 m0, s24, 8192
    s_add_u32 s20, s20, 65536
    buffer_load_dwordx4 v2, s[12:15], s21 offen offset:0 lds
    v_mfma_f32_32x32x16_bf16 v[64:79], v[16:19], v[8:11], v[64:79]
    ds_read_b128 v[36:39], v6 offset:27648
    ds_read_b128 v[40:43], v6 offset:31744
    buffer_load_dwordx4 v2, s[12:15], s21 offen offset:1024 lds
    s_waitcnt lgkmcnt(4)
    v_mfma_f32_32x32x16_bf16 v[48:63], v[24:27], v[20:23], v[48:63]
    ds_read_b64_tr_b16 v[8:9], v4 offset:49152
    ds_read_b64_tr_b16 v[10:11], v4 offset:50176
    buffer_load_dwordx4 v2, s[12:15], s21 offen offset:2048 lds
    v_mfma_f32_32x32x16_bf16 v[64:79], v[28:31], v[20:23], v[64:79]
    ds_read_b128 v[12:15], v6 offset:49152
    ds_read_b128 v[16:19], v6 offset:53248
    buffer_load_dwordx4 v2, s[12:15], s21 offen offset:3072 lds
    s_add_u32 s21, s21, 4096
    s_waitcnt lgkmcnt(4)
    v_mfma_f32_32x32x16_bf16 v[48:63], v[36:39], v[32:35], v[48:63]
    ds_read_b64_tr_b16 v[20:21], v4 offset:51200
    ds_read_b64_tr_b16 v[22:23], v4 offset:52224
    v_mfma_f32_32x32x16_bf16 v[64:79], v[40:43], v[32:35], v[64:79]
    ds_read_b128 v[24:27], v6 offset:50176
    ds_read_b128 v[28:31], v6 offset:54272
    s_waitcnt vmcnt(12)
    s_barrier
    s_waitcnt lgkmcnt(4)
    v_mfma_f32_32x32x16_bf16 v[48:63], v[12:15], v[8:11], v[48:63]
    ds_read_b64_tr_b16 v[32:33], v4 offset:53248
    ds_read_b64_tr_b16 v[34:35], v4 offset:54272
    s_add_u32 m0, s23, 24576
    s_add_u32 s22, s20, 0
    buffer_load_dwordx4 v1, s[8:11], s22 offen lds
    v_mfma_f32_32x32x16_bf16 v[64:79], v[16:19], v[8:11], v[64:79]
    ds_read_b128 v[36:39], v6 offset:51200
    ds_read_b128 v[40:43], v6 offset:55296
    s_add_u32 m0, s23, 28672
    s_add_u32 s22, s20, 32768
    buffer_load_dwordx4 v1, s[8:11], s22 offen lds
    s_waitcnt lgkmcnt(4)
    v_mfma_f32_32x32x16_bf16 v[48:63], v[24:27], v[20:23], v[48:63]
    ds_read_b64_tr_b16 v[8:9], v4 offset:55296
    ds_read_b64_tr_b16 v[10:11], v4 offset:56320
    s_add_u32 m0, s24, 32768
    s_add_u32 s20, s20, 65536
    buffer_load_dwordx4 v2, s[12:15], s21 offen offset:0 lds
    v_mfma_f32_32x32x16_bf16 v[64:79], v[28:31], v[20:23], v[64:79]
    ds_read_b128 v[12:15], v6 offset:52224
    ds_read_b128 v[16:19], v6 offset:56320
    buffer_load_dwordx4 v2, s[12:15], s21 offen offset:1024 lds
    s_waitcnt lgkmcnt(4)
    v_mfma_f32_32x32x16_bf16 v[48:63], v[36:39], v[32:35], v[48:63]
    ds_read_b64_tr_b16 v[20:21], v5 offset:8192
    ds_read_b64_tr_b16 v[22:23], v5 offset:9216
    buffer_load_dwordx4 v2, s[12:15], s21 offen offset:2048 lds
    v_mfma_f32_32x32x16_bf16 v[64:79], v[40:43], v[32:35], v[64:79]
    ds_read_b128 v[24:27], v3 offset:8192
    ds_read_b128 v[28:31], v3 offset:12288
    buffer_load_dwordx4 v2, s[12:15], s21 offen offset:3072 lds
    s_add_u32 s21, s21, 4096
    s_waitcnt lgkmcnt(4)
    v_mfma_f32_32x32x16_bf16 v[48:63], v[12:15], v[8:11], v[48:63]
    ds_read_b64_tr_b16 v[32:33], v5 offset:10240
    ds_read_b64_tr_b16 v[34:35], v5 offset:11264
    v_mfma_f32_32x32x16_bf16 v[64:79], v[16:19], v[8:11], v[64:79]
    ds_read_b128 v[36:39], v3 offset:9216
    ds_read_b128 v[40:43], v3 offset:13312
    s_waitcnt vmcnt(12)
    s_barrier
    s_waitcnt lgkmcnt(4)
    v_mfma_f32_32x32x16_bf16 v[48:63], v[24:27], v[20:23], v[48:63]
    ds_read_b64_tr_b16 v[8:9], v5 offset:12288
    ds_read_b64_tr_b16 v[10:11], v5 offset:13312
    v_mfma_f32_32x32x16_bf16 v[64:79], v[28:31], v[20:23], v[64:79]
    ds_read_b128 v[12:15], v3 offset:10240
    ds_read_b128 v[16:19], v3 offset:14336
    s_waitcnt lgkmcnt(4)
    v_mfma_f32_32x32x16_bf16 v[48:63], v[36:39], v[32:35], v[48:63]
    ds_read_b64_tr_b16 v[20:21], v5 offset:14336
    ds_read_b64_tr_b16 v[22:23], v5 offset:15360
    v_mfma_f32_32x32x16_bf16 v[64:79], v[40:43], v[32:35], v[64:79]
    ds_read_b128 v[24:27], v3 offset:11264
    ds_read_b128 v[28:31], v3 offset:15360
    s_waitcnt lgkmcnt(4)
    v_mfma_f32_32x32x16_bf16 v[48:63], v[12:15], v[8:11], v[48:63]
    ds_read_b64_tr_b16 v[32:33], v5 offset:32768
    ds_read_b64_tr_b16 v[34:35], v5 offset:33792
    v_mfma_f32_32x32x16_bf16 v[64:79], v[16:19], v[8:11], v[64:79]
    ds_read_b128 v[36:39], v3 offset:32768
    ds_read_b128 v[40:43], v3 offset:36864
    s_waitcnt lgkmcnt(4)
    v_mfma_f32_32x32x16_bf16 v[48:63], v[24:27], v[20:23], v[48:63]
    ds_read_b64_tr_b16 v[8:9], v5 offset:34816
    ds_read_b64_tr_b16 v[10:11], v5 offset:35840
    v_mfma_f32_32x32x16_bf16 v[64:79], v[28:31], v[20:23], v[64:79]
    ds_read_b128 v[12:15], v3 offset:33792
    ds_read_b128 v[16:19], v3 offset:37888
    s_waitcnt vmcnt(6)
    s_barrier
    s_waitcnt lgkmcnt(4)
    v_mfma_f32_32x32x16_bf16 v[48:63], v[36:39], v[32:35], v[48:63]
    ds_read_b64_tr_b16 v[20:21], v5 offset:36864
    ds_read_b64_tr_b16 v[22:23], v5 offset:37888
    v_mfma_f32_32x32x16_bf16 v[64:79], v[40:43], v[32:35], v[64:79]
    ds_read_b128 v[24:27], v3 offset:34816
    ds_read_b128 v[28:31], v3 offset:38912
    s_waitcnt lgkmcnt(4)
    v_mfma_f32_32x32x16_bf16 v[48:63], v[12:15], v[8:11], v[48:63]
    ds_read_b64_tr_b16 v[32:33], v5 offset:38912
    ds_read_b64_tr_b16 v[34:35], v5 offset:39936
    v_mfma_f32_32x32x16_bf16 v[64:79], v[16:19], v[8:11], v[64:79]
    ds_read_b128 v[36:39], v3 offset:35840
    ds_read_b128 v[40:43], v3 offset:39936
    s_waitcnt lgkmcnt(4)
    v_mfma_f32_32x32x16_bf16 v[48:63], v[24:27], v[20:23], v[48:63]
    ds_read_b64_tr_b16 v[8:9], v4 offset:0
    ds_read_b64_tr_b16 v[10:11], v4 offset:1024
    v_mfma_f32_32x32x16_bf16 v[64:79], v[28:31], v[20:23], v[64:79]
    ds_read_b128 v[12:15], v6 offset:0
    ds_read_b128 v[16:19], v6 offset:4096
    s_waitcnt lgkmcnt(4)
    v_mfma_f32_32x32x16_bf16 v[48:63], v[36:39], v[32:35], v[48:63]
    ds_read_b64_tr_b16 v[20:21], v4 offset:2048
    ds_read_b64_tr_b16 v[22:23], v4 offset:3072
    v_mfma_f32_32x32x16_bf16 v[64:79], v[40:43], v[32:35], v[64:79]
    ds_read_b128 v[24:27], v6 offset:1024
    ds_read_b128 v[28:31], v6 offset:5120
    s_waitcnt vmcnt(0)
    s_barrier
    s_waitcnt lgkmcnt(4)
    v_mfma_f32_32x32x16_bf16 v[48:63], v[12:15], v[8:11], v[48:63]
    ds_read_b64_tr_b16 v[32:33], v4 offset:4096
    ds_read_b64_tr_b16 v[34:35], v4 offset:5120
    v_mfma_f32_32x32x16_bf16 v[64:79], v[16:19], v[8:11], v[64:79]
    ds_read_b128 v[36:39], v6 offset:2048
    ds_read_b128 v[40:43], v6 offset:6144
    s_waitcnt lgkmcnt(4)
    v_mfma_f32_32x32x16_bf16 v[48:63], v[24:27], v[20:23], v[48:63]
    ds_read_b64_tr_b16 v[8:9], v4 offset:6144
    ds_read_b64_tr_b16 v[10:11], v4 offset:7168
    v_mfma_f32_32x32x16_bf16 v[64:79], v[28:31], v[20:23], v[64:79]
    ds_read_b128 v[12:15], v6 offset:3072
    ds_read_b128 v[16:19], v6 offset:7168
    s_waitcnt lgkmcnt(4)
    v_mfma_f32_32x32x16_bf16 v[48:63], v[36:39], v[32:35], v[48:63]
    ds_read_b64_tr_b16 v[20:21], v4 offset:24576
    ds_read_b64_tr_b16 v[22:23], v4 offset:25600
    v_mfma_f32_32x32x16_bf16 v[64:79], v[40:43], v[32:35], v[64:79]
    ds_read_b128 v[24:27], v6 offset:24576
    ds_read_b128 v[28:31], v6 offset:28672
    s_waitcnt lgkmcnt(4)
    v_mfma_f32_32x32x16_bf16 v[48:63], v[12:15], v[8:11], v[48:63]
    ds_read_b64_tr_b16 v[32:33], v4 offset:26624
    ds_read_b64_tr_b16 v[34:35], v4 offset:27648
    v_mfma_f32_32x32x16_bf16 v[64:79], v[16:19], v[8:11], v[64:79]
    ds_read_b128 v[36:39], v6 offset:25600
    ds_read_b128 v[40:43], v6 offset:29696
    s_waitcnt vmcnt(0)
    s_barrier
    s_waitcnt lgkmcnt(4)
    v_mfma_f32_32x32x16_bf16 v[48:63], v[24:27], v[20:23], v[48:63]
    ds_read_b64_tr_b16 v[8:9], v4 offset:28672
    ds_read_b64_tr_b16 v[10:11], v4 offset:29696
    v_mfma_f32_32x32x16_bf16 v[64:79], v[28:31], v[20:23], v[64:79]
    ds_read_b128 v[12:15], v6 offset:26624
    ds_read_b128 v[16:19], v6 offset:30720
    s_waitcnt lgkmcnt(4)
    v_mfma_f32_32x32x16_bf16 v[48:63], v[36:39], v[32:35], v[48:63]
    ds_read_b64_tr_b16 v[20:21], v4 offset:30720
    ds_read_b64_tr_b16 v[22:23], v4 offset:31744
    v_mfma_f32_32x32x16_bf16 v[64:79], v[40:43], v[32:35], v[64:79]
    ds_read_b128 v[24:27], v6 offset:27648
    ds_read_b128 v[28:31], v6 offset:31744
    s_waitcnt lgkmcnt(4)
    v_mfma_f32_32x32x16_bf16 v[48:63], v[12:15], v[8:11], v[48:63]
    v_mfma_f32_32x32x16_bf16 v[64:79], v[16:19], v[8:11], v[64:79]
    s_waitcnt lgkmcnt(0)
    v_mfma_f32_32x32x16_bf16 v[48:63], v[24:27], v[20:23], v[48:63]
    v_mfma_f32_32x32x16_bf16 v[64:79], v[28:31], v[20:23], v[64:79]
    s_nop 15
    v_and_b32 v20, 31, v0
    v_lshlrev_b32 v20, 2, v20
    v_lshrrev_b32 v21, 5, v0
    v_lshlrev_b32 v21, 13, v21
    v_add_u32 v20, v20, v21
    s_lshl_b32 s7, s6, 22
    s_lshl_b32 s22, s4, 18
    s_add_u32 s7, s7, s22
    s_lshr_b32 s22, s3, 1
    s_lshl_b32 s22, s22, 17
    s_add_u32 s7, s7, s22
    s_lshl_b32 s22, s5, 8
    s_add_u32 s7, s7, s22
    s_and_b32 s22, s3, 1
    s_lshl_b32 s22, s22, 7
    s_add_u32 s7, s7, s22

    s_add_u32 s22, s7, 0
    buffer_store_dword v48, v20, s[16:19], s22 offen offset:0 sc1
    buffer_store_dword v49, v20, s[16:19], s22 offen offset:2048 sc1
    s_add_u32 s22, s7, 4096
    buffer_store_dword v50, v20, s[16:19], s22 offen offset:0 sc1
    buffer_store_dword v51, v20, s[16:19], s22 offen offset:2048 sc1
    s_add_u32 s22, s7, 16384
    buffer_store_dword v52, v20, s[16:19], s22 offen offset:0 sc1
    buffer_store_dword v53, v20, s[16:19], s22 offen offset:2048 sc1
    s_add_u32 s22, s7, 20480
    buffer_store_dword v54, v20, s[16:19], s22 offen offset:0 sc1
    buffer_store_dword v55, v20, s[16:19], s22 offen offset:2048 sc1
    s_add_u32 s22, s7, 32768
    buffer_store_dword v56, v20, s[16:19], s22 offen offset:0 sc1
    buffer_store_dword v57, v20, s[16:19], s22 offen offset:2048 sc1
    s_add_u32 s22, s7, 36864
    buffer_store_dword v58, v20, s[16:19], s22 offen offset:0 sc1
    buffer_store_dword v59, v20, s[16:19], s22 offen offset:2048 sc1
    s_add_u32 s22, s7, 49152
    buffer_store_dword v60, v20, s[16:19], s22 offen offset:0 sc1
    buffer_store_dword v61, v20, s[16:19], s22 offen offset:2048 sc1
    s_add_u32 s22, s7, 53248
    buffer_store_dword v62, v20, s[16:19], s22 offen offset:0 sc1
    buffer_store_dword v63, v20, s[16:19], s22 offen offset:2048 sc1
    s_add_u32 s22, s7, 65536
    buffer_store_dword v64, v20, s[16:19], s22 offen offset:0 sc1
    buffer_store_dword v65, v20, s[16:19], s22 offen offset:2048 sc1
    s_add_u32 s22, s7, 69632
    buffer_store_dword v66, v20, s[16:19], s22 offen offset:0 sc1
    buffer_store_dword v67, v20, s[16:19], s22 offen offset:2048 sc1
    s_add_u32 s22, s7, 81920
    buffer_store_dword v68, v20, s[16:19], s22 offen offset:0 sc1
    buffer_store_dword v69, v20, s[16:19], s22 offen offset:2048 sc1
    s_add_u32 s22, s7, 86016
    buffer_store_dword v70, v20, s[16:19], s22 offen offset:0 sc1
    buffer_store_dword v71, v20, s[16:19], s22 offen offset:2048 sc1
    s_add_u32 s22, s7, 98304
    buffer_store_dword v72, v20, s[16:19], s22 offen offset:0 sc1
    buffer_store_dword v73, v20, s[16:19], s22 offen offset:2048 sc1
    s_add_u32 s22, s7, 102400
    buffer_store_dword v74, v20, s[16:19], s22 offen offset:0 sc1
    buffer_store_dword v75, v20, s[16:19], s22 offen offset:2048 sc1
    s_add_u32 s22, s7, 114688
    buffer_store_dword v76, v20, s[16:19], s22 offen offset:0 sc1
    buffer_store_dword v77, v20, s[16:19], s22 offen offset:2048 sc1
    s_add_u32 s22, s7, 118784
    buffer_store_dword v78, v20, s[16:19], s22 offen offset:0 sc1
    buffer_store_dword v79, v20, s[16:19], s22 offen offset:2048 sc1
Lk3_end:
    s_endpgm
.globl pm_kernel
.p2align 8
.type pm_kernel,@function
pm_kernel:
    s_cmp_ge_u32 s2, 184
    s_cbranch_scc1 Lk5_end
    s_load_dwordx2 s[4:5], s[0:1], 56
    s_load_dwordx2 s[6:7], s[0:1], 64
    s_load_dwordx2 s[8:9], s[0:1], 112
    s_load_dwordx2 s[10:11], s[0:1], 72
    s_load_dwordx2 s[64:65], s[0:1], 96
    s_load_dwordx2 s[66:67], s[0:1], 104
    s_load_dwordx2 s[80:81], s[0:1], 0
    s_load_dwordx2 s[82:83], s[0:1], 48
    v_and_b32 v1, 63, v0
    v_lshrrev_b32 v2, 6, v0
    s_nop 0
    v_readfirstlane_b32 s3, v2
    v_lshlrev_b32 v4, 4, v1
    s_waitcnt lgkmcnt(0)

    s_add_u32 s20, s8, 0x4810000
    s_addc_u32 s21, s9, 0
    s_mov_b32 s22, 0x2000
    s_mov_b32 s23, 0x00020000
    s_add_u32 s24, s8, 0x4400000
    s_addc_u32 s25, s9, 0
    s_mov_b32 s26, 0x200000
    s_mov_b32 s27, 0x00020000
    s_add_u32 s32, s8, 0x4000000
    s_addc_u32 s33, s9, 0
    s_mov_b32 s34, 0x200000
    s_mov_b32 s35, 0x00020000
    s_add_u32 s60, s8, 0x4800000
    s_addc_u32 s61, s9, 0
    s_mov_b32 s62, 0x2000
    s_mov_b32 s63, 0x00020000
    s_mov_b32 s68, s64
    s_mov_b32 s69, s65
    s_mov_b32 s70, 0x200000
    s_mov_b32 s71, 0x00020000
    s_mov_b32 s72, s66
    s_mov_b32 s73, s67
    s_mov_b32 s74, 0x100
    s_mov_b32 s75, 0x00020000
    s_mov_b32 s76, s8
    s_mov_b32 s77, s9
    s_mov_b32 s78, 0x3000
    s_mov_b32 s79, 0x00020000
    s_cmp_lt_u32 s2, 56
    s_cbranch_scc1 Lk5_moe

    s_mov_b32 s12, s80
    s_mov_b32 s13, s81
    s_mov_b32 s14, 0x200000
    s_mov_b32 s15, 0x00020000
    s_add_u32 s16, s8, 0x2000000
    s_addc_u32 s17, s9, 0
    s_mov_b32 s18, 0x800000
    s_mov_b32 s19, 0x00020000
    s_mov_b32 s28, s82
    s_mov_b32 s29, s83
    s_mov_b32 s30, 0x400
    s_mov_b32 s31, 0x00020000
    s_sub_u32 s36, s2, 56
    s_lshl_b32 s36, s36, 4
    s_add_u32 s36, s36, s3
    s_mul_i32 s36, s36, 1
    s_lshl_b32 s37, s36, 10
    s_lshl_b32 s38, s36, 11
    v_lshlrev_b32 v5, 5, v1

    s_add_u32 s39, s38, 0
    buffer_load_dwordx4 v[64:67], v5, s[16:19], s39 offen
    buffer_load_dwordx4 v[68:71], v5, s[16:19], s39 offen offset:16
    s_add_u32 s39, s39, 0x400000
    buffer_load_dwordx4 v[72:75], v5, s[16:19], s39 offen
    buffer_load_dwordx4 v[76:79], v5, s[16:19], s39 offen offset:16
    buffer_load_dwordx4 v[8:11], v4, s[12:15], s37 offen
    buffer_load_dwordx4 v[96:99], v4, s[28:31], 0 offen
    s_mov_b32 s39, 4096
    buffer_load_dwordx4 v[100:103], v5, s[76:79], s39 offen
    buffer_load_dwordx4 v[104:107], v5, s[76:79], s39 offen offset:16
    buffer_load_dwordx4 v[16:19], v5, s[76:79], s39 offen offset:2048
    buffer_load_dwordx4 v[20:23], v5, s[76:79], s39 offen offset:2064
    s_mov_b32 s39, 8192
    buffer_load_dwordx4 v[24:27], v5, s[76:79], s39 offen
    buffer_load_dwordx4 v[28:31], v5, s[76:79], s39 offen offset:16
    buffer_load_dwordx4 v[108:111], v5, s[76:79], s39 offen offset:2048
    buffer_load_dwordx4 v[112:115], v5, s[76:79], s39 offen offset:2064
    s_waitcnt vmcnt(0)

    v_lshlrev_b32 v116, 16, v96
    v_and_b32 v117, 0xffff0000, v96
    v_lshlrev_b32 v118, 16, v97
    v_and_b32 v119, 0xffff0000, v97
    v_lshlrev_b32 v120, 16, v98
    v_and_b32 v121, 0xffff0000, v98
    v_lshlrev_b32 v122, 16, v99
    v_and_b32 v123, 0xffff0000, v99
    v_lshlrev_b32 v32, 16, v8
    v_and_b32 v33, 0xffff0000, v8
    v_lshlrev_b32 v34, 16, v9
    v_and_b32 v35, 0xffff0000, v9
    v_lshlrev_b32 v36, 16, v10
    v_and_b32 v37, 0xffff0000, v10
    v_lshlrev_b32 v38, 16, v11
    v_and_b32 v39, 0xffff0000, v11
    v_add_f32 v64, v64, v72
    v_cvt_pk_bf16_f32 v64, 0, v64
    v_mul_f32 v64, v64, v100
    v_cvt_pk_bf16_f32 v64, 0, v64
    v_add_f32 v32, v32, v64
    v_cvt_pk_bf16_f32 v32, 0, v32
    v_add_f32 v65, v65, v73
    v_cvt_pk_bf16_f32 v65, 0, v65
    v_mul_f32 v65, v65, v101
    v_cvt_pk_bf16_f32 v65, 0, v65
    v_add_f32 v33, v33, v65
    v_cvt_pk_bf16_f32 v33, 0, v33
    v_add_f32 v66, v66, v74
    v_cvt_pk_bf16_f32 v66, 0, v66
    v_mul_f32 v66, v66, v102
    v_cvt_pk_bf16_f32 v66, 0, v66
    v_add_f32 v34, v34, v66
    v_cvt_pk_bf16_f32 v34, 0, v34
    v_add_f32 v67, v67, v75
    v_cvt_pk_bf16_f32 v67, 0, v67
    v_mul_f32 v67, v67, v103
    v_cvt_pk_bf16_f32 v67, 0, v67
    v_add_f32 v35, v35, v67
    v_cvt_pk_bf16_f32 v35, 0, v35
    v_add_f32 v68, v68, v76
    v_cvt_pk_bf16_f32 v68, 0, v68
    v_mul_f32 v68, v68, v104
    v_cvt_pk_bf16_f32 v68, 0, v68
    v_add_f32 v36, v36, v68
    v_cvt_pk_bf16_f32 v36, 0, v36
    v_add_f32 v69, v69, v77
    v_cvt_pk_bf16_f32 v69, 0, v69
    v_mul_f32 v69, v69, v105
    v_cvt_pk_bf16_f32 v69, 0, v69
    v_add_f32 v37, v37, v69
    v_cvt_pk_bf16_f32 v37, 0, v37
    v_add_f32 v70, v70, v78
    v_cvt_pk_bf16_f32 v70, 0, v70
    v_mul_f32 v70, v70, v106
    v_cvt_pk_bf16_f32 v70, 0, v70
    v_add_f32 v38, v38, v70
    v_cvt_pk_bf16_f32 v38, 0, v38
    v_add_f32 v71, v71, v79
    v_cvt_pk_bf16_f32 v71, 0, v71
    v_mul_f32 v71, v71, v107
    v_cvt_pk_bf16_f32 v71, 0, v71
    v_add_f32 v39, v39, v71
    v_cvt_pk_bf16_f32 v39, 0, v39
    v_add_f32 v12, v32, v33
    v_add_f32 v12, v12, v34
    v_add_f32 v12, v12, v35
    v_add_f32 v12, v12, v36
    v_add_f32 v12, v12, v37
    v_add_f32 v12, v12, v38
    v_add_f32 v12, v12, v39
    s_nop 1
    v_add_f32_dpp v12, v12, v12 quad_perm:[1,0,3,2] row_mask:0xf bank_mask:0xf
    s_nop 1
    v_add_f32_dpp v12, v12, v12 quad_perm:[2,3,0,1] row_mask:0xf bank_mask:0xf
    s_nop 1
    v_add_f32_dpp v12, v12, v12 row_half_mirror row_mask:0xf bank_mask:0xf
    s_nop 1
    v_add_f32_dpp v12, v12, v12 row_mirror row_mask:0xf bank_mask:0xf
    v_mov_b32 v13, v12
    v_mov_b32 v14, v12
    s_nop 1
    v_permlane16_swap_b32 v13, v14
    s_nop 1
    v_add_f32 v12, v13, v14
    v_mov_b32 v13, v12
    v_mov_b32 v14, v12
    s_nop 1
    v_permlane32_swap_b32 v13, v14
    s_nop 1
    v_add_f32 v12, v13, v14
    v_mul_f32 v12, 0x3b000000, v12
    v_sub_f32 v13, v32, v12
    v_mul_f32 v15, v13, v13
    v_sub_f32 v13, v33, v12
    v_fmac_f32 v15, v13, v13
    v_sub_f32 v13, v34, v12
    v_fmac_f32 v15, v13, v13
    v_sub_f32 v13, v35, v12
    v_fmac_f32 v15, v13, v13
    v_sub_f32 v13, v36, v12
    v_fmac_f32 v15, v13, v13
    v_sub_f32 v13, v37, v12
    v_fmac_f32 v15, v13, v13
    v_sub_f32 v13, v38, v12
    v_fmac_f32 v15, v13, v13
    v_sub_f32 v13, v39, v12
    v_fmac_f32 v15, v13, v13
    s_nop 1
    v_add_f32_dpp v15, v15, v15 quad_perm:[1,0,3,2] row_mask:0xf bank_mask:0xf
    s_nop 1
    v_add_f32_dpp v15, v15, v15 quad_perm:[2,3,0,1] row_mask:0xf bank_mask:0xf
    s_nop 1
    v_add_f32_dpp v15, v15, v15 row_half_mirror row_mask:0xf bank_mask:0xf
    s_nop 1
    v_add_f32_dpp v15, v15, v15 row_mirror row_mask:0xf bank_mask:0xf
    v_mov_b32 v13, v15
    v_mov_b32 v14, v15
    s_nop 1
    v_permlane16_swap_b32 v13, v14
    s_nop 1
    v_add_f32 v15, v13, v14
    v_mov_b32 v13, v15
    v_mov_b32 v14, v15
    s_nop 1
    v_permlane32_swap_b32 v13, v14
    s_nop 1
    v_add_f32 v15, v13, v14
    v_mul_f32 v15, 0x3b000000, v15
    v_cvt_pk_bf16_f32 v12, 0, v12
    v_cvt_pk_bf16_f32 v15, 0, v15
    v_add_f32 v15, 0x3727c5ac, v15
    v_cvt_pk_bf16_f32 v15, 0, v15
    v_sqrt_f32 v15, v15
    s_nop 0
    v_cvt_pk_bf16_f32 v15, 0, v15
    v_rcp_f32 v15, v15
    s_nop 0
    v_sub_f32 v40, v32, v12
    v_cvt_pk_bf16_f32 v40, 0, v40
    v_mul_f32 v40, v40, v15
    v_cvt_pk_bf16_f32 v40, 0, v40
    v_add_f32 v13, 1.0, v24
    v_cvt_pk_bf16_f32 v13, 0, v13
    v_mul_f32 v40, v40, v13
    v_cvt_pk_bf16_f32 v40, 0, v40
    v_add_f32 v40, v40, v16
    v_cvt_pk_bf16_f32 v40, 0, v40
    v_sub_f32 v41, v33, v12
    v_cvt_pk_bf16_f32 v41, 0, v41
    v_mul_f32 v41, v41, v15
    v_cvt_pk_bf16_f32 v41, 0, v41
    v_add_f32 v13, 1.0, v25
    v_cvt_pk_bf16_f32 v13, 0, v13
    v_mul_f32 v41, v41, v13
    v_cvt_pk_bf16_f32 v41, 0, v41
    v_add_f32 v41, v41, v17
    v_cvt_pk_bf16_f32 v41, 0, v41
    v_sub_f32 v42, v34, v12
    v_cvt_pk_bf16_f32 v42, 0, v42
    v_mul_f32 v42, v42, v15
    v_cvt_pk_bf16_f32 v42, 0, v42
    v_add_f32 v13, 1.0, v26
    v_cvt_pk_bf16_f32 v13, 0, v13
    v_mul_f32 v42, v42, v13
    v_cvt_pk_bf16_f32 v42, 0, v42
    v_add_f32 v42, v42, v18
    v_cvt_pk_bf16_f32 v42, 0, v42
    v_sub_f32 v43, v35, v12
    v_cvt_pk_bf16_f32 v43, 0, v43
    v_mul_f32 v43, v43, v15
    v_cvt_pk_bf16_f32 v43, 0, v43
    v_add_f32 v13, 1.0, v27
    v_cvt_pk_bf16_f32 v13, 0, v13
    v_mul_f32 v43, v43, v13
    v_cvt_pk_bf16_f32 v43, 0, v43
    v_add_f32 v43, v43, v19
    v_cvt_pk_bf16_f32 v43, 0, v43
    v_sub_f32 v44, v36, v12
    v_cvt_pk_bf16_f32 v44, 0, v44
    v_mul_f32 v44, v44, v15
    v_cvt_pk_bf16_f32 v44, 0, v44
    v_add_f32 v13, 1.0, v28
    v_cvt_pk_bf16_f32 v13, 0, v13
    v_mul_f32 v44, v44, v13
    v_cvt_pk_bf16_f32 v44, 0, v44
    v_add_f32 v44, v44, v20
    v_cvt_pk_bf16_f32 v44, 0, v44
    v_sub_f32 v45, v37, v12
    v_cvt_pk_bf16_f32 v45, 0, v45
    v_mul_f32 v45, v45, v15
    v_cvt_pk_bf16_f32 v45, 0, v45
    v_add_f32 v13, 1.0, v29
    v_cvt_pk_bf16_f32 v13, 0, v13
    v_mul_f32 v45, v45, v13
    v_cvt_pk_bf16_f32 v45, 0, v45
    v_add_f32 v45, v45, v21
    v_cvt_pk_bf16_f32 v45, 0, v45
    v_sub_f32 v46, v38, v12
    v_cvt_pk_bf16_f32 v46, 0, v46
    v_mul_f32 v46, v46, v15
    v_cvt_pk_bf16_f32 v46, 0, v46
    v_add_f32 v13, 1.0, v30
    v_cvt_pk_bf16_f32 v13, 0, v13
    v_mul_f32 v46, v46, v13
    v_cvt_pk_bf16_f32 v46, 0, v46
    v_add_f32 v46, v46, v22
    v_cvt_pk_bf16_f32 v46, 0, v46
    v_sub_f32 v47, v39, v12
    v_cvt_pk_bf16_f32 v47, 0, v47
    v_mul_f32 v47, v47, v15
    v_cvt_pk_bf16_f32 v47, 0, v47
    v_add_f32 v13, 1.0, v31
    v_cvt_pk_bf16_f32 v13, 0, v13
    v_mul_f32 v47, v47, v13
    v_cvt_pk_bf16_f32 v47, 0, v47
    v_add_f32 v47, v47, v23
    v_cvt_pk_bf16_f32 v47, 0, v47
    v_mul_f32 v56, v40, v116
    v_fmac_f32 v56, v41, v117
    v_fmac_f32 v56, v42, v118
    v_fmac_f32 v56, v43, v119
    v_fmac_f32 v56, v44, v120
    v_fmac_f32 v56, v45, v121
    v_fmac_f32 v56, v46, v122
    v_fmac_f32 v56, v47, v123
    s_nop 1
    v_add_f32_dpp v56, v56, v56 quad_perm:[1,0,3,2] row_mask:0xf bank_mask:0xf
    s_nop 1
    v_add_f32_dpp v56, v56, v56 quad_perm:[2,3,0,1] row_mask:0xf bank_mask:0xf
    s_nop 1
    v_add_f32_dpp v56, v56, v56 row_half_mirror row_mask:0xf bank_mask:0xf
    s_nop 1
    v_add_f32_dpp v56, v56, v56 row_mirror row_mask:0xf bank_mask:0xf
    v_mov_b32 v57, v56
    v_mov_b32 v58, v56
    s_nop 1
    v_permlane16_swap_b32 v57, v58
    s_nop 1
    v_add_f32 v56, v57, v58
    v_mov_b32 v57, v56
    v_mov_b32 v58, v56
    s_nop 1
    v_permlane32_swap_b32 v57, v58
    s_nop 1
    v_add_f32 v56, v57, v58
    v_cvt_pk_bf16_f32 v56, 0, v56
    v_cvt_pk_bf16_f32 v48, v40, v41
    v_cvt_pk_bf16_f32 v52, v32, v33
    v_cvt_pk_bf16_f32 v49, v42, v43
    v_cvt_pk_bf16_f32 v53, v34, v35
    v_cvt_pk_bf16_f32 v50, v44, v45
    v_cvt_pk_bf16_f32 v54, v36, v37
    v_cvt_pk_bf16_f32 v51, v46, v47
    v_cvt_pk_bf16_f32 v55, v38, v39
    buffer_store_dwordx4 v[48:51], v4, s[24:27], s37 offen offset:0 sc1
    buffer_store_dwordx4 v[52:55], v4, s[32:35], s37 offen offset:0 sc1
    v_mul_f32 v64, v40, v108
    v_cvt_pk_bf16_f32 v64, 0, v64
    v_add_f32 v64, v64, v32
    v_mul_f32 v65, v41, v109
    v_cvt_pk_bf16_f32 v65, 0, v65
    v_add_f32 v65, v65, v33
    v_mul_f32 v66, v42, v110
    v_cvt_pk_bf16_f32 v66, 0, v66
    v_add_f32 v66, v66, v34
    v_mul_f32 v67, v43, v111
    v_cvt_pk_bf16_f32 v67, 0, v67
    v_add_f32 v67, v67, v35
    v_mul_f32 v68, v44, v112
    v_cvt_pk_bf16_f32 v68, 0, v68
    v_add_f32 v68, v68, v36
    v_mul_f32 v69, v45, v113
    v_cvt_pk_bf16_f32 v69, 0, v69
    v_add_f32 v69, v69, v37
    v_mul_f32 v70, v46, v114
    v_cvt_pk_bf16_f32 v70, 0, v70
    v_add_f32 v70, v70, v38
    v_mul_f32 v71, v47, v115
    v_cvt_pk_bf16_f32 v71, 0, v71
    v_add_f32 v71, v71, v39
    v_cvt_pk_bf16_f32 v60, v64, v65
    v_cvt_pk_bf16_f32 v61, v66, v67
    v_cvt_pk_bf16_f32 v62, v68, v69
    v_cvt_pk_bf16_f32 v63, v70, v71
    buffer_store_dwordx4 v[60:63], v4, s[68:71], s37 offen offset:0 sc1
    v_ashrrev_i32 v57, 31, v56
    v_or_b32 v57, 0x80000000, v57
    v_xor_b32 v57, v57, v56
    v_and_b32 v57, 0xffff0000, v57
    s_add_u32 s39, s36, 0
    s_sub_u32 s40, 2047, s39
    v_or_b32 v57, s40, v57
    s_lshl_b32 s39, s39, 2
    v_mov_b32 v58, 0
    s_mov_b64 exec, 1
    buffer_store_dword v56, v58, s[60:63], s39 offen sc1
    buffer_store_dword v57, v58, s[20:23], s39 offen sc1
    s_mov_b64 exec, -1

    s_waitcnt vmcnt(0)
    s_barrier
    s_cmp_lg_u32 s3, 0
    s_cbranch_scc1 Lk5_end
    v_mov_b32 v44, 1
    v_mov_b32 v45, 64
    s_mov_b64 exec, 1
    buffer_atomic_add v44, v45, s[72:75], 0 offen sc0 sc1
    s_waitcnt vmcnt(0)
    v_readfirstlane_b32 s36, v44
    s_nop 3
    s_cmp_lg_u32 s36, 127
    s_cbranch_scc1 Lk5_end
    v_mov_b32 v44, 128
    v_mov_b32 v45, 128
    buffer_store_dword v44, v45, s[72:75], 0 offen sc0 sc1
    s_branch Lk5_end

Lk5_moe:
    s_cmp_ge_u32 s3, 8
    s_cbranch_scc1 Lk5_end
    v_lshrrev_b32 v3, 2, v1
    s_mov_b32 s36, 3584
    v_mul_lo_u32 v3, v3, s36
    v_and_b32 v44, 3, v1
    v_lshlrev_b32 v44, 4, v44
    v_add_u32 v3, v3, v44
    s_lshr_b32 s36, s3, 2
    s_cmp_eq_u32 s36, 0
    s_cselect_b32 s12, s4, s6
    s_cselect_b32 s13, s5, s7
    s_mov_b32 s14, 0x1c0000
    s_mov_b32 s15, 0x00020000

    s_mov_b32 s16, s10
    s_mov_b32 s17, s11
    s_mov_b32 s18, 0x1c0000
    s_mov_b32 s19, 0x00020000
    s_add_u32 s28, s8, 0x4910000
    s_addc_u32 s29, s9, 0
    s_mov_b32 s30, 0x4000
    s_mov_b32 s31, 0x00020000
    s_and_b32 s36, s3, 3
    s_mul_i32 s37, s36, 458752
    s_lshl_b32 s38, s2, 6
    s_add_u32 s37, s37, s38
    s_lshl_b32 s38, s3, 13

    s_add_u32 m0, s38, 0
    s_nop 0
    buffer_load_dwordx4 v3, s[12:15], s37 offen lds
    s_add_u32 s37, s37, 57344
    s_add_u32 m0, s38, 1024
    s_nop 0
    buffer_load_dwordx4 v3, s[12:15], s37 offen lds
    s_add_u32 s37, s37, 57344
    s_add_u32 m0, s38, 2048
    s_nop 0
    buffer_load_dwordx4 v3, s[12:15], s37 offen lds
    s_add_u32 s37, s37, 57344
    s_add_u32 m0, s38, 3072
    s_nop 0
    buffer_load_dwordx4 v3, s[12:15], s37 offen lds
    s_add_u32 s37, s37, 57344
    s_add_u32 m0, s38, 4096
    s_nop 0
    buffer_load_dwordx4 v3, s[12:15], s37 offen lds
    s_add_u32 s37, s37, 57344
    s_add_u32 m0, s38, 5120
    s_nop 0
    buffer_load_dwordx4 v3, s[12:15], s37 offen lds
    s_add_u32 s37, s37, 57344
    s_add_u32 m0, s38, 6144
    s_nop 0
    buffer_load_dwordx4 v3, s[12:15], s37 offen lds
    s_add_u32 s37, s37, 57344
    s_add_u32 m0, s38, 7168
    s_nop 0
    buffer_load_dwordx4 v3, s[12:15], s37 offen lds
    s_lshl_b32 s37, s2, 15
    s_lshl_b32 s39, s3, 12
    s_add_u32 s37, s37, s39

    v_xor_b32 v44, 0, v4
    s_add_u32 m0, s39, 65536
    s_nop 0
    buffer_load_dwordx4 v44, s[16:19], s37 offen lds
    s_add_u32 s37, s37, 1024
    v_xor_b32 v44, 64, v4
    s_add_u32 m0, s39, 66560
    s_nop 0
    buffer_load_dwordx4 v44, s[16:19], s37 offen lds
    s_add_u32 s37, s37, 1024
    v_xor_b32 v44, 128, v4
    s_add_u32 m0, s39, 67584
    s_nop 0
    buffer_load_dwordx4 v44, s[16:19], s37 offen lds
    s_add_u32 s37, s37, 1024
    v_xor_b32 v44, 192, v4
    s_add_u32 m0, s39, 68608
    s_nop 0
    buffer_load_dwordx4 v44, s[16:19], s37 offen lds
    v_lshrrev_b32 v6, 5, v1
    v_lshlrev_b32 v6, 3, v6
    v_and_b32 v7, 15, v1
    v_lshrrev_b32 v7, 2, v7
    v_add_u32 v6, v6, v7
    v_lshlrev_b32 v5, 6, v6
    v_lshrrev_b32 v6, 4, v1
    v_and_b32 v6, 1, v6
    v_lshlrev_b32 v6, 5, v6
    v_add_u32 v5, v5, v6
    v_and_b32 v6, 3, v1
    v_lshlrev_b32 v6, 3, v6
    v_add_u32 v5, v5, v6

    v_add_u32 v5, s38, v5
    v_and_b32 v6, 7, v1
    v_lshrrev_b32 v47, 5, v1
    v_and_b32 v48, 15, v1
    v_lshrrev_b32 v48, 2, v48
    v_lshlrev_b32 v49, 3, v47
    v_add_u32 v49, v49, v48
    v_lshlrev_b32 v49, 10, v49
    v_lshrrev_b32 v50, 4, v1
    v_and_b32 v50, 1, v50
    v_lshlrev_b32 v50, 5, v50
    v_add_u32 v49, v49, v50
    v_and_b32 v50, 3, v1
    v_lshlrev_b32 v50, 3, v50
    v_add_u32 v49, v49, v50
    s_lshr_b32 s37, s3, 1
    s_lshl_b32 s37, s37, 8
    s_add_u32 s37, s37, 65536
    v_add_u32 v49, s37, v49
    s_and_b32 s37, s3, 1
    s_lshl_b32 s37, s37, 1
    v_xor_b32 v50, s37, v48
    v_lshlrev_b32 v50, 6, v50
    v_add_u32 v51, v49, v50
    s_add_u32 s37, s37, 1
    v_xor_b32 v50, s37, v48
    v_lshlrev_b32 v50, 6, v50
    v_add_u32 v52, v49, v50
    v_lshlrev_b32 v53, 6, v6
    v_lshlrev_b32 v50, 4, v47
    v_add_u32 v53, v53, v50
    v_add_u32 v53, 106496, v53
    v_and_b32 v54, 31, v1
    v_lshlrev_b32 v54, 2, v54
    v_lshlrev_b32 v50, 13, v47
    v_add_u32 v54, v54, v50
    v_lshlrev_b32 v55, 5, v1
    s_mov_b32 s37, 10240
    buffer_load_dwordx4 v[56:59], v55, s[76:79], s37 offen
    buffer_load_dwordx4 v[60:63], v55, s[76:79], s37 offen offset:16
    v_mov_b32 v45, 128

    s_cmp_lg_u32 s3, 0
    s_cbranch_scc1 Lk5_go2

Lk5_poll:
    buffer_load_dword v44, v45, s[72:75], 0 offen sc0 sc1
    s_waitcnt vmcnt(0)
    v_readfirstlane_b32 s37, v44
    s_nop 3
    s_cmp_ge_u32 s37, 128
    s_cbranch_scc1 Lk5_go
    s_sleep 3
    s_branch Lk5_poll

Lk5_go:
    v_lshlrev_b32 v40, 7, v1
    buffer_load_dwordx4 v[8:11], v40, s[20:23], 0 offen offset:0 sc1
    buffer_load_dwordx4 v[12:15], v40, s[20:23], 0 offen offset:16 sc1
    buffer_load_dwordx4 v[16:19], v40, s[20:23], 0 offen offset:32 sc1
    buffer_load_dwordx4 v[20:23], v40, s[20:23], 0 offen offset:48 sc1
    buffer_load_dwordx4 v[24:27], v40, s[20:23], 0 offen offset:64 sc1
    buffer_load_dwordx4 v[28:31], v40, s[20:23], 0 offen offset:80 sc1
    buffer_load_dwordx4 v[32:35], v40, s[20:23], 0 offen offset:96 sc1
    buffer_load_dwordx4 v[36:39], v40, s[20:23], 0 offen offset:112 sc1
    s_waitcnt vmcnt(0)
    v_max3_u32 v40, v8, v9, v10
    v_max3_u32 v40, v40, v11, v12
    v_max3_u32 v40, v40, v13, v14
    v_max3_u32 v40, v40, v15, v16
    v_max3_u32 v40, v40, v17, v18
    v_max3_u32 v40, v40, v19, v20
    v_max3_u32 v40, v40, v21, v22
    v_max3_u32 v40, v40, v23, v24
    v_max3_u32 v40, v40, v25, v26
    v_max3_u32 v40, v40, v27, v28
    v_max3_u32 v40, v40, v29, v30
    v_max3_u32 v40, v40, v31, v32
    v_max3_u32 v40, v40, v33, v34
    v_max3_u32 v40, v40, v35, v36
    v_max3_u32 v40, v40, v37, v38
    v_max_u32 v40, v40, v39
    s_nop 1
    v_max_u32_dpp v40, v40, v40 quad_perm:[1,0,3,2] row_mask:0xf bank_mask:0xf
    s_nop 1
    v_max_u32_dpp v40, v40, v40 quad_perm:[2,3,0,1] row_mask:0xf bank_mask:0xf
    s_nop 1
    v_max_u32_dpp v40, v40, v40 row_half_mirror row_mask:0xf bank_mask:0xf
    s_nop 1
    v_max_u32_dpp v40, v40, v40 row_mirror row_mask:0xf bank_mask:0xf
    v_mov_b32 v41, v40
    v_mov_b32 v42, v40
    s_nop 1
    v_permlane16_swap_b32 v41, v42
    s_nop 1
    v_max_u32 v40, v41, v42
    v_mov_b32 v41, v40
    v_mov_b32 v42, v40
    s_nop 1
    v_permlane32_swap_b32 v41, v42
    s_nop 1
    v_max_u32 v40, v41, v42
    s_nop 0
    v_readfirstlane_b32 s48, v40
    s_sub_u32 s41, s48, 1
    v_sub_u32 v40, s41, v8
    v_sub_u32 v41, s41, v9
    v_sub_u32 v42, s41, v10
    v_min3_u32 v40, v40, v41, v42
    v_sub_u32 v41, s41, v11
    v_sub_u32 v42, s41, v12
    v_min3_u32 v40, v40, v41, v42
    v_sub_u32 v41, s41, v13
    v_sub_u32 v42, s41, v14
    v_min3_u32 v40, v40, v41, v42
    v_sub_u32 v41, s41, v15
    v_sub_u32 v42, s41, v16
    v_min3_u32 v40, v40, v41, v42
    v_sub_u32 v41, s41, v17
    v_sub_u32 v42, s41, v18
    v_min3_u32 v40, v40, v41, v42
    v_sub_u32 v41, s41, v19
    v_sub_u32 v42, s41, v20
    v_min3_u32 v40, v40, v41, v42
    v_sub_u32 v41, s41, v21
    v_sub_u32 v42, s41, v22
    v_min3_u32 v40, v40, v41, v42
    v_sub_u32 v41, s41, v23
    v_sub_u32 v42, s41, v24
    v_min3_u32 v40, v40, v41, v42
    v_sub_u32 v41, s41, v25
    v_sub_u32 v42, s41, v26
    v_min3_u32 v40, v40, v41, v42
    v_sub_u32 v41, s41, v27
    v_sub_u32 v42, s41, v28
    v_min3_u32 v40, v40, v41, v42
    v_sub_u32 v41, s41, v29
    v_sub_u32 v42, s41, v30
    v_min3_u32 v40, v40, v41, v42
    v_sub_u32 v41, s41, v31
    v_sub_u32 v42, s41, v32
    v_min3_u32 v40, v40, v41, v42
    v_sub_u32 v41, s41, v33
    v_sub_u32 v42, s41, v34
    v_min3_u32 v40, v40, v41, v42
    v_sub_u32 v41, s41, v35
    v_sub_u32 v42, s41, v36
    v_min3_u32 v40, v40, v41, v42
    v_sub_u32 v41, s41, v37
    v_sub_u32 v42, s41, v38
    v_min3_u32 v40, v40, v41, v42
    v_sub_u32 v41, s41, v39
    v_min_u32 v40, v40, v41
    s_nop 1
    v_min_u32_dpp v40, v40, v40 quad_perm:[1,0,3,2] row_mask:0xf bank_mask:0xf
    s_nop 1
    v_min_u32_dpp v40, v40, v40 quad_perm:[2,3,0,1] row_mask:0xf bank_mask:0xf
    s_nop 1
    v_min_u32_dpp v40, v40, v40 row_half_mirror row_mask:0xf bank_mask:0xf
    s_nop 1
    v_min_u32_dpp v40, v40, v40 row_mirror row_mask:0xf bank_mask:0xf
    v_mov_b32 v41, v40
    v_mov_b32 v42, v40
    s_nop 1
    v_permlane16_swap_b32 v41, v42
    s_nop 1
    v_min_u32 v40, v41, v42
    v_mov_b32 v41, v40
    v_mov_b32 v42, v40
    s_nop 1
    v_permlane32_swap_b32 v41, v42
    s_nop 1
    v_min_u32 v40, v41, v42
    s_nop 0
    v_readfirstlane_b32 s49, v40
    s_nop 3
    s_sub_u32 s49, s41, s49
    s_sub_u32 s42, s49, 1
    v_sub_u32 v40, s42, v8
    v_sub_u32 v41, s42, v9
    v_sub_u32 v42, s42, v10
    v_min3_u32 v40, v40, v41, v42
    v_sub_u32 v41, s42, v11
    v_sub_u32 v42, s42, v12
    v_min3_u32 v40, v40, v41, v42
    v_sub_u32 v41, s42, v13
    v_sub_u32 v42, s42, v14
    v_min3_u32 v40, v40, v41, v42
    v_sub_u32 v41, s42, v15
    v_sub_u32 v42, s42, v16
    v_min3_u32 v40, v40, v41, v42
    v_sub_u32 v41, s42, v17
    v_sub_u32 v42, s42, v18
    v_min3_u32 v40, v40, v41, v42
    v_sub_u32 v41, s42, v19
    v_sub_u32 v42, s42, v20
    v_min3_u32 v40, v40, v41, v42
    v_sub_u32 v41, s42, v21
    v_sub_u32 v42, s42, v22
    v_min3_u32 v40, v40, v41, v42
    v_sub_u32 v41, s42, v23
    v_sub_u32 v42, s42, v24
    v_min3_u32 v40, v40, v41, v42
    v_sub_u32 v41, s42, v25
    v_sub_u32 v42, s42, v26
    v_min3_u32 v40, v40, v41, v42
    v_sub_u32 v41, s42, v27
    v_sub_u32 v42, s42, v28
    v_min3_u32 v40, v40, v41, v42
    v_sub_u32 v41, s42, v29
    v_sub_u32 v42, s42, v30
    v_min3_u32 v40, v40, v41, v42
    v_sub_u32 v41, s42, v31
    v_sub_u32 v42, s42, v32
    v_min3_u32 v40, v40, v41, v42
    v_sub_u32 v41, s42, v33
    v_sub_u32 v42, s42, v34
    v_min3_u32 v40, v40, v41, v42
    v_sub_u32 v41, s42, v35
    v_sub_u32 v42, s42, v36
    v_min3_u32 v40, v40, v41, v42
    v_sub_u32 v41, s42, v37
    v_sub_u32 v42, s42, v38
    v_min3_u32 v40, v40, v41, v42
    v_sub_u32 v41, s42, v39
    v_min_u32 v40, v40, v41
    s_nop 1
    v_min_u32_dpp v40, v40, v40 quad_perm:[1,0,3,2] row_mask:0xf bank_mask:0xf
    s_nop 1
    v_min_u32_dpp v40, v40, v40 quad_perm:[2,3,0,1] row_mask:0xf bank_mask:0xf
    s_nop 1
    v_min_u32_dpp v40, v40, v40 row_half_mirror row_mask:0xf bank_mask:0xf
    s_nop 1
    v_min_u32_dpp v40, v40, v40 row_mirror row_mask:0xf bank_mask:0xf
    v_mov_b32 v41, v40
    v_mov_b32 v42, v40
    s_nop 1
    v_permlane16_swap_b32 v41, v42
    s_nop 1
    v_min_u32 v40, v41, v42
    v_mov_b32 v41, v40
    v_mov_b32 v42, v40
    s_nop 1
    v_permlane32_swap_b32 v41, v42
    s_nop 1
    v_min_u32 v40, v41, v42
    s_nop 0
    v_readfirstlane_b32 s50, v40
    s_nop 3
    s_sub_u32 s50, s42, s50
    s_sub_u32 s43, s50, 1
    v_sub_u32 v40, s43, v8
    v_sub_u32 v41, s43, v9
    v_sub_u32 v42, s43, v10
    v_min3_u32 v40, v40, v41, v42
    v_sub_u32 v41, s43, v11
    v_sub_u32 v42, s43, v12
    v_min3_u32 v40, v40, v41, v42
    v_sub_u32 v41, s43, v13
    v_sub_u32 v42, s43, v14
    v_min3_u32 v40, v40, v41, v42
    v_sub_u32 v41, s43, v15
    v_sub_u32 v42, s43, v16
    v_min3_u32 v40, v40, v41, v42
    v_sub_u32 v41, s43, v17
    v_sub_u32 v42, s43, v18
    v_min3_u32 v40, v40, v41, v42
    v_sub_u32 v41, s43, v19
    v_sub_u32 v42, s43, v20
    v_min3_u32 v40, v40, v41, v42
    v_sub_u32 v41, s43, v21
    v_sub_u32 v42, s43, v22
    v_min3_u32 v40, v40, v41, v42
    v_sub_u32 v41, s43, v23
    v_sub_u32 v42, s43, v24
    v_min3_u32 v40, v40, v41, v42
    v_sub_u32 v41, s43, v25
    v_sub_u32 v42, s43, v26
    v_min3_u32 v40, v40, v41, v42
    v_sub_u32 v41, s43, v27
    v_sub_u32 v42, s43, v28
    v_min3_u32 v40, v40, v41, v42
    v_sub_u32 v41, s43, v29
    v_sub_u32 v42, s43, v30
    v_min3_u32 v40, v40, v41, v42
    v_sub_u32 v41, s43, v31
    v_sub_u32 v42, s43, v32
    v_min3_u32 v40, v40, v41, v42
    v_sub_u32 v41, s43, v33
    v_sub_u32 v42, s43, v34
    v_min3_u32 v40, v40, v41, v42
    v_sub_u32 v41, s43, v35
    v_sub_u32 v42, s43, v36
    v_min3_u32 v40, v40, v41, v42
    v_sub_u32 v41, s43, v37
    v_sub_u32 v42, s43, v38
    v_min3_u32 v40, v40, v41, v42
    v_sub_u32 v41, s43, v39
    v_min_u32 v40, v40, v41
    s_nop 1
    v_min_u32_dpp v40, v40, v40 quad_perm:[1,0,3,2] row_mask:0xf bank_mask:0xf
    s_nop 1
    v_min_u32_dpp v40, v40, v40 quad_perm:[2,3,0,1] row_mask:0xf bank_mask:0xf
    s_nop 1
    v_min_u32_dpp v40, v40, v40 row_half_mirror row_mask:0xf bank_mask:0xf
    s_nop 1
    v_min_u32_dpp v40, v40, v40 row_mirror row_mask:0xf bank_mask:0xf
    v_mov_b32 v41, v40
    v_mov_b32 v42, v40
    s_nop 1
    v_permlane16_swap_b32 v41, v42
    s_nop 1
    v_min_u32 v40, v41, v42
    v_mov_b32 v41, v40
    v_mov_b32 v42, v40
    s_nop 1
    v_permlane32_swap_b32 v41, v42
    s_nop 1
    v_min_u32 v40, v41, v42
    s_nop 0
    v_readfirstlane_b32 s51, v40
    s_nop 3
    s_sub_u32 s51, s43, s51
    s_sub_u32 s44, s51, 1
    v_sub_u32 v40, s44, v8
    v_sub_u32 v41, s44, v9
    v_sub_u32 v42, s44, v10
    v_min3_u32 v40, v40, v41, v42
    v_sub_u32 v41, s44, v11
    v_sub_u32 v42, s44, v12
    v_min3_u32 v40, v40, v41, v42
    v_sub_u32 v41, s44, v13
    v_sub_u32 v42, s44, v14
    v_min3_u32 v40, v40, v41, v42
    v_sub_u32 v41, s44, v15
    v_sub_u32 v42, s44, v16
    v_min3_u32 v40, v40, v41, v42
    v_sub_u32 v41, s44, v17
    v_sub_u32 v42, s44, v18
    v_min3_u32 v40, v40, v41, v42
    v_sub_u32 v41, s44, v19
    v_sub_u32 v42, s44, v20
    v_min3_u32 v40, v40, v41, v42
    v_sub_u32 v41, s44, v21
    v_sub_u32 v42, s44, v22
    v_min3_u32 v40, v40, v41, v42
    v_sub_u32 v41, s44, v23
    v_sub_u32 v42, s44, v24
    v_min3_u32 v40, v40, v41, v42
    v_sub_u32 v41, s44, v25
    v_sub_u32 v42, s44, v26
    v_min3_u32 v40, v40, v41, v42
    v_sub_u32 v41, s44, v27
    v_sub_u32 v42, s44, v28
    v_min3_u32 v40, v40, v41, v42
    v_sub_u32 v41, s44, v29
    v_sub_u32 v42, s44, v30
    v_min3_u32 v40, v40, v41, v42
    v_sub_u32 v41, s44, v31
    v_sub_u32 v42, s44, v32
    v_min3_u32 v40, v40, v41, v42
    v_sub_u32 v41, s44, v33
    v_sub_u32 v42, s44, v34
    v_min3_u32 v40, v40, v41, v42
    v_sub_u32 v41, s44, v35
    v_sub_u32 v42, s44, v36
    v_min3_u32 v40, v40, v41, v42
    v_sub_u32 v41, s44, v37
    v_sub_u32 v42, s44, v38
    v_min3_u32 v40, v40, v41, v42
    v_sub_u32 v41, s44, v39
    v_min_u32 v40, v40, v41
    s_nop 1
    v_min_u32_dpp v40, v40, v40 quad_perm:[1,0,3,2] row_mask:0xf bank_mask:0xf
    s_nop 1
    v_min_u32_dpp v40, v40, v40 quad_perm:[2,3,0,1] row_mask:0xf bank_mask:0xf
    s_nop 1
    v_min_u32_dpp v40, v40, v40 row_half_mirror row_mask:0xf bank_mask:0xf
    s_nop 1
    v_min_u32_dpp v40, v40, v40 row_mirror row_mask:0xf bank_mask:0xf
    v_mov_b32 v41, v40
    v_mov_b32 v42, v40
    s_nop 1
    v_permlane16_swap_b32 v41, v42
    s_nop 1
    v_min_u32 v40, v41, v42
    v_mov_b32 v41, v40
    v_mov_b32 v42, v40
    s_nop 1
    v_permlane32_swap_b32 v41, v42
    s_nop 1
    v_min_u32 v40, v41, v42
    s_nop 0
    v_readfirstlane_b32 s52, v40
    s_nop 3
    s_sub_u32 s52, s44, s52
    s_sub_u32 s45, s52, 1
    v_sub_u32 v40, s45, v8
    v_sub_u32 v41, s45, v9
    v_sub_u32 v42, s45, v10
    v_min3_u32 v40, v40, v41, v42
    v_sub_u32 v41, s45, v11
    v_sub_u32 v42, s45, v12
    v_min3_u32 v40, v40, v41, v42
    v_sub_u32 v41, s45, v13
    v_sub_u32 v42, s45, v14
    v_min3_u32 v40, v40, v41, v42
    v_sub_u32 v41, s45, v15
    v_sub_u32 v42, s45, v16
    v_min3_u32 v40, v40, v41, v42
    v_sub_u32 v41, s45, v17
    v_sub_u32 v42, s45, v18
    v_min3_u32 v40, v40, v41, v42
    v_sub_u32 v41, s45, v19
    v_sub_u32 v42, s45, v20
    v_min3_u32 v40, v40, v41, v42
    v_sub_u32 v41, s45, v21
    v_sub_u32 v42, s45, v22
    v_min3_u32 v40, v40, v41, v42
    v_sub_u32 v41, s45, v23
    v_sub_u32 v42, s45, v24
    v_min3_u32 v40, v40, v41, v42
    v_sub_u32 v41, s45, v25
    v_sub_u32 v42, s45, v26
    v_min3_u32 v40, v40, v41, v42
    v_sub_u32 v41, s45, v27
    v_sub_u32 v42, s45, v28
    v_min3_u32 v40, v40, v41, v42
    v_sub_u32 v41, s45, v29
    v_sub_u32 v42, s45, v30
    v_min3_u32 v40, v40, v41, v42
    v_sub_u32 v41, s45, v31
    v_sub_u32 v42, s45, v32
    v_min3_u32 v40, v40, v41, v42
    v_sub_u32 v41, s45, v33
    v_sub_u32 v42, s45, v34
    v_min3_u32 v40, v40, v41, v42
    v_sub_u32 v41, s45, v35
    v_sub_u32 v42, s45, v36
    v_min3_u32 v40, v40, v41, v42
    v_sub_u32 v41, s45, v37
    v_sub_u32 v42, s45, v38
    v_min3_u32 v40, v40, v41, v42
    v_sub_u32 v41, s45, v39
    v_min_u32 v40, v40, v41
    s_nop 1
    v_min_u32_dpp v40, v40, v40 quad_perm:[1,0,3,2] row_mask:0xf bank_mask:0xf
    s_nop 1
    v_min_u32_dpp v40, v40, v40 quad_perm:[2,3,0,1] row_mask:0xf bank_mask:0xf
    s_nop 1
    v_min_u32_dpp v40, v40, v40 row_half_mirror row_mask:0xf bank_mask:0xf
    s_nop 1
    v_min_u32_dpp v40, v40, v40 row_mirror row_mask:0xf bank_mask:0xf
    v_mov_b32 v41, v40
    v_mov_b32 v42, v40
    s_nop 1
    v_permlane16_swap_b32 v41, v42
    s_nop 1
    v_min_u32 v40, v41, v42
    v_mov_b32 v41, v40
    v_mov_b32 v42, v40
    s_nop 1
    v_permlane32_swap_b32 v41, v42
    s_nop 1
    v_min_u32 v40, v41, v42
    s_nop 0
    v_readfirstlane_b32 s53, v40
    s_nop 3
    s_sub_u32 s53, s45, s53
    s_sub_u32 s46, s53, 1
    v_sub_u32 v40, s46, v8
    v_sub_u32 v41, s46, v9
    v_sub_u32 v42, s46, v10
    v_min3_u32 v40, v40, v41, v42
    v_sub_u32 v41, s46, v11
    v_sub_u32 v42, s46, v12
    v_min3_u32 v40, v40, v41, v42
    v_sub_u32 v41, s46, v13
    v_sub_u32 v42, s46, v14
    v_min3_u32 v40, v40, v41, v42
    v_sub_u32 v41, s46, v15
    v_sub_u32 v42, s46, v16
    v_min3_u32 v40, v40, v41, v42
    v_sub_u32 v41, s46, v17
    v_sub_u32 v42, s46, v18
    v_min3_u32 v40, v40, v41, v42
    v_sub_u32 v41, s46, v19
    v_sub_u32 v42, s46, v20
    v_min3_u32 v40, v40, v41, v42
    v_sub_u32 v41, s46, v21
    v_sub_u32 v42, s46, v22
    v_min3_u32 v40, v40, v41, v42
    v_sub_u32 v41, s46, v23
    v_sub_u32 v42, s46, v24
    v_min3_u32 v40, v40, v41, v42
    v_sub_u32 v41, s46, v25
    v_sub_u32 v42, s46, v26
    v_min3_u32 v40, v40, v41, v42
    v_sub_u32 v41, s46, v27
    v_sub_u32 v42, s46, v28
    v_min3_u32 v40, v40, v41, v42
    v_sub_u32 v41, s46, v29
    v_sub_u32 v42, s46, v30
    v_min3_u32 v40, v40, v41, v42
    v_sub_u32 v41, s46, v31
    v_sub_u32 v42, s46, v32
    v_min3_u32 v40, v40, v41, v42
    v_sub_u32 v41, s46, v33
    v_sub_u32 v42, s46, v34
    v_min3_u32 v40, v40, v41, v42
    v_sub_u32 v41, s46, v35
    v_sub_u32 v42, s46, v36
    v_min3_u32 v40, v40, v41, v42
    v_sub_u32 v41, s46, v37
    v_sub_u32 v42, s46, v38
    v_min3_u32 v40, v40, v41, v42
    v_sub_u32 v41, s46, v39
    v_min_u32 v40, v40, v41
    s_nop 1
    v_min_u32_dpp v40, v40, v40 quad_perm:[1,0,3,2] row_mask:0xf bank_mask:0xf
    s_nop 1
    v_min_u32_dpp v40, v40, v40 quad_perm:[2,3,0,1] row_mask:0xf bank_mask:0xf
    s_nop 1
    v_min_u32_dpp v40, v40, v40 row_half_mirror row_mask:0xf bank_mask:0xf
    s_nop 1
    v_min_u32_dpp v40, v40, v40 row_mirror row_mask:0xf bank_mask:0xf
    v_mov_b32 v41, v40
    v_mov_b32 v42, v40
    s_nop 1
    v_permlane16_swap_b32 v41, v42
    s_nop 1
    v_min_u32 v40, v41, v42
    v_mov_b32 v41, v40
    v_mov_b32 v42, v40
    s_nop 1
    v_permlane32_swap_b32 v41, v42
    s_nop 1
    v_min_u32 v40, v41, v42
    s_nop 0
    v_readfirstlane_b32 s54, v40
    s_nop 3
    s_sub_u32 s54, s46, s54
    s_sub_u32 s47, s54, 1
    v_sub_u32 v40, s47, v8
    v_sub_u32 v41, s47, v9
    v_sub_u32 v42, s47, v10
    v_min3_u32 v40, v40, v41, v42
    v_sub_u32 v41, s47, v11
    v_sub_u32 v42, s47, v12
    v_min3_u32 v40, v40, v41, v42
    v_sub_u32 v41, s47, v13
    v_sub_u32 v42, s47, v14
    v_min3_u32 v40, v40, v41, v42
    v_sub_u32 v41, s47, v15
    v_sub_u32 v42, s47, v16
    v_min3_u32 v40, v40, v41, v42
    v_sub_u32 v41, s47, v17
    v_sub_u32 v42, s47, v18
    v_min3_u32 v40, v40, v41, v42
    v_sub_u32 v41, s47, v19
    v_sub_u32 v42, s47, v20
    v_min3_u32 v40, v40, v41, v42
    v_sub_u32 v41, s47, v21
    v_sub_u32 v42, s47, v22
    v_min3_u32 v40, v40, v41, v42
    v_sub_u32 v41, s47, v23
    v_sub_u32 v42, s47, v24
    v_min3_u32 v40, v40, v41, v42
    v_sub_u32 v41, s47, v25
    v_sub_u32 v42, s47, v26
    v_min3_u32 v40, v40, v41, v42
    v_sub_u32 v41, s47, v27
    v_sub_u32 v42, s47, v28
    v_min3_u32 v40, v40, v41, v42
    v_sub_u32 v41, s47, v29
    v_sub_u32 v42, s47, v30
    v_min3_u32 v40, v40, v41, v42
    v_sub_u32 v41, s47, v31
    v_sub_u32 v42, s47, v32
    v_min3_u32 v40, v40, v41, v42
    v_sub_u32 v41, s47, v33
    v_sub_u32 v42, s47, v34
    v_min3_u32 v40, v40, v41, v42
    v_sub_u32 v41, s47, v35
    v_sub_u32 v42, s47, v36
    v_min3_u32 v40, v40, v41, v42
    v_sub_u32 v41, s47, v37
    v_sub_u32 v42, s47, v38
    v_min3_u32 v40, v40, v41, v42
    v_sub_u32 v41, s47, v39
    v_min_u32 v40, v40, v41
    s_nop 1
    v_min_u32_dpp v40, v40, v40 quad_perm:[1,0,3,2] row_mask:0xf bank_mask:0xf
    s_nop 1
    v_min_u32_dpp v40, v40, v40 quad_perm:[2,3,0,1] row_mask:0xf bank_mask:0xf
    s_nop 1
    v_min_u32_dpp v40, v40, v40 row_half_mirror row_mask:0xf bank_mask:0xf
    s_nop 1
    v_min_u32_dpp v40, v40, v40 row_mirror row_mask:0xf bank_mask:0xf
    v_mov_b32 v41, v40
    v_mov_b32 v42, v40
    s_nop 1
    v_permlane16_swap_b32 v41, v42
    s_nop 1
    v_min_u32 v40, v41, v42
    v_mov_b32 v41, v40
    v_mov_b32 v42, v40
    s_nop 1
    v_permlane32_swap_b32 v41, v42
    s_nop 1
    v_min_u32 v40, v41, v42
    s_nop 0
    v_readfirstlane_b32 s55, v40
    s_nop 3
    s_sub_u32 s55, s47, s55
    s_nop 3
    s_and_b32 s40, s48, 0x7ff
    s_sub_u32 s40, 2047, s40
    s_and_b32 s41, s49, 0x7ff
    s_sub_u32 s41, 2047, s41
    s_and_b32 s42, s50, 0x7ff
    s_sub_u32 s42, 2047, s42
    s_and_b32 s43, s51, 0x7ff
    s_sub_u32 s43, 2047, s43
    s_and_b32 s44, s52, 0x7ff
    s_sub_u32 s44, 2047, s44
    s_and_b32 s45, s53, 0x7ff
    s_sub_u32 s45, 2047, s45
    s_and_b32 s46, s54, 0x7ff
    s_sub_u32 s46, 2047, s46
    s_and_b32 s47, s55, 0x7ff
    s_sub_u32 s47, 2047, s47
    v_mov_b32 v8, s40
    v_mov_b32 v9, s41
    v_mov_b32 v10, s42
    v_mov_b32 v11, s43
    v_mov_b32 v12, s44
    v_mov_b32 v13, s45
    v_mov_b32 v14, s46
    v_mov_b32 v15, s47
    v_mov_b32 v45, 107072
    ds_write_b128 v45, v[8:11]
    ds_write_b128 v45, v[12:15] offset:16
    s_waitcnt lgkmcnt(0)

Lk5_go2:
    s_barrier
    v_mov_b32 v45, 107072
    ds_read_b128 v[8:11], v45
    ds_read_b128 v[12:15], v45 offset:16
    s_waitcnt lgkmcnt(0)

    v_readfirstlane_b32 s40, v8
    v_readfirstlane_b32 s41, v9
    v_readfirstlane_b32 s42, v10
    v_readfirstlane_b32 s43, v11
    v_readfirstlane_b32 s44, v12
    v_readfirstlane_b32 s45, v13
    v_readfirstlane_b32 s46, v14
    v_readfirstlane_b32 s47, v15
    s_nop 3
    v_mov_b32 v7, s40
    v_cmp_eq_u32 vcc, 1, v6
    v_mov_b32 v44, s41
    s_nop 0
    v_cndmask_b32 v7, v7, v44, vcc
    v_cmp_eq_u32 vcc, 2, v6
    v_mov_b32 v44, s42
    s_nop 0
    v_cndmask_b32 v7, v7, v44, vcc
    v_cmp_eq_u32 vcc, 3, v6
    v_mov_b32 v44, s43
    s_nop 0
    v_cndmask_b32 v7, v7, v44, vcc
    v_cmp_eq_u32 vcc, 4, v6
    v_mov_b32 v44, s44
    s_nop 0
    v_cndmask_b32 v7, v7, v44, vcc
    v_cmp_eq_u32 vcc, 5, v6
    v_mov_b32 v44, s45
    s_nop 0
    v_cndmask_b32 v7, v7, v44, vcc
    v_cmp_eq_u32 vcc, 6, v6
    v_mov_b32 v44, s46
    s_nop 0
    v_cndmask_b32 v7, v7, v44, vcc
    v_cmp_eq_u32 vcc, 7, v6
    v_mov_b32 v44, s47
    s_nop 0
    v_cndmask_b32 v7, v7, v44, vcc
    v_lshlrev_b32 v7, 10, v7
    v_lshrrev_b32 v44, 5, v1
    v_lshlrev_b32 v44, 4, v44
    v_add_u32 v7, v7, v44
    s_lshl_b32 s37, s36, 8

    buffer_load_dwordx4 v[64:67], v7, s[24:27], s37 offen offset:0 sc1
    buffer_load_dwordx4 v[68:71], v7, s[24:27], s37 offen offset:32 sc1
    buffer_load_dwordx4 v[72:75], v7, s[24:27], s37 offen offset:64 sc1
    buffer_load_dwordx4 v[76:79], v7, s[24:27], s37 offen offset:96 sc1
    buffer_load_dwordx4 v[80:83], v7, s[24:27], s37 offen offset:128 sc1
    buffer_load_dwordx4 v[84:87], v7, s[24:27], s37 offen offset:160 sc1
    buffer_load_dwordx4 v[88:91], v7, s[24:27], s37 offen offset:192 sc1
    buffer_load_dwordx4 v[92:95], v7, s[24:27], s37 offen offset:224 sc1
    s_cmp_eq_u32 s3, 0
    s_cselect_b32 s58, s40, s58
    s_cmp_eq_u32 s3, 1
    s_cselect_b32 s58, s41, s58
    s_cmp_eq_u32 s3, 2
    s_cselect_b32 s58, s42, s58
    s_cmp_eq_u32 s3, 3
    s_cselect_b32 s58, s43, s58
    s_cmp_eq_u32 s3, 4
    s_cselect_b32 s58, s44, s58
    s_cmp_eq_u32 s3, 5
    s_cselect_b32 s58, s45, s58
    s_cmp_eq_u32 s3, 6
    s_cselect_b32 s58, s46, s58
    s_cmp_eq_u32 s3, 7
    s_cselect_b32 s58, s47, s58
    s_lshl_b32 s59, s58, 10
    buffer_load_dwordx4 v[24:27], v4, s[24:27], s59 offen sc1
    buffer_load_dwordx4 v[28:31], v4, s[32:35], s59 offen sc1
    s_lshl_b32 s37, s58, 2
    v_mov_b32 v45, 0
    buffer_load_dword v32, v45, s[60:63], s37 offen sc1
    s_waitcnt vmcnt(3)

    ds_read_b64_tr_b16 v[96:97], v5 offset:0
    ds_read_b64_tr_b16 v[98:99], v5 offset:256
    ds_read_b64_tr_b16 v[100:101], v5 offset:1024
    ds_read_b64_tr_b16 v[102:103], v5 offset:1280
    ds_read_b64_tr_b16 v[104:105], v5 offset:2048
    ds_read_b64_tr_b16 v[106:107], v5 offset:2304
    ds_read_b64_tr_b16 v[108:109], v5 offset:3072
    ds_read_b64_tr_b16 v[110:111], v5 offset:3328
    ds_read_b64_tr_b16 v[112:113], v5 offset:4096
    ds_read_b64_tr_b16 v[114:115], v5 offset:4352
    ds_read_b64_tr_b16 v[116:117], v5 offset:5120
    ds_read_b64_tr_b16 v[118:119], v5 offset:5376
    ds_read_b64_tr_b16 v[120:121], v5 offset:6144
    ds_read_b64_tr_b16 v[122:123], v5 offset:6400
    ds_read_b64_tr_b16 v[124:125], v5 offset:7168
    ds_read_b64_tr_b16 v[126:127], v5 offset:7424
    s_waitcnt lgkmcnt(14)
    v_mfma_f32_32x32x16_bf16 v[8:23], v[96:99], v[64:67], 0
    s_waitcnt lgkmcnt(12)
    v_mfma_f32_32x32x16_bf16 v[8:23], v[100:103], v[68:71], v[8:23]
    s_waitcnt lgkmcnt(10)
    v_mfma_f32_32x32x16_bf16 v[8:23], v[104:107], v[72:75], v[8:23]
    s_waitcnt lgkmcnt(8)
    v_mfma_f32_32x32x16_bf16 v[8:23], v[108:111], v[76:79], v[8:23]
    s_waitcnt lgkmcnt(6)
    v_mfma_f32_32x32x16_bf16 v[8:23], v[112:115], v[80:83], v[8:23]
    s_waitcnt lgkmcnt(4)
    v_mfma_f32_32x32x16_bf16 v[8:23], v[116:119], v[84:87], v[8:23]
    s_waitcnt lgkmcnt(2)
    v_mfma_f32_32x32x16_bf16 v[8:23], v[120:123], v[88:91], v[8:23]
    s_waitcnt lgkmcnt(0)
    v_mfma_f32_32x32x16_bf16 v[8:23], v[124:127], v[92:95], v[8:23]
    v_and_b32 v44, 31, v1
    v_lshlrev_b32 v45, 7, v44
    v_lshrrev_b32 v46, 5, v1
    v_lshlrev_b32 v46, 4, v46
    v_add_u32 v45, v45, v46
    s_lshl_b32 s37, s3, 10
    s_add_u32 s37, s37, 98304
    v_add_u32 v45, s37, v45
    v_cmp_gt_u32 vcc, 8, v44
    s_nop 7
    s_nop 3
    s_and_saveexec_b64 s[56:57], vcc

    ds_write_b128 v45, v[8:11] offset:0
    ds_write_b128 v45, v[12:15] offset:32
    ds_write_b128 v45, v[16:19] offset:64
    ds_write_b128 v45, v[20:23] offset:96
    s_mov_b64 exec, -1
    s_waitcnt lgkmcnt(0)
    s_barrier
    s_cmp_ge_u32 s3, 4
    s_cbranch_scc1 Lk5_noact
    v_lshlrev_b32 v44, 2, v0
    v_add_u32 v44, 98304, v44

    ds_read_b32 v8, v44 offset:0
    ds_read_b32 v9, v44 offset:1024
    ds_read_b32 v10, v44 offset:2048
    ds_read_b32 v11, v44 offset:3072
    ds_read_b32 v12, v44 offset:4096
    ds_read_b32 v13, v44 offset:5120
    ds_read_b32 v14, v44 offset:6144
    ds_read_b32 v15, v44 offset:7168
    s_waitcnt lgkmcnt(0)
    v_add_f32 v8, v8, v9
    v_add_f32 v10, v10, v11
    v_add_f32 v8, v8, v10
    v_add_f32 v12, v12, v13
    v_add_f32 v14, v14, v15
    v_add_f32 v12, v12, v14

    v_cvt_pk_bf16_f32 v8, 0, v8
    v_cvt_pk_bf16_f32 v12, 0, v12
    s_mov_b32 s36, 0x3fb8aa3b
    v_mul_f32 v9, s36, v8
    v_exp_f32 v9, -v9
    s_nop 0
    v_add_f32 v9, 1.0, v9
    v_rcp_f32 v9, v9
    s_nop 0
    v_mul_f32 v8, v8, v9

    v_cvt_pk_bf16_f32 v8, 0, v8
    v_mul_f32 v8, v8, v12
    v_cvt_pk_bf16_f32 v8, v8, v8
    v_lshlrev_b32 v44, 1, v0
    v_add_u32 v44, 106496, v44
    ds_write_b16 v44, v8

Lk5_noact:
    s_waitcnt lgkmcnt(0)
    s_barrier
    ds_read_b128 v[64:67], v53
    ds_read_b128 v[68:71], v53 offset:32

    ds_read_b64_tr_b16 v[72:73], v51 offset:0
    ds_read_b64_tr_b16 v[74:75], v51 offset:4096
    ds_read_b64_tr_b16 v[76:77], v51 offset:16384
    ds_read_b64_tr_b16 v[78:79], v51 offset:20480
    ds_read_b64_tr_b16 v[80:81], v52 offset:0
    ds_read_b64_tr_b16 v[82:83], v52 offset:4096
    ds_read_b64_tr_b16 v[84:85], v52 offset:16384
    ds_read_b64_tr_b16 v[86:87], v52 offset:20480
    s_waitcnt lgkmcnt(0)
    v_mfma_f32_32x32x16_bf16 v[96:111], v[64:67], v[72:75], 0
    v_mfma_f32_32x32x16_bf16 v[96:111], v[68:71], v[76:79], v[96:111]
    v_mfma_f32_32x32x16_bf16 v[112:127], v[64:67], v[80:83], 0
    v_mfma_f32_32x32x16_bf16 v[112:127], v[68:71], v[84:87], v[112:127]
    s_lshl_b32 s37, s3, 8
    s_add_u32 s39, s37, 4096
    s_nop 15

    buffer_atomic_add_f32 v96, v54, s[28:31], s37 offen offset:0
    buffer_atomic_add_f32 v97, v54, s[28:31], s37 offen offset:2048
    buffer_atomic_add_f32 v98, v54, s[28:31], s39 offen offset:0
    buffer_atomic_add_f32 v99, v54, s[28:31], s39 offen offset:2048
    buffer_atomic_add_f32 v112, v54, s[28:31], s37 offen offset:128
    buffer_atomic_add_f32 v113, v54, s[28:31], s37 offen offset:2176
    buffer_atomic_add_f32 v114, v54, s[28:31], s39 offen offset:128
    buffer_atomic_add_f32 v115, v54, s[28:31], s39 offen offset:2176
    s_waitcnt vmcnt(0)
    s_barrier
    s_cmp_lg_u32 s3, 0
    s_cbranch_scc1 Lk5_wait
    v_mov_b32 v44, 1
    v_mov_b32 v45, 0
    s_mov_b64 exec, 1
    buffer_atomic_add v44, v45, s[72:75], 0 offen sc0 sc1
    s_waitcnt vmcnt(0)
    v_mov_b32 v45, 107008
    ds_write_b32 v45, v44
    s_mov_b64 exec, -1
    s_waitcnt lgkmcnt(0)

Lk5_wait:
    s_barrier
    v_mov_b32 v45, 107008
    ds_read_b32 v44, v45
    s_waitcnt lgkmcnt(0)
    s_nop 0
    v_readfirstlane_b32 s36, v44
    s_nop 3
    s_cmp_lg_u32 s36, 55
    s_cbranch_scc1 Lk5_end
    s_lshl_b32 s37, s3, 11

    v_mov_b32 v8, 0
    v_mov_b32 v9, 0
    v_mov_b32 v10, 0
    v_mov_b32 v11, 0
    v_mov_b32 v12, 0
    v_mov_b32 v13, 0
    v_mov_b32 v14, 0
    v_mov_b32 v15, 0
    buffer_atomic_add_f32 v8, v55, s[28:31], s37 offen offset:0 sc0
    buffer_atomic_add_f32 v9, v55, s[28:31], s37 offen offset:4 sc0
    buffer_atomic_add_f32 v10, v55, s[28:31], s37 offen offset:8 sc0
    buffer_atomic_add_f32 v11, v55, s[28:31], s37 offen offset:12 sc0
    buffer_atomic_add_f32 v12, v55, s[28:31], s37 offen offset:16 sc0
    buffer_atomic_add_f32 v13, v55, s[28:31], s37 offen offset:20 sc0
    buffer_atomic_add_f32 v14, v55, s[28:31], s37 offen offset:24 sc0
    buffer_atomic_add_f32 v15, v55, s[28:31], s37 offen offset:28 sc0
    s_mov_b32 s37, 0x3fb8aa3b
    v_mul_f32 v32, s37, v32
    v_exp_f32 v32, -v32
    s_nop 0
    v_add_f32 v32, 1.0, v32
    v_rcp_f32 v32, v32
    s_nop 0

    v_cvt_pk_bf16_f32 v32, 0, v32
    v_lshlrev_b32 v64, 16, v24
    v_and_b32 v65, 0xffff0000, v24
    v_lshlrev_b32 v72, 16, v28
    v_and_b32 v73, 0xffff0000, v28
    v_lshlrev_b32 v66, 16, v25
    v_and_b32 v67, 0xffff0000, v25
    v_lshlrev_b32 v74, 16, v29
    v_and_b32 v75, 0xffff0000, v29
    v_lshlrev_b32 v68, 16, v26
    v_and_b32 v69, 0xffff0000, v26
    v_lshlrev_b32 v76, 16, v30
    v_and_b32 v77, 0xffff0000, v30
    v_lshlrev_b32 v70, 16, v27
    v_and_b32 v71, 0xffff0000, v27
    v_lshlrev_b32 v78, 16, v31
    v_and_b32 v79, 0xffff0000, v31
    s_waitcnt vmcnt(0)
    v_cvt_pk_bf16_f32 v8, 0, v8
    v_mul_f32 v8, v8, v32
    v_cvt_pk_bf16_f32 v8, 0, v8
    v_add_f32 v8, v8, v64
    v_cvt_pk_bf16_f32 v8, 0, v8
    v_mul_f32 v8, v8, v56
    v_cvt_pk_bf16_f32 v8, 0, v8
    v_add_f32 v8, v8, v72
    v_cvt_pk_bf16_f32 v9, 0, v9
    v_mul_f32 v9, v9, v32
    v_cvt_pk_bf16_f32 v9, 0, v9
    v_add_f32 v9, v9, v65
    v_cvt_pk_bf16_f32 v9, 0, v9
    v_mul_f32 v9, v9, v57
    v_cvt_pk_bf16_f32 v9, 0, v9
    v_add_f32 v9, v9, v73
    v_cvt_pk_bf16_f32 v10, 0, v10
    v_mul_f32 v10, v10, v32
    v_cvt_pk_bf16_f32 v10, 0, v10
    v_add_f32 v10, v10, v66
    v_cvt_pk_bf16_f32 v10, 0, v10
    v_mul_f32 v10, v10, v58
    v_cvt_pk_bf16_f32 v10, 0, v10
    v_add_f32 v10, v10, v74
    v_cvt_pk_bf16_f32 v11, 0, v11
    v_mul_f32 v11, v11, v32
    v_cvt_pk_bf16_f32 v11, 0, v11
    v_add_f32 v11, v11, v67
    v_cvt_pk_bf16_f32 v11, 0, v11
    v_mul_f32 v11, v11, v59
    v_cvt_pk_bf16_f32 v11, 0, v11
    v_add_f32 v11, v11, v75
    v_cvt_pk_bf16_f32 v12, 0, v12
    v_mul_f32 v12, v12, v32
    v_cvt_pk_bf16_f32 v12, 0, v12
    v_add_f32 v12, v12, v68
    v_cvt_pk_bf16_f32 v12, 0, v12
    v_mul_f32 v12, v12, v60
    v_cvt_pk_bf16_f32 v12, 0, v12
    v_add_f32 v12, v12, v76
    v_cvt_pk_bf16_f32 v13, 0, v13
    v_mul_f32 v13, v13, v32
    v_cvt_pk_bf16_f32 v13, 0, v13
    v_add_f32 v13, v13, v69
    v_cvt_pk_bf16_f32 v13, 0, v13
    v_mul_f32 v13, v13, v61
    v_cvt_pk_bf16_f32 v13, 0, v13
    v_add_f32 v13, v13, v77
    v_cvt_pk_bf16_f32 v14, 0, v14
    v_mul_f32 v14, v14, v32
    v_cvt_pk_bf16_f32 v14, 0, v14
    v_add_f32 v14, v14, v70
    v_cvt_pk_bf16_f32 v14, 0, v14
    v_mul_f32 v14, v14, v62
    v_cvt_pk_bf16_f32 v14, 0, v14
    v_add_f32 v14, v14, v78
    v_cvt_pk_bf16_f32 v15, 0, v15
    v_mul_f32 v15, v15, v32
    v_cvt_pk_bf16_f32 v15, 0, v15
    v_add_f32 v15, v15, v71
    v_cvt_pk_bf16_f32 v15, 0, v15
    v_mul_f32 v15, v15, v63
    v_cvt_pk_bf16_f32 v15, 0, v15
    v_add_f32 v15, v15, v79
    v_cvt_pk_bf16_f32 v80, v8, v9
    v_cvt_pk_bf16_f32 v81, v10, v11
    v_cvt_pk_bf16_f32 v82, v12, v13
    v_cvt_pk_bf16_f32 v83, v14, v15
    buffer_store_dwordx4 v[80:83], v4, s[68:71], s59 offen sc1
Lk5_end:
    s_endpgm
.section .rodata,"a"
.p2align 6
.amdhsa_kernel prep_kernel
  .amdhsa_next_free_vgpr 104
  .amdhsa_next_free_sgpr 64
  .amdhsa_accum_offset 104
  .amdhsa_group_segment_fixed_size 0
  .amdhsa_kernarg_size 120
  .amdhsa_user_sgpr_count 2
  .amdhsa_user_sgpr_kernarg_segment_ptr 1
  .amdhsa_system_sgpr_workgroup_id_x 1
.end_amdhsa_kernel
.p2align 6
.amdhsa_kernel attn_kernel
  .amdhsa_next_free_vgpr 256
  .amdhsa_next_free_sgpr 80
  .amdhsa_accum_offset 160
  .amdhsa_group_segment_fixed_size 0
  .amdhsa_kernarg_size 120
  .amdhsa_user_sgpr_count 2
  .amdhsa_user_sgpr_kernarg_segment_ptr 1
  .amdhsa_system_sgpr_workgroup_id_x 1
.end_amdhsa_kernel
.p2align 6
.amdhsa_kernel oproj_kernel
  .amdhsa_next_free_vgpr 96
  .amdhsa_next_free_sgpr 64
  .amdhsa_accum_offset 96
  .amdhsa_group_segment_fixed_size 0
  .amdhsa_kernarg_size 120
  .amdhsa_user_sgpr_count 2
  .amdhsa_user_sgpr_kernarg_segment_ptr 1
  .amdhsa_system_sgpr_workgroup_id_x 1
.end_amdhsa_kernel
.p2align 6
.amdhsa_kernel pm_kernel
  .amdhsa_next_free_vgpr 128
  .amdhsa_next_free_sgpr 100
  .amdhsa_accum_offset 128
  .amdhsa_group_segment_fixed_size 0
  .amdhsa_kernarg_size 120
  .amdhsa_user_sgpr_count 2
  .amdhsa_user_sgpr_kernarg_segment_ptr 1
  .amdhsa_system_sgpr_workgroup_id_x 1
.end_amdhsa_kernel
```
